```python
import torch

def _softmax(x, axis=-1):
    return torch.softmax(x, dim=axis)
def _gelu(x):
    return torch.nn.functional.gelu(x, approximate="tanh")
def _silu(x):
    return torch.nn.functional.silu(x)
def _sigmoid(x):
    return torch.sigmoid(x)
def _layernorm(x, axis=-1, eps=1e-5):
    m = x.mean(dim=axis, keepdim=True)
    v = x.var(dim=axis, keepdim=True, unbiased=False)
    return (x - m) / torch.sqrt(v + eps)
def _scatter_add(tgt, idx, src, axis=0):
    return tgt.clone().index_add_(axis, idx, src)
def _segment_sum(src, seg, n):
    out = torch.zeros((n,) + src.shape[1:], dtype=src.dtype)
    return out.index_add_(0, seg, src)
def _pad(x, pw):
    flat = tuple(v for pair in reversed(pw) for v in pair)
    return torch.nn.functional.pad(x, flat)

kernel_name = 'recurrent_scan__mha_block_cached__moe_arch_mod__prompt'

def setup_inputs():

    _w = (lambda a: (lambda t: t.to(torch.bfloat16) if t.is_floating_point() else t)(torch.as_tensor(a)))
    def _A_setup():
        B, Sq, D = 1, 2048, 512
        H, Sk, Dh = 32, 2048, 128
        return {
            "x": _w((lambda *s: torch.randn(*s, dtype=torch.bfloat16) * 0.05)(B, Sq, D)),
            "k_cache": _w((lambda *s: torch.randn(*s, dtype=torch.bfloat16) * 1.6)(B, H, Sk, Dh)),
            "v_cache": _w((lambda *s: torch.randn(*s, dtype=torch.bfloat16) * 0.2)(B, H, Sk, Dh)),
            "wq": _w((lambda *s: torch.randn(*s, dtype=torch.bfloat16) * 1.6)(D, H * Dh) * (D ** -0.5)),
            "wo": _w((lambda *s: torch.randn(*s, dtype=torch.bfloat16) * 0.2)(H * Dh, D) * ((H * Dh) ** -0.5)),
        }
    _A_in = _A_setup()

    def _B_setup():
        B, S, D, F, C = 1, 2048, 512, 1376, 1
        return {
            "x": _w((lambda *s: torch.randn(*s, dtype=torch.bfloat16) * 0.05)(B, S, D)),
            "w_r": _w((lambda *s: torch.randn(*s, dtype=torch.bfloat16) * 0.2)(D)),
            "w_gate": _w((lambda *s: torch.randn(*s, dtype=torch.bfloat16) * 0.1)(D, F)),
            "w_up": _w((lambda *s: torch.randn(*s, dtype=torch.bfloat16) * 0.1)(D, F)),
            "w_down": _w((lambda *s: torch.randn(*s, dtype=torch.bfloat16) * 0.1)(F, D)),
        }
    _B_in = _B_setup()

    return {
        "A_x": _A_in["x"],
        "A_k_cache": _A_in["k_cache"],
        "A_v_cache": _A_in["v_cache"],
        "A_wq": _A_in["wq"],
        "A_wo": _A_in["wo"],
        "B_x": _B_in["x"],
        "B_w_r": _B_in["w_r"],
        "B_w_gate": _B_in["w_gate"],
        "B_w_up": _B_in["w_up"],
        "B_w_down": _B_in["w_down"],
    }

def reference(A_x, A_k_cache, A_v_cache, A_wq, A_wo, B_x, B_w_r, B_w_gate, B_w_up, B_w_down):
    def _A_ref(x, k_cache, v_cache, wq, wo):
        B, Sq, D = x.shape
        H, Dh = 32, 128
        q = (lambda x, *d: x.permute(*d))((x @ wq).reshape(B, Sq, H, Dh), 0, 2, 1, 3)
        scores = torch.einsum("bhqd,bhkd->bhqk", q, k_cache) * (Dh ** -0.5)
        p = _softmax(scores, axis=-1)
        o = torch.einsum("bhqk,bhkd->bhqd", p, v_cache)
        return (lambda x, *d: x.permute(*d))(o, 0, 2, 1, 3).reshape(B, Sq, H * Dh) @ wo

    def _B_ref(x, w_r, w_gate, w_up, w_down):
        B, S, D = x.shape
        C = 1
        r = x @ w_r
        idx = torch.argsort(-r, axis=-1)[:, :C]
        idx_e = (lambda x, n, axis: torch.repeat_interleave(x, n, dim=axis))(idx.reshape(B, C, 1), D, axis=2)
        x_sel = (lambda x, i, axis: torch.take_along_dim(x, i, dim=axis))(x, idx_e, axis=1)
        g = _silu(x_sel @ w_gate)
        u = x_sel @ w_up
        y = (g * u) @ w_down
        r_sel = _sigmoid((lambda x, i, axis: torch.take_along_dim(x, i, dim=axis))(r, idx, axis=1))
        y = y * r_sel.reshape(B, C, 1)
        b_off = (torch.arange(B) * S).reshape(B, 1)
        flat_idx = (idx + b_off).reshape(B * C)
        zero = (x * 0.0).reshape(B * S, D)
        upd = _scatter_add(zero, flat_idx, y.reshape(B * C, D), axis=0)
        return x + upd.reshape(B, S, D)

    x = A_x
    xn = _layernorm(x, axis=-1)
    s = _A_ref(xn, A_k_cache, A_v_cache, A_wq, A_wo)
    g = _silu(_B_ref(xn, B_w_r, B_w_gate, B_w_up, B_w_down))
    return x + s * g
```

```asm
; @launch grid=(256,1,1) block=(256,1,1) lds=163840
.amdgcn_target "amdgcn-amd-amdhsa--gfx950"
.text
.globl recurrent_scan__mha_block_cached__moe_arch_mod__prompt_kernel
.p2align 12
.p2align 8
.type recurrent_scan__mha_block_cached__moe_arch_mod__prompt_kernel,@function
recurrent_scan__mha_block_cached__moe_arch_mod__prompt_kernel:
    s_cmp_ge_u32 s2, 256
    s_cbranch_scc1 L_end
    s_load_dwordx4 s[44:47], s[0:1], 0
    s_load_dwordx4 s[48:51], s[0:1], 16
    s_load_dwordx2 s[52:53], s[0:1], 96
    s_load_dwordx4 s[60:63], s[0:1], 48
    s_load_dwordx2 s[56:57], s[0:1], 32
    s_load_dwordx4 s[64:67], s[0:1], 64
    s_load_dwordx2 s[68:69], s[0:1], 80
    v_lshrrev_b32 v2, 6, v0
    s_mov_b32 s74, 0
    v_readfirstlane_b32 s3, v2
    s_and_b32 s42, s2, 7
    s_lshl_b32 s35, s42, 2
    s_lshr_b32 s43, s2, 3
    s_and_b32 s43, s43, 3
    s_add_u32 s35, s35, s43
    s_lshr_b32 s36, s2, 5
    s_branch L_start
L_restart:
    v_mbcnt_lo_u32_b32 v0, -1, 0
    v_mbcnt_hi_u32_b32 v0, -1, v0
    v_mov_b32 v2, s3
L_start:
    v_and_b32 v1, 63, v0
    v_and_b32 v3, 15, v0
    v_bfe_u32 v4, v0, 4, 2
    v_lshlrev_b32 v5, 1, v4
    v_xor_b32 v5, v5, v3
    v_lshlrev_b32 v5, 4, v5
    v_lshlrev_b32 v6, 4, v2
    v_add_u32 v6, v6, v4
    v_lshlrev_b32 v7, 13, v6
    v_add_u32 v136, v7, v5
    v_add_u32 v137, 31744, v136
    v_xor_b32 v8, 128, v136
    v_add_u32 v138, 63488, v8
    v_add_u32 v139, 95232, v8
    s_mov_b32 s37, 0
    s_mov_b32 s38, 0
    s_lshl_b32 s42, s3, 12
    s_lshl_b32 s43, s3, 13
    s_add_u32 s28, s42, 65536
    s_add_u32 s29, s42, 81920
    s_add_u32 s30, s42, 98304
    s_add_u32 s31, s42, 114688
    s_add_u32 s39, s43, 0
    s_add_u32 s40, s43, 32768
    s_add_u32 s41, s43, 131072
    v_lshrrev_b32 v8, 3, v1
    v_lshlrev_b32 v9, 6, v2
    v_add_u32 v8, v8, v9
    v_lshlrev_b32 v8, 10, v8
    v_and_b32 v9, 7, v1
    v_xor_b32 v9, v9, v4
    v_lshlrev_b32 v9, 4, v9
    v_add_u32 v8, v8, v9
    v_xor_b32 v9, 64, v8
    v_add_u32 v128, 0, v8
    v_add_u32 v129, 7168, v9
    v_add_u32 v130, 14336, v8
    v_add_u32 v131, 21504, v9
    v_add_u32 v132, 32768, v8
    v_add_u32 v133, 39936, v9
    v_add_u32 v134, 47104, v8
    v_add_u32 v135, 54272, v9
    s_lshl_b32 s42, s35, 8
    s_sub_u32 s10, 4194304, s42
    s_lshl_b32 s43, s36, 18
    s_waitcnt lgkmcnt(0)
    s_add_u32 s8, s50, s42
    s_addc_u32 s9, s51, 0
    s_mov_b32 s11, 0x20000
    s_add_u32 s4, s44, s43
    s_addc_u32 s5, s45, 0
    s_mov_b32 s6, 262144
    s_mov_b32 s7, 0x20000
    s_mov_b32 m0, s29
    s_nop 0
    buffer_load_dwordx4 v136, s[8:11], s38 offen offset:0  lds
    buffer_load_dwordx4 v137, s[8:11], s38 offen offset:1024  lds
    buffer_load_dwordx4 v138, s[8:11], s38 offen offset:2048  lds
    buffer_load_dwordx4 v139, s[8:11], s38 offen offset:3072  lds
    s_mov_b32 m0, s40
    s_nop 0
    buffer_load_dwordx4 v128, s[4:7], s37 offen offset:0  lds
    buffer_load_dwordx4 v129, s[4:7], s37 offen offset:1024  lds
    buffer_load_dwordx4 v130, s[4:7], s37 offen offset:2048  lds
    buffer_load_dwordx4 v131, s[4:7], s37 offen offset:3072  lds
    s_add_u32 m0, s40, 4096
    s_nop 0
    buffer_load_dwordx4 v132, s[4:7], s37 offen offset:0  lds
    buffer_load_dwordx4 v133, s[4:7], s37 offen offset:1024  lds
    buffer_load_dwordx4 v134, s[4:7], s37 offen offset:2048  lds
    buffer_load_dwordx4 v135, s[4:7], s37 offen offset:3072  lds
    s_add_u32 s37, s37, 128
    s_and_b32 s37, s37, 0x3ff
    s_lshl_b32 s38, s37, 12
    s_cmp_lg_u32 s74, 0
    s_cbranch_scc1 L_noepo
    s_mov_b32 s42, 16797696
    s_load_dword s71, s[52:53], s42
L_noepo:
    v_lshlrev_b32 v252, 4, v1
    s_and_b32 s42, s2, 7
    s_lshr_b32 s43, s2, 3
    s_and_b32 s73, s43, 3
    s_mul_i32 s75, s42, 22
    s_add_u32 s75, s75, s43
    s_cmp_lt_u32 s43, 22
    s_cselect_b32 s75, s75, 255
    s_lshr_b32 s59, s42, 1
    s_and_b32 s42, s42, 1
    s_lshl_b32 s72, s36, 1
    s_add_u32 s72, s72, s42
    s_lshl_b32 s42, s3, 12
    s_add_u32 s24, s42, 0
    s_add_u32 s25, s42, 16384
    s_add_u32 s26, s42, 32768
    s_add_u32 s27, s42, 49152
    s_mov_b32 s76, s60
    s_mov_b32 s77, s61
    s_mov_b32 s78, 1024
    s_mov_b32 s79, 0x20000
    s_lshl_b32 s42, s35, 19
    s_add_u32 s12, s46, s42
    s_addc_u32 s13, s47, 0
    s_mov_b32 s14, 524288
    s_mov_b32 s15, 0x20000
    s_add_u32 s16, s48, s42
    s_addc_u32 s17, s49, 0
    s_mov_b32 s18, 524288
    s_mov_b32 s19, 0x20000
    s_mov_b32 s20, s52
    s_mov_b32 s21, s53
    s_mov_b32 s22, 268435456
    s_mov_b32 s23, 0x20000
    v_lshlrev_b32 v7, 8, v6
    v_add_u32 v234, v7, v5
    v_xor_b32 v235, 128, v234
    v_and_b32 v8, 1, v2
    v_lshlrev_b32 v8, 3, v8
    v_or_b32 v8, v8, v4
    v_xor_b32 v8, v8, v3
    v_lshlrev_b32 v8, 4, v8
    v_add_u32 v232, v7, v8
    v_xor_b32 v233, 64, v232
    v_lshrrev_b32 v8, 2, v3
    v_lshlrev_b32 v8, 3, v8
    v_and_b32 v9, 3, v3
    v_add_u32 v8, v8, v9
    v_lshlrev_b32 v8, 8, v8
    v_xor_b32 v9, v4, v3
    v_lshlrev_b32 v9, 4, v9
    v_add_u32 v228, v8, v9
    v_xor_b32 v229, 64, v228
    v_xor_b32 v230, 128, v228
    v_xor_b32 v231, 192, v228
    v_lshrrev_b32 v8, 2, v3
    v_lshlrev_b32 v9, 3, v4
    v_add_u32 v9, v9, v8
    v_lshlrev_b32 v9, 8, v9
    v_lshlrev_b32 v8, 1, v8
    v_and_b32 v10, 1, v4
    v_lshlrev_b32 v10, 3, v10
    v_or_b32 v8, v8, v10
    v_bfe_u32 v10, v1, 1, 1
    v_or_b32 v8, v8, v10
    v_lshlrev_b32 v8, 4, v8
    v_add_u32 v9, v9, v8
    v_and_b32 v10, 1, v1
    v_lshlrev_b32 v10, 3, v10
    v_add_u32 v9, v9, v10
    v_add_u32 v220, 65536, v9
    v_xor_b32 v221, 32, v220
    v_xor_b32 v222, 64, v220
    v_xor_b32 v223, 96, v220
    v_xor_b32 v224, 128, v220
    v_xor_b32 v225, 160, v220
    v_xor_b32 v226, 192, v220
    v_xor_b32 v227, 224, v220
    v_and_b32 v8, 0xffffffe7, v220
    v_and_b32 v9, 3, v1
    v_lshlrev_b32 v9, 4, v9
    v_xor_b32 v220, v8, v9
    v_xor_b32 v221, 64, v220
    v_xor_b32 v222, 128, v220
    v_xor_b32 v223, 192, v220
    v_lshlrev_b32 v8, 6, v2
    v_xor_b32 v144, v8, v220
    v_lshlrev_b32 v8, 13, v2
    v_lshlrev_b32 v9, 7, v3
    v_add_u32 v8, v8, v9
    v_lshrrev_b32 v9, 1, v3
    v_xor_b32 v9, v9, v4
    v_lshlrev_b32 v9, 4, v9
    v_add_u32 v140, v8, v9
    v_xor_b32 v141, 64, v140
    v_add_u32 v142, 131072, v140
    v_add_u32 v143, 131072, v141
    v_lshlrev_b32 v8, 4, v4
    v_add_u32 v147, 114688, v8
    v_lshlrev_b32 v9, 7, v2
    v_add_u32 v146, v147, v9
    v_mov_b32 v216, 0x3f803f80
    v_mov_b32 v236, 0
    v_mov_b32 v217, 0x3f803f80
    v_mov_b32 v237, 0
    v_mov_b32 v218, 0x3f803f80
    v_mov_b32 v238, 0
    v_mov_b32 v219, 0x3f803f80
    v_mov_b32 v239, 0
    v_and_b32 v8, 1, v4
    v_lshlrev_b32 v8, 2, v8
    v_xor_b32 v9, v8, v3
    v_lshlrev_b32 v9, 4, v9
    v_lshlrev_b32 v10, 12, v4
    v_add_u32 v240, v9, v10
    v_lshrrev_b32 v9, 2, v3
    v_lshlrev_b32 v10, 10, v9
    v_lshrrev_b32 v9, 1, v9
    v_lshlrev_b32 v9, 3, v9
    v_or_b32 v8, v8, v9
    v_and_b32 v9, 3, v1
    v_lshlrev_b32 v11, 2, v2
    v_add_u32 v9, v9, v11
    v_xor_b32 v9, v9, v8
    v_lshlrev_b32 v9, 4, v9
    v_lshlrev_b32 v11, 8, v4
    v_add3_u32 v243, v9, v10, v11
    v_lshlrev_b32 v9, 10, v3
    v_lshlrev_b32 v10, 4, v4
    v_add_u32 v241, v9, v10
    v_lshlrev_b32 v242, 3, v3
    v_mul_u32_u24 v254, 2752, v1
    v_cmp_eq_u32 vcc, 0, v1
    v_mov_b32 v8, 1073741824
    v_mov_b32 v9, 0
    v_cndmask_b32 v255, v8, v9, vcc
    s_mov_b32 m0, s30
    s_nop 0
    buffer_load_dwordx4 v136, s[8:11], s38 offen offset:0  lds
    buffer_load_dwordx4 v137, s[8:11], s38 offen offset:1024  lds
    s_cmp_eq_u32 s3, 0
    s_cbranch_scc1 L_iw0
    s_cmp_eq_u32 s3, 1
    s_cbranch_scc1 L_iw1
    s_cmp_eq_u32 s3, 2
    s_cbranch_scc1 L_iw2
    s_branch L_iw3
L_iwr6:
    buffer_load_dwordx4 v138, s[8:11], s38 offen offset:2048  lds
    buffer_load_dwordx4 v139, s[8:11], s38 offen offset:3072  lds
    s_mov_b32 m0, s41
    s_nop 0
    buffer_load_dwordx4 v128, s[4:7], s37 offen offset:0  lds
    buffer_load_dwordx4 v129, s[4:7], s37 offen offset:1024  lds
    s_cmp_eq_u32 s3, 0
    s_cbranch_scc1 L_iw4
    s_cmp_eq_u32 s3, 1
    s_cbranch_scc1 L_iw5
    s_cmp_eq_u32 s3, 2
    s_cbranch_scc1 L_iw6
    s_branch L_iw7
L_iwr7:
    buffer_load_dwordx4 v130, s[4:7], s37 offen offset:2048  lds
    buffer_load_dwordx4 v131, s[4:7], s37 offen offset:3072  lds
    s_add_u32 m0, s41, 4096
    s_nop 0
    buffer_load_dwordx4 v132, s[4:7], s37 offen offset:0  lds
    buffer_load_dwordx4 v133, s[4:7], s37 offen offset:1024  lds
    s_cmp_eq_u32 s3, 0
    s_cbranch_scc1 L_iw8
    s_cmp_eq_u32 s3, 1
    s_cbranch_scc1 L_iw9
    s_cmp_eq_u32 s3, 2
    s_cbranch_scc1 L_iw10
    s_branch L_iw11
L_iwr8:
    buffer_load_dwordx4 v134, s[4:7], s37 offen offset:2048  lds
    buffer_load_dwordx4 v135, s[4:7], s37 offen offset:3072  lds
    s_add_u32 s37, s37, 128
    s_and_b32 s37, s37, 0x3ff
    s_lshl_b32 s38, s37, 12
    s_lshl_b32 s42, s35, 3
    s_lshl_b32 s43, s3, 1
    s_add_u32 s55, s42, s43
    s_lshl_b32 s42, s55, 10
    buffer_load_dwordx4 v[156:159], v252, s[4:7], s42 offen
    buffer_load_dwordx4 v[160:163], v252, s[4:7], s42 offen offset:1024
    buffer_load_dwordx4 v[164:167], v252, s[76:79], 0 offen
    s_getpc_b64 s[84:85]
L_pc0:
    s_mov_b32 s86, L_codeend-L_pc0
    s_mov_b32 s87, 0x20000
    s_lshr_b32 s42, s2, 3
    s_lshl_b32 s42, s42, 7
    s_cmp_eq_u32 s3, 0
    s_cselect_b32 s42, s42, 1073741824
    buffer_load_dword v244, v254, s[84:87], s42 offen
    s_waitcnt lgkmcnt(0)
    s_mul_i32 s70, s71, 0x9e3779b1
    s_add_u32 s70, s70, 0x85ebca6b
    s_lshl_b32 s42, s36, 8
    s_add_u32 s55, s55, s42
    s_lshl_b32 s58, s55, 3
    s_add_u32 s58, s58, 16777216
    s_lshl_b32 s54, s36, 11
    s_lshl_b32 s43, s3, 9
    s_add_u32 s54, s54, s43
    s_add_u32 s54, s54, 16777216
    s_lshl_b32 s42, s2, 11
    s_lshl_b32 s43, s3, 9
    s_add_u32 s42, s42, s43
    s_add_u32 s42, s42, 16809984
    s_lshl_b32 s43, s74, 8
    s_add_u32 s43, s43, s2
    s_cmp_lt_u32 s43, 8
    s_cselect_b32 s83, s42, 1073741824
    s_waitcnt vmcnt(16)
    s_barrier
    ds_read_b64_tr_b16 a[224:225], v144 offset:16384
    ds_read_b64_tr_b16 a[226:227], v144 offset:17408
    ds_read_b64_tr_b16 a[228:229], v144 offset:16392
    ds_read_b64_tr_b16 a[230:231], v144 offset:17416
    ds_read_b64_tr_b16 a[232:233], v144 offset:24576
    ds_read_b64_tr_b16 a[234:235], v144 offset:25600
    ds_read_b64_tr_b16 a[236:237], v144 offset:24584
    ds_read_b64_tr_b16 a[238:239], v144 offset:25608
    ds_read_b128 a[192:195], v140 offset:32768
    ds_read_b128 a[208:211], v141 offset:32768
    ds_read_b128 a[196:199], v140 offset:34816
    ds_read_b128 a[212:215], v141 offset:34816
    ds_read_b128 a[200:203], v140 offset:36864
    ds_read_b128 a[216:219], v141 offset:36864
    ds_read_b128 a[204:207], v140 offset:38912
    ds_read_b128 a[220:223], v141 offset:38912
    ds_read_b64_tr_b16 a[128:129], v220 offset:16384
    ds_read_b64_tr_b16 a[130:131], v220 offset:17408
    ds_read_b64_tr_b16 a[160:161], v220 offset:24576
    ds_read_b64_tr_b16 a[162:163], v220 offset:25600
    ds_read_b64_tr_b16 a[132:133], v220 offset:16392
    ds_read_b64_tr_b16 a[134:135], v220 offset:17416
    ds_read_b64_tr_b16 a[164:165], v220 offset:24584
    ds_read_b64_tr_b16 a[166:167], v220 offset:25608
    ds_read_b64_tr_b16 a[136:137], v221 offset:16384
    ds_read_b64_tr_b16 a[138:139], v221 offset:17408
    ds_read_b64_tr_b16 a[168:169], v221 offset:24576
    ds_read_b64_tr_b16 a[170:171], v221 offset:25600
    ds_read_b64_tr_b16 a[140:141], v221 offset:16392
    ds_read_b64_tr_b16 a[142:143], v221 offset:17416
    ds_read_b64_tr_b16 a[172:173], v221 offset:24584
    ds_read_b64_tr_b16 a[174:175], v221 offset:25608
    ds_read_b64_tr_b16 a[144:145], v222 offset:16384
    ds_read_b64_tr_b16 a[146:147], v222 offset:17408
    ds_read_b64_tr_b16 a[176:177], v222 offset:24576
    ds_read_b64_tr_b16 a[178:179], v222 offset:25600
    ds_read_b64_tr_b16 a[148:149], v222 offset:16392
    ds_read_b64_tr_b16 a[150:151], v222 offset:17416
    ds_read_b64_tr_b16 a[180:181], v222 offset:24584
    ds_read_b64_tr_b16 a[182:183], v222 offset:25608
    ds_read_b64_tr_b16 a[152:153], v223 offset:16384
    ds_read_b64_tr_b16 a[154:155], v223 offset:17408
    ds_read_b64_tr_b16 a[184:185], v223 offset:24576
    ds_read_b64_tr_b16 a[186:187], v223 offset:25600
    ds_read_b64_tr_b16 a[156:157], v223 offset:16392
    ds_read_b64_tr_b16 a[158:159], v223 offset:17416
    ds_read_b64_tr_b16 a[188:189], v223 offset:24584
    ds_read_b64_tr_b16 a[190:191], v223 offset:25608
    s_waitcnt lgkmcnt(15)
    v_mfma_f32_16x16x32_bf16 v[148:151], a[224:227], v[216:219], 0
    s_mov_b32 m0, s31
    v_mfma_f32_16x16x32_bf16 v[148:151], a[232:235], v[216:219], v[148:151]
    buffer_load_dwordx4 v136, s[8:11], s38 offen offset:0  lds
    v_mfma_f32_16x16x32_bf16 v[152:155], a[228:231], v[216:219], 0
    buffer_load_dwordx4 v137, s[8:11], s38 offen offset:1024  lds
    v_mfma_f32_16x16x32_bf16 v[152:155], a[236:239], v[216:219], v[152:155]
    buffer_load_dwordx4 v138, s[8:11], s38 offen offset:2048  lds
    v_mfma_f32_16x16x32_bf16 v[0:3], a[128:131], a[192:195], 0
    buffer_load_dwordx4 v139, s[8:11], s38 offen offset:3072  lds
    v_mfma_f32_16x16x32_bf16 v[0:3], a[160:163], a[208:211], v[0:3]
    s_mov_b32 m0, s39
    v_mfma_f32_16x16x32_bf16 v[32:35], a[128:131], a[196:199], 0
    buffer_load_dwordx4 v128, s[4:7], s37 offen offset:0  lds
    v_mfma_f32_16x16x32_bf16 v[32:35], a[160:163], a[212:215], v[32:35]
    buffer_load_dwordx4 v129, s[4:7], s37 offen offset:1024  lds
    v_mfma_f32_16x16x32_bf16 v[64:67], a[128:131], a[200:203], 0
    buffer_load_dwordx4 v130, s[4:7], s37 offen offset:2048  lds
    v_mfma_f32_16x16x32_bf16 v[64:67], a[160:163], a[216:219], v[64:67]
    buffer_load_dwordx4 v131, s[4:7], s37 offen offset:3072  lds
    v_mfma_f32_16x16x32_bf16 v[96:99], a[128:131], a[204:207], 0
    s_add_u32 m0, s39, 4096
    v_mfma_f32_16x16x32_bf16 v[96:99], a[160:163], a[220:223], v[96:99]
    buffer_load_dwordx4 v132, s[4:7], s37 offen offset:0  lds
    v_mfma_f32_16x16x32_bf16 v[4:7], a[132:135], a[192:195], 0
    buffer_load_dwordx4 v133, s[4:7], s37 offen offset:1024  lds
    v_mfma_f32_16x16x32_bf16 v[4:7], a[164:167], a[208:211], v[4:7]
    buffer_load_dwordx4 v134, s[4:7], s37 offen offset:2048  lds
    v_mfma_f32_16x16x32_bf16 v[36:39], a[132:135], a[196:199], 0
    buffer_load_dwordx4 v135, s[4:7], s37 offen offset:3072  lds
    v_mfma_f32_16x16x32_bf16 v[36:39], a[164:167], a[212:215], v[36:39]
    s_add_u32 s37, s37, 128
    s_and_b32 s37, s37, 0x3ff
    v_mfma_f32_16x16x32_bf16 v[68:71], a[132:135], a[200:203], 0
    s_lshl_b32 s38, s37, 12
    v_mfma_f32_16x16x32_bf16 v[68:71], a[164:167], a[216:219], v[68:71]
    v_mfma_f32_16x16x32_bf16 v[100:103], a[132:135], a[204:207], 0
    v_mfma_f32_16x16x32_bf16 v[100:103], a[164:167], a[220:223], v[100:103]
    v_mfma_f32_16x16x32_bf16 v[8:11], a[136:139], a[192:195], 0
    s_mov_b64 exec, 0
    s_cmp_eq_u32 s3, 0
    s_cbranch_scc1 L_iw12
    s_cmp_eq_u32 s3, 1
    s_cbranch_scc1 L_iw13
    s_cmp_eq_u32 s3, 2
    s_cbranch_scc1 L_ix0
    s_branch L_ix1
L_iwr1:
    s_mov_b64 exec, -1
L_iwdone:
    s_waitcnt vmcnt(16) lgkmcnt(0)
    s_barrier
    v_mfma_f32_16x16x32_bf16 v[8:11], a[168:171], a[208:211], v[8:11]
    ds_read_b64_tr_b16 a[96:97], v144 offset:32768
    s_mov_b32 m0, s29
    v_mfma_f32_16x16x32_bf16 v[40:43], a[136:139], a[196:199], 0
    buffer_load_dwordx4 v136, s[8:11], s38 offen offset:0  lds
    v_mfma_f32_16x16x32_bf16 v[40:43], a[168:171], a[212:215], v[40:43]
    ds_read_b64_tr_b16 a[98:99], v144 offset:33792
    ds_read_b64_tr_b16 a[100:101], v144 offset:32776
    v_mfma_f32_16x16x32_bf16 v[72:75], a[136:139], a[200:203], 0
    buffer_load_dwordx4 v137, s[8:11], s38 offen offset:1024  lds
    v_mfma_f32_16x16x32_bf16 v[72:75], a[168:171], a[216:219], v[72:75]
    ds_read_b64_tr_b16 a[102:103], v144 offset:33800
    ds_read_b64_tr_b16 a[104:105], v144 offset:40960
    v_mfma_f32_16x16x32_bf16 v[104:107], a[136:139], a[204:207], 0
    buffer_load_dwordx4 v138, s[8:11], s38 offen offset:2048  lds
    v_mfma_f32_16x16x32_bf16 v[104:107], a[168:171], a[220:223], v[104:107]
    ds_read_b64_tr_b16 a[106:107], v144 offset:41984
    ds_read_b64_tr_b16 a[108:109], v144 offset:40968
    v_mfma_f32_16x16x32_bf16 v[12:15], a[140:143], a[192:195], 0
    buffer_load_dwordx4 v139, s[8:11], s38 offen offset:3072  lds
    v_mfma_f32_16x16x32_bf16 v[12:15], a[172:175], a[208:211], v[12:15]
    ds_read_b64_tr_b16 a[110:111], v144 offset:41992
    s_mov_b32 m0, s40
    v_mfma_f32_16x16x32_bf16 v[44:47], a[140:143], a[196:199], 0
    ds_read_b128 a[64:67], v142 offset:0
    ds_read_b128 a[80:83], v143 offset:0
    v_mfma_f32_16x16x32_bf16 v[44:47], a[172:175], a[212:215], v[44:47]
    buffer_load_dwordx4 v128, s[4:7], s37 offen offset:0  lds
    v_mfma_f32_16x16x32_bf16 v[76:79], a[140:143], a[200:203], 0
    ds_read_b128 a[68:71], v142 offset:2048
    ds_read_b128 a[84:87], v143 offset:2048
    v_mfma_f32_16x16x32_bf16 v[76:79], a[172:175], a[216:219], v[76:79]
    buffer_load_dwordx4 v129, s[4:7], s37 offen offset:1024  lds
    v_mfma_f32_16x16x32_bf16 v[108:111], a[140:143], a[204:207], 0
    s_branch L_io0
    .p2align 12
L_iw0:
    s_branch L_iwr6
L_io0:
    ds_read_b128 a[72:75], v142 offset:4096
    ds_read_b128 a[88:91], v143 offset:4096
    v_mfma_f32_16x16x32_bf16 v[108:111], a[172:175], a[220:223], v[108:111]
    buffer_load_dwordx4 v130, s[4:7], s37 offen offset:2048  lds
    v_mfma_f32_16x16x32_bf16 v[16:19], a[144:147], a[192:195], 0
    ds_read_b128 a[76:79], v142 offset:6144
    ds_read_b128 a[92:95], v143 offset:6144
    v_mfma_f32_16x16x32_bf16 v[16:19], a[176:179], a[208:211], v[16:19]
    buffer_load_dwordx4 v131, s[4:7], s37 offen offset:3072  lds
    v_mfma_f32_16x16x32_bf16 v[48:51], a[144:147], a[196:199], 0
    ds_read_b64_tr_b16 a[0:1], v220 offset:32768
    s_add_u32 m0, s40, 4096
    v_mfma_f32_16x16x32_bf16 v[48:51], a[176:179], a[212:215], v[48:51]
    ds_read_b64_tr_b16 a[2:3], v220 offset:33792
    ds_read_b64_tr_b16 a[32:33], v220 offset:40960
    v_mfma_f32_16x16x32_bf16 v[80:83], a[144:147], a[200:203], 0
    buffer_load_dwordx4 v132, s[4:7], s37 offen offset:0  lds
    v_mfma_f32_16x16x32_bf16 v[80:83], a[176:179], a[216:219], v[80:83]
    ds_read_b64_tr_b16 a[34:35], v220 offset:41984
    ds_read_b64_tr_b16 a[4:5], v220 offset:32776
    v_mfma_f32_16x16x32_bf16 v[112:115], a[144:147], a[204:207], 0
    buffer_load_dwordx4 v133, s[4:7], s37 offen offset:1024  lds
    v_mfma_f32_16x16x32_bf16 v[112:115], a[176:179], a[220:223], v[112:115]
    ds_read_b64_tr_b16 a[6:7], v220 offset:33800
    ds_read_b64_tr_b16 a[36:37], v220 offset:40968
    v_mfma_f32_16x16x32_bf16 v[20:23], a[148:151], a[192:195], 0
    buffer_load_dwordx4 v134, s[4:7], s37 offen offset:2048  lds
    v_mfma_f32_16x16x32_bf16 v[20:23], a[180:183], a[208:211], v[20:23]
    ds_read_b64_tr_b16 a[38:39], v220 offset:41992
    ds_read_b64_tr_b16 a[8:9], v221 offset:32768
    v_mfma_f32_16x16x32_bf16 v[52:55], a[148:151], a[196:199], 0
    buffer_load_dwordx4 v135, s[4:7], s37 offen offset:3072  lds
    v_mfma_f32_16x16x32_bf16 v[52:55], a[180:183], a[212:215], v[52:55]
    ds_read_b64_tr_b16 a[10:11], v221 offset:33792
    s_add_u32 s37, s37, 128
    v_mfma_f32_16x16x32_bf16 v[84:87], a[148:151], a[200:203], 0
    ds_read_b64_tr_b16 a[40:41], v221 offset:40960
    s_and_b32 s37, s37, 0x3ff
    v_mfma_f32_16x16x32_bf16 v[84:87], a[180:183], a[216:219], v[84:87]
    ds_read_b64_tr_b16 a[42:43], v221 offset:41984
    s_lshl_b32 s38, s37, 12
    v_mfma_f32_16x16x32_bf16 v[116:119], a[148:151], a[204:207], 0
    ds_read_b64_tr_b16 a[12:13], v221 offset:32776
    ds_read_b64_tr_b16 a[14:15], v221 offset:33800
    v_mfma_f32_16x16x32_bf16 v[116:119], a[180:183], a[220:223], v[116:119]
    ds_read_b64_tr_b16 a[44:45], v221 offset:40968
    ds_read_b64_tr_b16 a[46:47], v221 offset:41992
    v_mfma_f32_16x16x32_bf16 v[24:27], a[152:155], a[192:195], 0
    ds_read_b64_tr_b16 a[16:17], v222 offset:32768
    ds_read_b64_tr_b16 a[18:19], v222 offset:33792
    v_mfma_f32_16x16x32_bf16 v[24:27], a[184:187], a[208:211], v[24:27]
    ds_read_b64_tr_b16 a[48:49], v222 offset:40960
    ds_read_b64_tr_b16 a[50:51], v222 offset:41984
    v_mfma_f32_16x16x32_bf16 v[56:59], a[152:155], a[196:199], 0
    ds_read_b64_tr_b16 a[20:21], v222 offset:32776
    ds_read_b64_tr_b16 a[22:23], v222 offset:33800
    v_mfma_f32_16x16x32_bf16 v[56:59], a[184:187], a[212:215], v[56:59]
    ds_read_b64_tr_b16 a[52:53], v222 offset:40968
    ds_read_b64_tr_b16 a[54:55], v222 offset:41992
    v_mfma_f32_16x16x32_bf16 v[88:91], a[152:155], a[200:203], 0
    ds_read_b64_tr_b16 a[24:25], v223 offset:32768
    ds_read_b64_tr_b16 a[26:27], v223 offset:33792
    v_mfma_f32_16x16x32_bf16 v[88:91], a[184:187], a[216:219], v[88:91]
    ds_read_b64_tr_b16 a[56:57], v223 offset:40960
    ds_read_b64_tr_b16 a[58:59], v223 offset:41984
    v_mfma_f32_16x16x32_bf16 v[120:123], a[152:155], a[204:207], 0
    ds_read_b64_tr_b16 a[28:29], v223 offset:32776
    ds_read_b64_tr_b16 a[30:31], v223 offset:33800
    v_mfma_f32_16x16x32_bf16 v[120:123], a[184:187], a[220:223], v[120:123]
    ds_read_b64_tr_b16 a[60:61], v223 offset:40968
    ds_read_b64_tr_b16 a[62:63], v223 offset:41992
    v_mfma_f32_16x16x32_bf16 v[28:31], a[156:159], a[192:195], 0
    v_mfma_f32_16x16x32_bf16 v[28:31], a[188:191], a[208:211], v[28:31]
    v_mfma_f32_16x16x32_bf16 v[60:63], a[156:159], a[196:199], 0
    v_mfma_f32_16x16x32_bf16 v[60:63], a[188:191], a[212:215], v[60:63]
    v_mfma_f32_16x16x32_bf16 v[92:95], a[156:159], a[200:203], 0
    v_mfma_f32_16x16x32_bf16 v[92:95], a[188:191], a[216:219], v[92:95]
    v_mfma_f32_16x16x32_bf16 v[124:127], a[156:159], a[204:207], 0
    v_mfma_f32_16x16x32_bf16 v[124:127], a[188:191], a[220:223], v[124:127]
    s_waitcnt vmcnt(12) lgkmcnt(0)
    s_barrier
    v_mfma_f32_16x16x32_bf16 v[148:151], a[96:99], v[216:219], v[148:151]
    ds_read_b64_tr_b16 a[224:225], v144 offset:49152
    s_mov_b32 m0, s30
    v_mfma_f32_16x16x32_bf16 v[148:151], a[104:107], v[216:219], v[148:151]
    buffer_load_dwordx4 v136, s[8:11], s38 offen offset:0  lds
    v_mfma_f32_16x16x32_bf16 v[152:155], a[100:103], v[216:219], v[152:155]
    ds_read_b64_tr_b16 a[226:227], v144 offset:50176
    ds_read_b64_tr_b16 a[228:229], v144 offset:49160
    v_mfma_f32_16x16x32_bf16 v[152:155], a[108:111], v[216:219], v[152:155]
    v_lshrrev_b32 v168, 1, v252
    buffer_store_dwordx2 v[236:237], v168, s[20:23], s83 offen sc1
    v_mfma_f32_16x16x32_bf16 v[0:3], a[0:3], a[64:67], v[0:3]
    buffer_load_dwordx4 v137, s[8:11], s38 offen offset:1024  lds
    v_mfma_f32_16x16x32_bf16 v[0:3], a[32:35], a[80:83], v[0:3]
    ds_read_b64_tr_b16 a[230:231], v144 offset:50184
    ds_read_b64_tr_b16 a[232:233], v144 offset:57344
    v_mfma_f32_16x16x32_bf16 v[32:35], a[0:3], a[68:71], v[32:35]
    v_lshlrev_b32 v176, 16, v156
    v_and_b32 v177, 0xffff0000, v156
    v_mfma_f32_16x16x32_bf16 v[32:35], a[32:35], a[84:87], v[32:35]
    buffer_load_dwordx4 v138, s[8:11], s38 offen offset:2048  lds
    v_mfma_f32_16x16x32_bf16 v[64:67], a[0:3], a[72:75], v[64:67]
    ds_read_b64_tr_b16 a[234:235], v144 offset:58368
    ds_read_b64_tr_b16 a[236:237], v144 offset:57352
    v_mfma_f32_16x16x32_bf16 v[64:67], a[32:35], a[88:91], v[64:67]
    v_lshlrev_b32 v184, 16, v160
    v_and_b32 v185, 0xffff0000, v160
    v_mfma_f32_16x16x32_bf16 v[96:99], a[0:3], a[76:79], v[96:99]
    buffer_load_dwordx4 v139, s[8:11], s38 offen offset:3072  lds
    v_mfma_f32_16x16x32_bf16 v[96:99], a[32:35], a[92:95], v[96:99]
    ds_read_b64_tr_b16 a[238:239], v144 offset:58376
    s_mov_b32 m0, s41
    v_mfma_f32_16x16x32_bf16 v[4:7], a[4:7], a[64:67], v[4:7]
    ds_read_b128 a[192:195], v140 offset:0
    ds_read_b128 a[208:211], v141 offset:0
    v_mfma_f32_16x16x32_bf16 v[4:7], a[36:39], a[80:83], v[4:7]
    v_lshlrev_b32 v178, 16, v157
    v_and_b32 v179, 0xffff0000, v157
    v_mfma_f32_16x16x32_bf16 v[36:39], a[4:7], a[68:71], v[36:39]
    buffer_load_dwordx4 v128, s[4:7], s37 offen offset:0  lds
    v_mfma_f32_16x16x32_bf16 v[36:39], a[36:39], a[84:87], v[36:39]
    ds_read_b128 a[196:199], v140 offset:2048
    ds_read_b128 a[212:215], v141 offset:2048
    v_mfma_f32_16x16x32_bf16 v[68:71], a[4:7], a[72:75], v[68:71]
    v_lshlrev_b32 v186, 16, v161
    v_and_b32 v187, 0xffff0000, v161
    v_mfma_f32_16x16x32_bf16 v[68:71], a[36:39], a[88:91], v[68:71]
    buffer_load_dwordx4 v129, s[4:7], s37 offen offset:1024  lds
    v_mfma_f32_16x16x32_bf16 v[100:103], a[4:7], a[76:79], v[100:103]
    ds_read_b128 a[200:203], v140 offset:4096
    ds_read_b128 a[216:219], v141 offset:4096
    v_mfma_f32_16x16x32_bf16 v[100:103], a[36:39], a[92:95], v[100:103]
    v_lshlrev_b32 v180, 16, v158
    v_and_b32 v181, 0xffff0000, v158
    v_mfma_f32_16x16x32_bf16 v[8:11], a[8:11], a[64:67], v[8:11]
    buffer_load_dwordx4 v130, s[4:7], s37 offen offset:2048  lds
    v_mfma_f32_16x16x32_bf16 v[8:11], a[40:43], a[80:83], v[8:11]
    ds_read_b128 a[204:207], v140 offset:6144
    ds_read_b128 a[220:223], v141 offset:6144
    v_mfma_f32_16x16x32_bf16 v[40:43], a[8:11], a[68:71], v[40:43]
    v_lshlrev_b32 v188, 16, v162
    v_and_b32 v189, 0xffff0000, v162
    v_mfma_f32_16x16x32_bf16 v[40:43], a[40:43], a[84:87], v[40:43]
    buffer_load_dwordx4 v131, s[4:7], s37 offen offset:3072  lds
    v_mfma_f32_16x16x32_bf16 v[72:75], a[8:11], a[72:75], v[72:75]
    ds_read_b64_tr_b16 a[128:129], v220 offset:49152
    s_add_u32 m0, s41, 4096
    v_mfma_f32_16x16x32_bf16 v[72:75], a[40:43], a[88:91], v[72:75]
    ds_read_b64_tr_b16 a[130:131], v220 offset:50176
    ds_read_b64_tr_b16 a[160:161], v220 offset:57344
    v_mfma_f32_16x16x32_bf16 v[104:107], a[8:11], a[76:79], v[104:107]
    v_lshlrev_b32 v182, 16, v159
    v_and_b32 v183, 0xffff0000, v159
    v_mfma_f32_16x16x32_bf16 v[104:107], a[40:43], a[92:95], v[104:107]
    buffer_load_dwordx4 v132, s[4:7], s37 offen offset:0  lds
    v_mfma_f32_16x16x32_bf16 v[12:15], a[12:15], a[64:67], v[12:15]
    ds_read_b64_tr_b16 a[162:163], v220 offset:58368
    ds_read_b64_tr_b16 a[132:133], v220 offset:49160
    v_mfma_f32_16x16x32_bf16 v[12:15], a[44:47], a[80:83], v[12:15]
    v_lshlrev_b32 v190, 16, v163
    v_and_b32 v191, 0xffff0000, v163
    v_mfma_f32_16x16x32_bf16 v[44:47], a[12:15], a[68:71], v[44:47]
    buffer_load_dwordx4 v133, s[4:7], s37 offen offset:1024  lds
    v_mfma_f32_16x16x32_bf16 v[44:47], a[44:47], a[84:87], v[44:47]
    ds_read_b64_tr_b16 a[134:135], v220 offset:50184
    ds_read_b64_tr_b16 a[164:165], v220 offset:57352
    v_mfma_f32_16x16x32_bf16 v[76:79], a[12:15], a[72:75], v[76:79]
    v_add_f32 v200, v176, v177
    v_add_f32 v204, v184, v185
    v_mfma_f32_16x16x32_bf16 v[76:79], a[44:47], a[88:91], v[76:79]
    buffer_load_dwordx4 v134, s[4:7], s37 offen offset:2048  lds
    v_mfma_f32_16x16x32_bf16 v[108:111], a[12:15], a[76:79], v[108:111]
    ds_read_b64_tr_b16 a[166:167], v220 offset:58376
    ds_read_b64_tr_b16 a[136:137], v221 offset:49152
    v_mfma_f32_16x16x32_bf16 v[108:111], a[44:47], a[92:95], v[108:111]
    v_add_f32 v201, v178, v179
    v_add_f32 v205, v186, v187
    v_mfma_f32_16x16x32_bf16 v[16:19], a[16:19], a[64:67], v[16:19]
    buffer_load_dwordx4 v135, s[4:7], s37 offen offset:3072  lds
    v_mfma_f32_16x16x32_bf16 v[16:19], a[48:51], a[80:83], v[16:19]
    ds_read_b64_tr_b16 a[138:139], v221 offset:50176
    s_add_u32 s37, s37, 128
    v_mfma_f32_16x16x32_bf16 v[48:51], a[16:19], a[68:71], v[48:51]
    ds_read_b64_tr_b16 a[168:169], v221 offset:57344
    s_and_b32 s37, s37, 0x3ff
    v_mfma_f32_16x16x32_bf16 v[48:51], a[48:51], a[84:87], v[48:51]
    ds_read_b64_tr_b16 a[170:171], v221 offset:58368
    s_lshl_b32 s38, s37, 12
    v_mfma_f32_16x16x32_bf16 v[80:83], a[16:19], a[72:75], v[80:83]
    ds_read_b64_tr_b16 a[140:141], v221 offset:49160
    ds_read_b64_tr_b16 a[142:143], v221 offset:50184
    v_mfma_f32_16x16x32_bf16 v[80:83], a[48:51], a[88:91], v[80:83]
    v_add_f32 v202, v180, v181
    v_add_f32 v206, v188, v189
    v_mfma_f32_16x16x32_bf16 v[112:115], a[16:19], a[76:79], v[112:115]
    ds_read_b64_tr_b16 a[172:173], v221 offset:57352
    ds_read_b64_tr_b16 a[174:175], v221 offset:58376
    v_mfma_f32_16x16x32_bf16 v[112:115], a[48:51], a[92:95], v[112:115]
    v_add_f32 v203, v182, v183
    v_add_f32 v207, v190, v191
    v_mfma_f32_16x16x32_bf16 v[20:23], a[20:23], a[64:67], v[20:23]
    ds_read_b64_tr_b16 a[144:145], v222 offset:49152
    ds_read_b64_tr_b16 a[146:147], v222 offset:50176
    v_mfma_f32_16x16x32_bf16 v[20:23], a[52:55], a[80:83], v[20:23]
    v_add_f32 v200, v200, v201
    v_add_f32 v202, v202, v203
    v_mfma_f32_16x16x32_bf16 v[52:55], a[20:23], a[68:71], v[52:55]
    ds_read_b64_tr_b16 a[176:177], v222 offset:57344
    ds_read_b64_tr_b16 a[178:179], v222 offset:58368
    v_mfma_f32_16x16x32_bf16 v[52:55], a[52:55], a[84:87], v[52:55]
    v_add_f32 v204, v204, v205
    v_add_f32 v206, v206, v207
    v_mfma_f32_16x16x32_bf16 v[84:87], a[20:23], a[72:75], v[84:87]
    ds_read_b64_tr_b16 a[148:149], v222 offset:49160
    ds_read_b64_tr_b16 a[150:151], v222 offset:50184
    v_mfma_f32_16x16x32_bf16 v[84:87], a[52:55], a[88:91], v[84:87]
    v_add_f32 v208, v200, v202
    v_add_f32 v209, v204, v206
    v_mfma_f32_16x16x32_bf16 v[116:119], a[20:23], a[76:79], v[116:119]
    ds_read_b64_tr_b16 a[180:181], v222 offset:57352
    ds_read_b64_tr_b16 a[182:183], v222 offset:58376
    v_mfma_f32_16x16x32_bf16 v[116:119], a[52:55], a[92:95], v[116:119]
    v_add_f32_dpp v208, v208, v208 row_ror:8 row_mask:0xf bank_mask:0xf
    v_add_f32_dpp v209, v209, v209 row_ror:8 row_mask:0xf bank_mask:0xf
    v_mfma_f32_16x16x32_bf16 v[24:27], a[24:27], a[64:67], v[24:27]
    ds_read_b64_tr_b16 a[152:153], v223 offset:49152
    ds_read_b64_tr_b16 a[154:155], v223 offset:50176
    v_mfma_f32_16x16x32_bf16 v[24:27], a[56:59], a[80:83], v[24:27]
    v_add_f32_dpp v208, v208, v208 row_ror:4 row_mask:0xf bank_mask:0xf
    v_add_f32_dpp v209, v209, v209 row_ror:4 row_mask:0xf bank_mask:0xf
    v_mfma_f32_16x16x32_bf16 v[56:59], a[24:27], a[68:71], v[56:59]
    ds_read_b64_tr_b16 a[184:185], v223 offset:57344
    ds_read_b64_tr_b16 a[186:187], v223 offset:58368
    v_mfma_f32_16x16x32_bf16 v[56:59], a[56:59], a[84:87], v[56:59]
    v_add_f32_dpp v208, v208, v208 row_ror:2 row_mask:0xf bank_mask:0xf
    v_add_f32_dpp v209, v209, v209 row_ror:2 row_mask:0xf bank_mask:0xf
    v_mfma_f32_16x16x32_bf16 v[88:91], a[24:27], a[72:75], v[88:91]
    ds_read_b64_tr_b16 a[156:157], v223 offset:49160
    ds_read_b64_tr_b16 a[158:159], v223 offset:50184
    v_mfma_f32_16x16x32_bf16 v[88:91], a[56:59], a[88:91], v[88:91]
    v_add_f32_dpp v208, v208, v208 row_ror:1 row_mask:0xf bank_mask:0xf
    v_add_f32_dpp v209, v209, v209 row_ror:1 row_mask:0xf bank_mask:0xf
    v_mfma_f32_16x16x32_bf16 v[120:123], a[24:27], a[76:79], v[120:123]
    ds_read_b64_tr_b16 a[188:189], v223 offset:57352
    ds_read_b64_tr_b16 a[190:191], v223 offset:58376
    v_mfma_f32_16x16x32_bf16 v[120:123], a[56:59], a[92:95], v[120:123]
    v_mov_b32 v210, v208
    v_mov_b32 v211, v209
    v_mfma_f32_16x16x32_bf16 v[28:31], a[28:31], a[64:67], v[28:31]
    v_permlane16_swap_b32 v210, v208
    v_permlane16_swap_b32 v211, v209
    v_mfma_f32_16x16x32_bf16 v[28:31], a[60:63], a[80:83], v[28:31]
    v_add_f32 v208, v208, v210
    v_add_f32 v209, v209, v211
    v_mfma_f32_16x16x32_bf16 v[60:63], a[28:31], a[68:71], v[60:63]
    v_mov_b32 v210, v208
    v_mov_b32 v211, v209
    v_mfma_f32_16x16x32_bf16 v[60:63], a[60:63], a[84:87], v[60:63]
    v_permlane32_swap_b32 v210, v208
    v_permlane32_swap_b32 v211, v209
    v_mfma_f32_16x16x32_bf16 v[92:95], a[28:31], a[72:75], v[92:95]
    v_add_f32 v208, v208, v210
    v_add_f32 v209, v209, v211
    v_mfma_f32_16x16x32_bf16 v[92:95], a[60:63], a[88:91], v[92:95]
    v_mul_f32 v172, 0x3b000000, v208
    v_mul_f32 v173, 0x3b000000, v209
    v_mfma_f32_16x16x32_bf16 v[124:127], a[28:31], a[76:79], v[124:127]
    v_sub_f32 v200, v176, v172
    v_sub_f32 v204, v184, v173
    v_mfma_f32_16x16x32_bf16 v[124:127], a[60:63], a[92:95], v[124:127]
    v_mul_f32 v208, v200, v200
    v_mul_f32 v209, v204, v204
    s_waitcnt vmcnt(13) lgkmcnt(0)
    s_barrier
    v_mfma_f32_16x16x32_bf16 v[148:151], a[224:227], v[216:219], v[148:151]
    ds_read_b64_tr_b16 a[96:97], v144 offset:16384
    s_mov_b32 m0, s31
    v_mfma_f32_16x16x32_bf16 v[148:151], a[232:235], v[216:219], v[148:151]
    buffer_load_dwordx4 v136, s[8:11], s38 offen offset:0  lds
    v_mfma_f32_16x16x32_bf16 v[152:155], a[228:231], v[216:219], v[152:155]
    ds_read_b64_tr_b16 a[98:99], v144 offset:17408
    ds_read_b64_tr_b16 a[100:101], v144 offset:16392
    v_mfma_f32_16x16x32_bf16 v[152:155], a[236:239], v[216:219], v[152:155]
    v_sub_f32 v201, v177, v172
    v_sub_f32 v205, v185, v173
    v_mfma_f32_16x16x32_bf16 v[0:3], a[128:131], a[192:195], v[0:3]
    buffer_load_dwordx4 v137, s[8:11], s38 offen offset:1024  lds
    v_mfma_f32_16x16x32_bf16 v[0:3], a[160:163], a[208:211], v[0:3]
    ds_read_b64_tr_b16 a[102:103], v144 offset:17416
    ds_read_b64_tr_b16 a[104:105], v144 offset:24576
    v_mfma_f32_16x16x32_bf16 v[32:35], a[128:131], a[196:199], v[32:35]
    v_fmac_f32 v208, v201, v201
    v_fmac_f32 v209, v205, v205
    v_mfma_f32_16x16x32_bf16 v[32:35], a[160:163], a[212:215], v[32:35]
    buffer_load_dwordx4 v138, s[8:11], s38 offen offset:2048  lds
    v_mfma_f32_16x16x32_bf16 v[64:67], a[128:131], a[200:203], v[64:67]
    ds_read_b64_tr_b16 a[106:107], v144 offset:25600
    ds_read_b64_tr_b16 a[108:109], v144 offset:24584
    v_mfma_f32_16x16x32_bf16 v[64:67], a[160:163], a[216:219], v[64:67]
    v_sub_f32 v200, v178, v172
    v_sub_f32 v204, v186, v173
    v_mfma_f32_16x16x32_bf16 v[96:99], a[128:131], a[204:207], v[96:99]
    buffer_load_dwordx4 v139, s[8:11], s38 offen offset:3072  lds
    v_mfma_f32_16x16x32_bf16 v[96:99], a[160:163], a[220:223], v[96:99]
    ds_read_b64_tr_b16 a[110:111], v144 offset:25608
    s_mov_b32 m0, s39
    v_mfma_f32_16x16x32_bf16 v[4:7], a[132:135], a[192:195], v[4:7]
    ds_read_b128 a[64:67], v140 offset:32768
    ds_read_b128 a[80:83], v141 offset:32768
    v_mfma_f32_16x16x32_bf16 v[4:7], a[164:167], a[208:211], v[4:7]
    v_fmac_f32 v208, v200, v200
    v_fmac_f32 v209, v204, v204
    v_mfma_f32_16x16x32_bf16 v[36:39], a[132:135], a[196:199], v[36:39]
    buffer_load_dwordx4 v128, s[4:7], s37 offen offset:0  lds
    v_mfma_f32_16x16x32_bf16 v[36:39], a[164:167], a[212:215], v[36:39]
    ds_read_b128 a[68:71], v140 offset:34816
    ds_read_b128 a[84:87], v141 offset:34816
    v_mfma_f32_16x16x32_bf16 v[68:71], a[132:135], a[200:203], v[68:71]
    v_sub_f32 v201, v179, v172
    v_sub_f32 v205, v187, v173
    v_mfma_f32_16x16x32_bf16 v[68:71], a[164:167], a[216:219], v[68:71]
    buffer_load_dwordx4 v129, s[4:7], s37 offen offset:1024  lds
    v_mfma_f32_16x16x32_bf16 v[100:103], a[132:135], a[204:207], v[100:103]
    ds_read_b128 a[72:75], v140 offset:36864
    ds_read_b128 a[88:91], v141 offset:36864
    v_mfma_f32_16x16x32_bf16 v[100:103], a[164:167], a[220:223], v[100:103]
    v_fmac_f32 v208, v201, v201
    v_fmac_f32 v209, v205, v205
    v_mfma_f32_16x16x32_bf16 v[8:11], a[136:139], a[192:195], v[8:11]
    buffer_load_dwordx4 v130, s[4:7], s37 offen offset:2048  lds
    v_mfma_f32_16x16x32_bf16 v[8:11], a[168:171], a[208:211], v[8:11]
    ds_read_b128 a[76:79], v140 offset:38912
    ds_read_b128 a[92:95], v141 offset:38912
    v_mfma_f32_16x16x32_bf16 v[40:43], a[136:139], a[196:199], v[40:43]
    v_sub_f32 v200, v180, v172
    v_sub_f32 v204, v188, v173
    v_mfma_f32_16x16x32_bf16 v[40:43], a[168:171], a[212:215], v[40:43]
    buffer_load_dwordx4 v131, s[4:7], s37 offen offset:3072  lds
    v_mfma_f32_16x16x32_bf16 v[72:75], a[136:139], a[200:203], v[72:75]
    ds_read_b64_tr_b16 a[0:1], v220 offset:16384
    s_add_u32 m0, s39, 4096
    v_mfma_f32_16x16x32_bf16 v[72:75], a[168:171], a[216:219], v[72:75]
    ds_read_b64_tr_b16 a[2:3], v220 offset:17408
    ds_read_b64_tr_b16 a[32:33], v220 offset:24576
    v_mfma_f32_16x16x32_bf16 v[104:107], a[136:139], a[204:207], v[104:107]
    v_fmac_f32 v208, v200, v200
    v_fmac_f32 v209, v204, v204
    v_mfma_f32_16x16x32_bf16 v[104:107], a[168:171], a[220:223], v[104:107]
    buffer_load_dwordx4 v132, s[4:7], s37 offen offset:0  lds
    v_mfma_f32_16x16x32_bf16 v[12:15], a[140:143], a[192:195], v[12:15]
    ds_read_b64_tr_b16 a[34:35], v220 offset:25600
    ds_read_b64_tr_b16 a[4:5], v220 offset:16392
    v_mfma_f32_16x16x32_bf16 v[12:15], a[172:175], a[208:211], v[12:15]
    v_sub_f32 v201, v181, v172
    v_sub_f32 v205, v189, v173
    v_mfma_f32_16x16x32_bf16 v[44:47], a[140:143], a[196:199], v[44:47]
    buffer_load_dwordx4 v133, s[4:7], s37 offen offset:1024  lds
    v_mfma_f32_16x16x32_bf16 v[44:47], a[172:175], a[212:215], v[44:47]
    ds_read_b64_tr_b16 a[6:7], v220 offset:17416
    ds_read_b64_tr_b16 a[36:37], v220 offset:24584
    v_mfma_f32_16x16x32_bf16 v[76:79], a[140:143], a[200:203], v[76:79]
    v_fmac_f32 v208, v201, v201
    v_fmac_f32 v209, v205, v205
    v_mfma_f32_16x16x32_bf16 v[76:79], a[172:175], a[216:219], v[76:79]
    buffer_load_dwordx4 v134, s[4:7], s37 offen offset:2048  lds
    v_mfma_f32_16x16x32_bf16 v[108:111], a[140:143], a[204:207], v[108:111]
    ds_read_b64_tr_b16 a[38:39], v220 offset:25608
    ds_read_b64_tr_b16 a[8:9], v221 offset:16384
    v_mfma_f32_16x16x32_bf16 v[108:111], a[172:175], a[220:223], v[108:111]
    s_branch L_io1
    .p2align 12
L_iw1:
    s_branch L_iwr6
L_io1:
    v_sub_f32 v200, v182, v172
    v_sub_f32 v204, v190, v173
    v_mfma_f32_16x16x32_bf16 v[16:19], a[144:147], a[192:195], v[16:19]
    buffer_load_dwordx4 v135, s[4:7], s37 offen offset:3072  lds
    v_mfma_f32_16x16x32_bf16 v[16:19], a[176:179], a[208:211], v[16:19]
    ds_read_b64_tr_b16 a[10:11], v221 offset:17408
    s_add_u32 s37, s37, 128
    v_mfma_f32_16x16x32_bf16 v[48:51], a[144:147], a[196:199], v[48:51]
    ds_read_b64_tr_b16 a[40:41], v221 offset:24576
    s_and_b32 s37, s37, 0x3ff
    v_mfma_f32_16x16x32_bf16 v[48:51], a[176:179], a[212:215], v[48:51]
    ds_read_b64_tr_b16 a[42:43], v221 offset:25600
    s_lshl_b32 s38, s37, 12
    v_mfma_f32_16x16x32_bf16 v[80:83], a[144:147], a[200:203], v[80:83]
    ds_read_b64_tr_b16 a[12:13], v221 offset:16392
    ds_read_b64_tr_b16 a[14:15], v221 offset:17416
    v_mfma_f32_16x16x32_bf16 v[80:83], a[176:179], a[216:219], v[80:83]
    v_fmac_f32 v208, v200, v200
    v_fmac_f32 v209, v204, v204
    v_mfma_f32_16x16x32_bf16 v[112:115], a[144:147], a[204:207], v[112:115]
    ds_read_b64_tr_b16 a[44:45], v221 offset:24584
    ds_read_b64_tr_b16 a[46:47], v221 offset:25608
    v_mfma_f32_16x16x32_bf16 v[112:115], a[176:179], a[220:223], v[112:115]
    v_sub_f32 v201, v183, v172
    v_sub_f32 v205, v191, v173
    v_mfma_f32_16x16x32_bf16 v[20:23], a[148:151], a[192:195], v[20:23]
    ds_read_b64_tr_b16 a[16:17], v222 offset:16384
    ds_read_b64_tr_b16 a[18:19], v222 offset:17408
    v_mfma_f32_16x16x32_bf16 v[20:23], a[180:183], a[208:211], v[20:23]
    v_fmac_f32 v208, v201, v201
    v_fmac_f32 v209, v205, v205
    v_mfma_f32_16x16x32_bf16 v[52:55], a[148:151], a[196:199], v[52:55]
    ds_read_b64_tr_b16 a[48:49], v222 offset:24576
    ds_read_b64_tr_b16 a[50:51], v222 offset:25600
    v_mfma_f32_16x16x32_bf16 v[52:55], a[180:183], a[212:215], v[52:55]
    v_add_f32_dpp v208, v208, v208 row_ror:8 row_mask:0xf bank_mask:0xf
    v_add_f32_dpp v209, v209, v209 row_ror:8 row_mask:0xf bank_mask:0xf
    v_mfma_f32_16x16x32_bf16 v[84:87], a[148:151], a[200:203], v[84:87]
    ds_read_b64_tr_b16 a[20:21], v222 offset:16392
    ds_read_b64_tr_b16 a[22:23], v222 offset:17416
    v_mfma_f32_16x16x32_bf16 v[84:87], a[180:183], a[216:219], v[84:87]
    v_add_f32_dpp v208, v208, v208 row_ror:4 row_mask:0xf bank_mask:0xf
    v_add_f32_dpp v209, v209, v209 row_ror:4 row_mask:0xf bank_mask:0xf
    v_mfma_f32_16x16x32_bf16 v[116:119], a[148:151], a[204:207], v[116:119]
    ds_read_b64_tr_b16 a[52:53], v222 offset:24584
    ds_read_b64_tr_b16 a[54:55], v222 offset:25608
    v_mfma_f32_16x16x32_bf16 v[116:119], a[180:183], a[220:223], v[116:119]
    v_add_f32_dpp v208, v208, v208 row_ror:2 row_mask:0xf bank_mask:0xf
    v_add_f32_dpp v209, v209, v209 row_ror:2 row_mask:0xf bank_mask:0xf
    v_mfma_f32_16x16x32_bf16 v[24:27], a[152:155], a[192:195], v[24:27]
    ds_read_b64_tr_b16 a[24:25], v223 offset:16384
    ds_read_b64_tr_b16 a[26:27], v223 offset:17408
    v_mfma_f32_16x16x32_bf16 v[24:27], a[184:187], a[208:211], v[24:27]
    v_add_f32_dpp v208, v208, v208 row_ror:1 row_mask:0xf bank_mask:0xf
    v_add_f32_dpp v209, v209, v209 row_ror:1 row_mask:0xf bank_mask:0xf
    v_mfma_f32_16x16x32_bf16 v[56:59], a[152:155], a[196:199], v[56:59]
    ds_read_b64_tr_b16 a[56:57], v223 offset:24576
    ds_read_b64_tr_b16 a[58:59], v223 offset:25600
    v_mfma_f32_16x16x32_bf16 v[56:59], a[184:187], a[212:215], v[56:59]
    v_mov_b32 v210, v208
    v_mov_b32 v211, v209
    v_mfma_f32_16x16x32_bf16 v[88:91], a[152:155], a[200:203], v[88:91]
    ds_read_b64_tr_b16 a[28:29], v223 offset:16392
    ds_read_b64_tr_b16 a[30:31], v223 offset:17416
    v_mfma_f32_16x16x32_bf16 v[88:91], a[184:187], a[216:219], v[88:91]
    v_permlane16_swap_b32 v210, v208
    v_permlane16_swap_b32 v211, v209
    v_mfma_f32_16x16x32_bf16 v[120:123], a[152:155], a[204:207], v[120:123]
    ds_read_b64_tr_b16 a[60:61], v223 offset:24584
    ds_read_b64_tr_b16 a[62:63], v223 offset:25608
    v_mfma_f32_16x16x32_bf16 v[120:123], a[184:187], a[220:223], v[120:123]
    v_add_f32 v208, v208, v210
    v_add_f32 v209, v209, v211
    v_mfma_f32_16x16x32_bf16 v[28:31], a[156:159], a[192:195], v[28:31]
    v_mov_b32 v210, v208
    v_mov_b32 v211, v209
    v_mfma_f32_16x16x32_bf16 v[28:31], a[188:191], a[208:211], v[28:31]
    v_permlane32_swap_b32 v210, v208
    v_permlane32_swap_b32 v211, v209
    v_mfma_f32_16x16x32_bf16 v[60:63], a[156:159], a[196:199], v[60:63]
    v_add_f32 v208, v208, v210
    v_add_f32 v209, v209, v211
    v_mfma_f32_16x16x32_bf16 v[60:63], a[188:191], a[212:215], v[60:63]
    v_mul_f32 v208, 0x3b000000, v208
    v_mul_f32 v209, 0x3b000000, v209
    v_mfma_f32_16x16x32_bf16 v[92:95], a[156:159], a[200:203], v[92:95]
    v_cvt_pk_bf16_f32 v208, v208, v172
    v_and_b32 v172, 0xffff0000, v208
    v_mfma_f32_16x16x32_bf16 v[92:95], a[188:191], a[216:219], v[92:95]
    v_lshlrev_b32 v208, 16, v208
    v_cvt_pk_bf16_f32 v209, v209, v173
    v_mfma_f32_16x16x32_bf16 v[124:127], a[156:159], a[204:207], v[124:127]
    v_and_b32 v173, 0xffff0000, v209
    v_lshlrev_b32 v209, 16, v209
    v_mfma_f32_16x16x32_bf16 v[124:127], a[188:191], a[220:223], v[124:127]
    v_add_f32 v208, 0x3727c5ac, v208
    v_add_f32 v209, 0x3727c5ac, v209
    s_waitcnt vmcnt(12) lgkmcnt(0)
    s_barrier
    v_mfma_f32_16x16x32_bf16 v[148:151], a[96:99], v[216:219], v[148:151]
    ds_read_b64_tr_b16 a[224:225], v144 offset:32768
    s_mov_b32 m0, s29
    v_mfma_f32_16x16x32_bf16 v[148:151], a[104:107], v[216:219], v[148:151]
    buffer_load_dwordx4 v136, s[8:11], s38 offen offset:0  lds
    v_mfma_f32_16x16x32_bf16 v[152:155], a[100:103], v[216:219], v[152:155]
    ds_read_b64_tr_b16 a[226:227], v144 offset:33792
    ds_read_b64_tr_b16 a[228:229], v144 offset:32776
    v_mfma_f32_16x16x32_bf16 v[152:155], a[108:111], v[216:219], v[152:155]
    v_cvt_pk_bf16_f32 v208, v208, v209
    v_and_b32 v209, 0xffff0000, v208
    v_mfma_f32_16x16x32_bf16 v[0:3], a[0:3], a[64:67], v[0:3]
    buffer_load_dwordx4 v137, s[8:11], s38 offen offset:1024  lds
    v_mfma_f32_16x16x32_bf16 v[0:3], a[32:35], a[80:83], v[0:3]
    ds_read_b64_tr_b16 a[230:231], v144 offset:33800
    ds_read_b64_tr_b16 a[232:233], v144 offset:40960
    v_mfma_f32_16x16x32_bf16 v[32:35], a[0:3], a[68:71], v[32:35]
    v_lshlrev_b32 v208, 16, v208
    v_sqrt_f32 v208, v208
    v_mfma_f32_16x16x32_bf16 v[32:35], a[32:35], a[84:87], v[32:35]
    buffer_load_dwordx4 v138, s[8:11], s38 offen offset:2048  lds
    v_mfma_f32_16x16x32_bf16 v[64:67], a[0:3], a[72:75], v[64:67]
    ds_read_b64_tr_b16 a[234:235], v144 offset:41984
    ds_read_b64_tr_b16 a[236:237], v144 offset:40968
    v_mfma_f32_16x16x32_bf16 v[64:67], a[32:35], a[88:91], v[64:67]
    v_sqrt_f32 v209, v209
    v_mov_b32 v169, s70
    v_mfma_f32_16x16x32_bf16 v[96:99], a[0:3], a[76:79], v[96:99]
    buffer_load_dwordx4 v139, s[8:11], s38 offen offset:3072  lds
    v_mfma_f32_16x16x32_bf16 v[96:99], a[32:35], a[92:95], v[96:99]
    ds_read_b64_tr_b16 a[238:239], v144 offset:41992
    s_mov_b32 m0, s40
    v_mfma_f32_16x16x32_bf16 v[4:7], a[4:7], a[64:67], v[4:7]
    ds_read_b128 a[192:195], v142 offset:0
    ds_read_b128 a[208:211], v143 offset:0
    v_mfma_f32_16x16x32_bf16 v[4:7], a[36:39], a[80:83], v[4:7]
    v_mov_b32 v171, s70
    v_cvt_pk_bf16_f32 v208, v208, v209
    v_mfma_f32_16x16x32_bf16 v[36:39], a[4:7], a[68:71], v[36:39]
    buffer_load_dwordx4 v128, s[4:7], s37 offen offset:0  lds
    v_mfma_f32_16x16x32_bf16 v[36:39], a[36:39], a[84:87], v[36:39]
    ds_read_b128 a[196:199], v142 offset:2048
    ds_read_b128 a[212:215], v143 offset:2048
    v_mfma_f32_16x16x32_bf16 v[68:71], a[4:7], a[72:75], v[68:71]
    v_and_b32 v209, 0xffff0000, v208
    v_lshlrev_b32 v208, 16, v208
    v_mfma_f32_16x16x32_bf16 v[68:71], a[36:39], a[88:91], v[68:71]
    buffer_load_dwordx4 v129, s[4:7], s37 offen offset:1024  lds
    v_mfma_f32_16x16x32_bf16 v[100:103], a[4:7], a[76:79], v[100:103]
    ds_read_b128 a[200:203], v142 offset:4096
    ds_read_b128 a[216:219], v143 offset:4096
    v_mfma_f32_16x16x32_bf16 v[100:103], a[36:39], a[92:95], v[100:103]
    v_lshrrev_b32 v210, 16, v208
    v_lshrrev_b32 v211, 16, v209
    v_mfma_f32_16x16x32_bf16 v[8:11], a[8:11], a[64:67], v[8:11]
    buffer_load_dwordx4 v130, s[4:7], s37 offen offset:2048  lds
    v_mfma_f32_16x16x32_bf16 v[8:11], a[40:43], a[80:83], v[8:11]
    ds_read_b128 a[204:207], v142 offset:6144
    ds_read_b128 a[220:223], v143 offset:6144
    v_mfma_f32_16x16x32_bf16 v[40:43], a[8:11], a[68:71], v[40:43]
    v_or_b32 v168, v210, v172
    v_or_b32 v170, v211, v173
    v_mfma_f32_16x16x32_bf16 v[40:43], a[40:43], a[84:87], v[40:43]
    buffer_load_dwordx4 v131, s[4:7], s37 offen offset:3072  lds
    v_mfma_f32_16x16x32_bf16 v[72:75], a[8:11], a[72:75], v[72:75]
    ds_read_b64_tr_b16 a[128:129], v220 offset:32768
    s_add_u32 m0, s40, 4096
    v_mfma_f32_16x16x32_bf16 v[72:75], a[40:43], a[88:91], v[72:75]
    ds_read_b64_tr_b16 a[130:131], v220 offset:33792
    ds_read_b64_tr_b16 a[160:161], v220 offset:40960
    v_mfma_f32_16x16x32_bf16 v[104:107], a[8:11], a[76:79], v[104:107]
    v_rcp_f32 v174, v208
    v_rcp_f32 v175, v209
    v_mfma_f32_16x16x32_bf16 v[104:107], a[40:43], a[92:95], v[104:107]
    buffer_load_dwordx4 v132, s[4:7], s37 offen offset:0  lds
    v_mfma_f32_16x16x32_bf16 v[12:15], a[12:15], a[64:67], v[12:15]
    ds_read_b64_tr_b16 a[162:163], v220 offset:41984
    ds_read_b64_tr_b16 a[132:133], v220 offset:32776
    v_mfma_f32_16x16x32_bf16 v[12:15], a[44:47], a[80:83], v[12:15]
    buffer_store_dwordx4 v[168:171], v255, s[20:23], s58 offen sc1
    v_and_b32 v156, 0xf0, v252
    v_mfma_f32_16x16x32_bf16 v[44:47], a[12:15], a[68:71], v[44:47]
    buffer_load_dwordx4 v133, s[4:7], s37 offen offset:1024  lds
    v_mfma_f32_16x16x32_bf16 v[44:47], a[44:47], a[84:87], v[44:47]
    ds_read_b64_tr_b16 a[134:135], v220 offset:33800
    ds_read_b64_tr_b16 a[164:165], v220 offset:40968
    v_mfma_f32_16x16x32_bf16 v[76:79], a[12:15], a[72:75], v[76:79]
    v_lshrrev_b32 v156, 1, v156
    v_lshlrev_b32 v192, 16, v164
    v_mfma_f32_16x16x32_bf16 v[76:79], a[44:47], a[88:91], v[76:79]
    buffer_load_dwordx4 v134, s[4:7], s37 offen offset:2048  lds
    v_mfma_f32_16x16x32_bf16 v[108:111], a[12:15], a[76:79], v[108:111]
    ds_read_b64_tr_b16 a[166:167], v220 offset:41992
    ds_read_b64_tr_b16 a[136:137], v221 offset:32768
    v_mfma_f32_16x16x32_bf16 v[108:111], a[44:47], a[92:95], v[108:111]
    v_and_b32 v193, 0xffff0000, v164
    v_lshlrev_b32 v194, 16, v165
    v_mfma_f32_16x16x32_bf16 v[16:19], a[16:19], a[64:67], v[16:19]
    buffer_load_dwordx4 v135, s[4:7], s37 offen offset:3072  lds
    v_mfma_f32_16x16x32_bf16 v[16:19], a[48:51], a[80:83], v[16:19]
    ds_read_b64_tr_b16 a[138:139], v221 offset:33792
    s_add_u32 s37, s37, 128
    v_mfma_f32_16x16x32_bf16 v[48:51], a[16:19], a[68:71], v[48:51]
    ds_read_b64_tr_b16 a[168:169], v221 offset:40960
    s_and_b32 s37, s37, 0x3ff
    v_mfma_f32_16x16x32_bf16 v[48:51], a[48:51], a[84:87], v[48:51]
    ds_read_b64_tr_b16 a[170:171], v221 offset:41984
    s_lshl_b32 s38, s37, 12
    v_mfma_f32_16x16x32_bf16 v[80:83], a[16:19], a[72:75], v[80:83]
    ds_read_b64_tr_b16 a[140:141], v221 offset:32776
    ds_read_b64_tr_b16 a[142:143], v221 offset:33800
    v_mfma_f32_16x16x32_bf16 v[80:83], a[48:51], a[88:91], v[80:83]
    v_and_b32 v195, 0xffff0000, v165
    v_lshlrev_b32 v196, 16, v166
    v_mfma_f32_16x16x32_bf16 v[112:115], a[16:19], a[76:79], v[112:115]
    ds_read_b64_tr_b16 a[172:173], v221 offset:40968
    ds_read_b64_tr_b16 a[174:175], v221 offset:41992
    v_mfma_f32_16x16x32_bf16 v[112:115], a[48:51], a[92:95], v[112:115]
    v_and_b32 v197, 0xffff0000, v166
    v_lshlrev_b32 v198, 16, v167
    v_mfma_f32_16x16x32_bf16 v[20:23], a[20:23], a[64:67], v[20:23]
    ds_read_b64_tr_b16 a[144:145], v222 offset:32768
    ds_read_b64_tr_b16 a[146:147], v222 offset:33792
    v_mfma_f32_16x16x32_bf16 v[20:23], a[52:55], a[80:83], v[20:23]
    v_and_b32 v199, 0xffff0000, v167
    v_sub_f32 v176, v176, v172
    v_mfma_f32_16x16x32_bf16 v[52:55], a[20:23], a[68:71], v[52:55]
    ds_read_b64_tr_b16 a[176:177], v222 offset:40960
    ds_read_b64_tr_b16 a[178:179], v222 offset:41984
    v_mfma_f32_16x16x32_bf16 v[52:55], a[52:55], a[84:87], v[52:55]
    v_sub_f32 v184, v184, v173
    v_sub_f32 v177, v177, v172
    v_mfma_f32_16x16x32_bf16 v[84:87], a[20:23], a[72:75], v[84:87]
    ds_read_b64_tr_b16 a[148:149], v222 offset:32776
    ds_read_b64_tr_b16 a[150:151], v222 offset:33800
    v_mfma_f32_16x16x32_bf16 v[84:87], a[52:55], a[88:91], v[84:87]
    v_sub_f32 v185, v185, v173
    v_sub_f32 v178, v178, v172
    v_mfma_f32_16x16x32_bf16 v[116:119], a[20:23], a[76:79], v[116:119]
    ds_read_b64_tr_b16 a[180:181], v222 offset:40968
    ds_read_b64_tr_b16 a[182:183], v222 offset:41992
    v_mfma_f32_16x16x32_bf16 v[116:119], a[52:55], a[92:95], v[116:119]
    v_sub_f32 v186, v186, v173
    v_sub_f32 v179, v179, v172
    v_mfma_f32_16x16x32_bf16 v[24:27], a[24:27], a[64:67], v[24:27]
    ds_read_b64_tr_b16 a[152:153], v223 offset:32768
    ds_read_b64_tr_b16 a[154:155], v223 offset:33792
    v_mfma_f32_16x16x32_bf16 v[24:27], a[56:59], a[80:83], v[24:27]
    v_sub_f32 v187, v187, v173
    v_sub_f32 v180, v180, v172
    v_mfma_f32_16x16x32_bf16 v[56:59], a[24:27], a[68:71], v[56:59]
    ds_read_b64_tr_b16 a[184:185], v223 offset:40960
    ds_read_b64_tr_b16 a[186:187], v223 offset:41984
    v_mfma_f32_16x16x32_bf16 v[56:59], a[56:59], a[84:87], v[56:59]
    v_sub_f32 v188, v188, v173
    v_sub_f32 v181, v181, v172
    v_mfma_f32_16x16x32_bf16 v[88:91], a[24:27], a[72:75], v[88:91]
    ds_read_b64_tr_b16 a[156:157], v223 offset:32776
    ds_read_b64_tr_b16 a[158:159], v223 offset:33800
    v_mfma_f32_16x16x32_bf16 v[88:91], a[56:59], a[88:91], v[88:91]
    v_sub_f32 v189, v189, v173
    v_sub_f32 v182, v182, v172
    v_mfma_f32_16x16x32_bf16 v[120:123], a[24:27], a[76:79], v[120:123]
    ds_read_b64_tr_b16 a[188:189], v223 offset:40968
    ds_read_b64_tr_b16 a[190:191], v223 offset:41992
    v_mfma_f32_16x16x32_bf16 v[120:123], a[56:59], a[92:95], v[120:123]
    v_sub_f32 v190, v190, v173
    v_sub_f32 v183, v183, v172
    v_mfma_f32_16x16x32_bf16 v[28:31], a[28:31], a[64:67], v[28:31]
    v_sub_f32 v191, v191, v173
    v_cvt_pk_bf16_f32 v176, v176, v177
    v_mfma_f32_16x16x32_bf16 v[28:31], a[60:63], a[80:83], v[28:31]
    v_cvt_pk_bf16_f32 v178, v178, v179
    v_cvt_pk_bf16_f32 v180, v180, v181
    v_mfma_f32_16x16x32_bf16 v[60:63], a[28:31], a[68:71], v[60:63]
    v_cvt_pk_bf16_f32 v182, v182, v183
    v_and_b32 v177, 0xffff0000, v176
    v_mfma_f32_16x16x32_bf16 v[60:63], a[60:63], a[84:87], v[60:63]
    v_lshlrev_b32 v176, 16, v176
    v_and_b32 v179, 0xffff0000, v178
    v_mfma_f32_16x16x32_bf16 v[92:95], a[28:31], a[72:75], v[92:95]
    v_lshlrev_b32 v178, 16, v178
    v_and_b32 v181, 0xffff0000, v180
    v_mfma_f32_16x16x32_bf16 v[92:95], a[60:63], a[88:91], v[92:95]
    v_lshlrev_b32 v180, 16, v180
    v_and_b32 v183, 0xffff0000, v182
    v_mfma_f32_16x16x32_bf16 v[124:127], a[28:31], a[76:79], v[124:127]
    v_lshlrev_b32 v182, 16, v182
    v_cvt_pk_bf16_f32 v184, v184, v185
    v_mfma_f32_16x16x32_bf16 v[124:127], a[60:63], a[92:95], v[124:127]
    v_cvt_pk_bf16_f32 v186, v186, v187
    v_cvt_pk_bf16_f32 v188, v188, v189
    s_waitcnt vmcnt(13) lgkmcnt(0)
    s_barrier
    v_mfma_f32_16x16x32_bf16 v[148:151], a[224:227], v[216:219], v[148:151]
    ds_read_b64_tr_b16 a[96:97], v144 offset:49152
    s_mov_b32 m0, s30
    v_mfma_f32_16x16x32_bf16 v[148:151], a[232:235], v[216:219], v[148:151]
    buffer_load_dwordx4 v136, s[8:11], s38 offen offset:0  lds
    v_mfma_f32_16x16x32_bf16 v[152:155], a[228:231], v[216:219], v[152:155]
    ds_read_b64_tr_b16 a[98:99], v144 offset:50176
    ds_read_b64_tr_b16 a[100:101], v144 offset:49160
    v_mfma_f32_16x16x32_bf16 v[152:155], a[236:239], v[216:219], v[152:155]
    v_cvt_pk_bf16_f32 v190, v190, v191
    v_and_b32 v185, 0xffff0000, v184
    v_mfma_f32_16x16x32_bf16 v[0:3], a[128:131], a[192:195], v[0:3]
    buffer_load_dwordx4 v137, s[8:11], s38 offen offset:1024  lds
    v_mfma_f32_16x16x32_bf16 v[0:3], a[160:163], a[208:211], v[0:3]
    ds_read_b64_tr_b16 a[102:103], v144 offset:50184
    ds_read_b64_tr_b16 a[104:105], v144 offset:57344
    v_mfma_f32_16x16x32_bf16 v[32:35], a[128:131], a[196:199], v[32:35]
    v_lshlrev_b32 v184, 16, v184
    v_and_b32 v187, 0xffff0000, v186
    v_mfma_f32_16x16x32_bf16 v[32:35], a[160:163], a[212:215], v[32:35]
    buffer_load_dwordx4 v138, s[8:11], s38 offen offset:2048  lds
    v_mfma_f32_16x16x32_bf16 v[64:67], a[128:131], a[200:203], v[64:67]
    ds_read_b64_tr_b16 a[106:107], v144 offset:58368
    ds_read_b64_tr_b16 a[108:109], v144 offset:57352
    v_mfma_f32_16x16x32_bf16 v[64:67], a[160:163], a[216:219], v[64:67]
    v_lshlrev_b32 v186, 16, v186
    v_and_b32 v189, 0xffff0000, v188
    v_mfma_f32_16x16x32_bf16 v[96:99], a[128:131], a[204:207], v[96:99]
    buffer_load_dwordx4 v139, s[8:11], s38 offen offset:3072  lds
    v_mfma_f32_16x16x32_bf16 v[96:99], a[160:163], a[220:223], v[96:99]
    ds_read_b64_tr_b16 a[110:111], v144 offset:58376
    s_mov_b32 m0, s41
    v_mfma_f32_16x16x32_bf16 v[4:7], a[132:135], a[192:195], v[4:7]
    ds_read_b128 a[64:67], v140 offset:0
    ds_read_b128 a[80:83], v141 offset:0
    v_mfma_f32_16x16x32_bf16 v[4:7], a[164:167], a[208:211], v[4:7]
    v_lshlrev_b32 v188, 16, v188
    v_and_b32 v191, 0xffff0000, v190
    v_mfma_f32_16x16x32_bf16 v[36:39], a[132:135], a[196:199], v[36:39]
    buffer_load_dwordx4 v128, s[4:7], s37 offen offset:0  lds
    v_mfma_f32_16x16x32_bf16 v[36:39], a[164:167], a[212:215], v[36:39]
    ds_read_b128 a[68:71], v140 offset:2048
    ds_read_b128 a[84:87], v141 offset:2048
    v_mfma_f32_16x16x32_bf16 v[68:71], a[132:135], a[200:203], v[68:71]
    v_lshlrev_b32 v190, 16, v190
    v_mul_f32 v176, v176, v174
    v_mfma_f32_16x16x32_bf16 v[68:71], a[164:167], a[216:219], v[68:71]
    buffer_load_dwordx4 v129, s[4:7], s37 offen offset:1024  lds
    v_mfma_f32_16x16x32_bf16 v[100:103], a[132:135], a[204:207], v[100:103]
    ds_read_b128 a[72:75], v140 offset:4096
    ds_read_b128 a[88:91], v141 offset:4096
    v_mfma_f32_16x16x32_bf16 v[100:103], a[164:167], a[220:223], v[100:103]
    v_mul_f32 v184, v184, v175
    v_mul_f32 v177, v177, v174
    v_mfma_f32_16x16x32_bf16 v[8:11], a[136:139], a[192:195], v[8:11]
    buffer_load_dwordx4 v130, s[4:7], s37 offen offset:2048  lds
    v_mfma_f32_16x16x32_bf16 v[8:11], a[168:171], a[208:211], v[8:11]
    ds_read_b128 a[76:79], v140 offset:6144
    ds_read_b128 a[92:95], v141 offset:6144
    v_mfma_f32_16x16x32_bf16 v[40:43], a[136:139], a[196:199], v[40:43]
    v_mul_f32 v185, v185, v175
    v_mul_f32 v178, v178, v174
    v_mfma_f32_16x16x32_bf16 v[40:43], a[168:171], a[212:215], v[40:43]
    buffer_load_dwordx4 v131, s[4:7], s37 offen offset:3072  lds
    v_mfma_f32_16x16x32_bf16 v[72:75], a[136:139], a[200:203], v[72:75]
    ds_read_b64_tr_b16 a[0:1], v220 offset:49152
    s_add_u32 m0, s41, 4096
    v_mfma_f32_16x16x32_bf16 v[72:75], a[168:171], a[216:219], v[72:75]
    ds_read_b64_tr_b16 a[2:3], v220 offset:50176
    ds_read_b64_tr_b16 a[32:33], v220 offset:57344
    v_mfma_f32_16x16x32_bf16 v[104:107], a[136:139], a[204:207], v[104:107]
    v_mul_f32 v186, v186, v175
    v_mul_f32 v179, v179, v174
    v_mfma_f32_16x16x32_bf16 v[104:107], a[168:171], a[220:223], v[104:107]
    buffer_load_dwordx4 v132, s[4:7], s37 offen offset:0  lds
    v_mfma_f32_16x16x32_bf16 v[12:15], a[140:143], a[192:195], v[12:15]
    ds_read_b64_tr_b16 a[34:35], v220 offset:58368
    ds_read_b64_tr_b16 a[4:5], v220 offset:49160
    v_mfma_f32_16x16x32_bf16 v[12:15], a[172:175], a[208:211], v[12:15]
    v_mul_f32 v187, v187, v175
    v_mul_f32 v180, v180, v174
    v_mfma_f32_16x16x32_bf16 v[44:47], a[140:143], a[196:199], v[44:47]
    buffer_load_dwordx4 v133, s[4:7], s37 offen offset:1024  lds
    v_mfma_f32_16x16x32_bf16 v[44:47], a[172:175], a[212:215], v[44:47]
    s_branch L_io2
    .p2align 12
L_iw2:
    s_branch L_iwr6
L_io2:
    ds_read_b64_tr_b16 a[6:7], v220 offset:50184
    ds_read_b64_tr_b16 a[36:37], v220 offset:57352
    v_mfma_f32_16x16x32_bf16 v[76:79], a[140:143], a[200:203], v[76:79]
    v_mul_f32 v188, v188, v175
    v_mul_f32 v181, v181, v174
    v_mfma_f32_16x16x32_bf16 v[76:79], a[172:175], a[216:219], v[76:79]
    buffer_load_dwordx4 v134, s[4:7], s37 offen offset:2048  lds
    v_mfma_f32_16x16x32_bf16 v[108:111], a[140:143], a[204:207], v[108:111]
    ds_read_b64_tr_b16 a[38:39], v220 offset:58376
    ds_read_b64_tr_b16 a[8:9], v221 offset:49152
    v_mfma_f32_16x16x32_bf16 v[108:111], a[172:175], a[220:223], v[108:111]
    v_mul_f32 v189, v189, v175
    v_mul_f32 v182, v182, v174
    v_mfma_f32_16x16x32_bf16 v[16:19], a[144:147], a[192:195], v[16:19]
    buffer_load_dwordx4 v135, s[4:7], s37 offen offset:3072  lds
    v_mfma_f32_16x16x32_bf16 v[16:19], a[176:179], a[208:211], v[16:19]
    ds_read_b64_tr_b16 a[10:11], v221 offset:50176
    ds_read_b64_tr_b16 a[40:41], v221 offset:57344
    v_mfma_f32_16x16x32_bf16 v[48:51], a[144:147], a[196:199], v[48:51]
    v_mul_f32 v190, v190, v175
    v_mul_f32 v183, v183, v174
    v_mfma_f32_16x16x32_bf16 v[48:51], a[176:179], a[212:215], v[48:51]
    ds_read_b64_tr_b16 a[42:43], v221 offset:58368
    ds_read_b64_tr_b16 a[12:13], v221 offset:49160
    v_mfma_f32_16x16x32_bf16 v[80:83], a[144:147], a[200:203], v[80:83]
    v_mul_f32 v191, v191, v175
    v_cvt_pk_bf16_f32 v176, v176, v177
    v_mfma_f32_16x16x32_bf16 v[80:83], a[176:179], a[216:219], v[80:83]
    ds_read_b64_tr_b16 a[14:15], v221 offset:50184
    ds_read_b64_tr_b16 a[44:45], v221 offset:57352
    v_mfma_f32_16x16x32_bf16 v[112:115], a[144:147], a[204:207], v[112:115]
    v_cvt_pk_bf16_f32 v178, v178, v179
    v_cvt_pk_bf16_f32 v180, v180, v181
    v_mfma_f32_16x16x32_bf16 v[112:115], a[176:179], a[220:223], v[112:115]
    ds_read_b64_tr_b16 a[46:47], v221 offset:58376
    ds_read_b64_tr_b16 a[16:17], v222 offset:49152
    v_mfma_f32_16x16x32_bf16 v[20:23], a[148:151], a[192:195], v[20:23]
    v_cvt_pk_bf16_f32 v182, v182, v183
    v_and_b32 v177, 0xffff0000, v176
    v_mfma_f32_16x16x32_bf16 v[20:23], a[180:183], a[208:211], v[20:23]
    ds_read_b64_tr_b16 a[18:19], v222 offset:50176
    ds_read_b64_tr_b16 a[48:49], v222 offset:57344
    v_mfma_f32_16x16x32_bf16 v[52:55], a[148:151], a[196:199], v[52:55]
    v_lshlrev_b32 v176, 16, v176
    v_and_b32 v179, 0xffff0000, v178
    v_mfma_f32_16x16x32_bf16 v[52:55], a[180:183], a[212:215], v[52:55]
    ds_read_b64_tr_b16 a[50:51], v222 offset:58368
    ds_read_b64_tr_b16 a[20:21], v222 offset:49160
    v_mfma_f32_16x16x32_bf16 v[84:87], a[148:151], a[200:203], v[84:87]
    v_lshlrev_b32 v178, 16, v178
    v_and_b32 v181, 0xffff0000, v180
    v_mfma_f32_16x16x32_bf16 v[84:87], a[180:183], a[216:219], v[84:87]
    ds_read_b64_tr_b16 a[22:23], v222 offset:50184
    ds_read_b64_tr_b16 a[52:53], v222 offset:57352
    v_mfma_f32_16x16x32_bf16 v[116:119], a[148:151], a[204:207], v[116:119]
    v_lshlrev_b32 v180, 16, v180
    v_and_b32 v183, 0xffff0000, v182
    v_mfma_f32_16x16x32_bf16 v[116:119], a[180:183], a[220:223], v[116:119]
    ds_read_b64_tr_b16 a[54:55], v222 offset:58376
    ds_read_b64_tr_b16 a[24:25], v223 offset:49152
    v_mfma_f32_16x16x32_bf16 v[24:27], a[152:155], a[192:195], v[24:27]
    v_lshlrev_b32 v182, 16, v182
    v_cvt_pk_bf16_f32 v184, v184, v185
    v_mfma_f32_16x16x32_bf16 v[24:27], a[184:187], a[208:211], v[24:27]
    ds_read_b64_tr_b16 a[26:27], v223 offset:50176
    ds_read_b64_tr_b16 a[56:57], v223 offset:57344
    v_mfma_f32_16x16x32_bf16 v[56:59], a[152:155], a[196:199], v[56:59]
    v_cvt_pk_bf16_f32 v186, v186, v187
    v_cvt_pk_bf16_f32 v188, v188, v189
    v_mfma_f32_16x16x32_bf16 v[56:59], a[184:187], a[212:215], v[56:59]
    ds_read_b64_tr_b16 a[58:59], v223 offset:58368
    ds_read_b64_tr_b16 a[28:29], v223 offset:49160
    v_mfma_f32_16x16x32_bf16 v[88:91], a[152:155], a[200:203], v[88:91]
    v_cvt_pk_bf16_f32 v190, v190, v191
    v_and_b32 v185, 0xffff0000, v184
    v_mfma_f32_16x16x32_bf16 v[88:91], a[184:187], a[216:219], v[88:91]
    ds_read_b64_tr_b16 a[30:31], v223 offset:50184
    ds_read_b64_tr_b16 a[60:61], v223 offset:57352
    v_mfma_f32_16x16x32_bf16 v[120:123], a[152:155], a[204:207], v[120:123]
    v_lshlrev_b32 v184, 16, v184
    v_and_b32 v187, 0xffff0000, v186
    v_mfma_f32_16x16x32_bf16 v[120:123], a[184:187], a[220:223], v[120:123]
    ds_read_b64_tr_b16 a[62:63], v223 offset:58376
    v_mfma_f32_16x16x32_bf16 v[28:31], a[156:159], a[192:195], v[28:31]
    v_lshlrev_b32 v186, 16, v186
    v_and_b32 v189, 0xffff0000, v188
    v_mfma_f32_16x16x32_bf16 v[28:31], a[188:191], a[208:211], v[28:31]
    v_lshlrev_b32 v188, 16, v188
    v_and_b32 v191, 0xffff0000, v190
    v_mfma_f32_16x16x32_bf16 v[60:63], a[156:159], a[196:199], v[60:63]
    v_lshlrev_b32 v190, 16, v190
    v_mul_f32 v208, v176, v192
    v_mfma_f32_16x16x32_bf16 v[60:63], a[188:191], a[212:215], v[60:63]
    v_mul_f32 v209, v184, v192
    v_fmac_f32 v208, v177, v193
    v_mfma_f32_16x16x32_bf16 v[92:95], a[156:159], a[200:203], v[92:95]
    v_fmac_f32 v209, v185, v193
    v_fmac_f32 v208, v178, v194
    v_mfma_f32_16x16x32_bf16 v[92:95], a[188:191], a[216:219], v[92:95]
    v_fmac_f32 v209, v186, v194
    v_fmac_f32 v208, v179, v195
    v_mfma_f32_16x16x32_bf16 v[124:127], a[156:159], a[204:207], v[124:127]
    v_fmac_f32 v209, v187, v195
    v_fmac_f32 v208, v180, v196
    v_mfma_f32_16x16x32_bf16 v[124:127], a[188:191], a[220:223], v[124:127]
    v_fmac_f32 v209, v188, v196
    v_fmac_f32 v208, v181, v197
    s_waitcnt vmcnt(12) lgkmcnt(0)
    s_barrier
    v_mfma_f32_16x16x32_bf16 v[148:151], a[96:99], v[216:219], v[148:151]
    ds_read_b64_tr_b16 a[224:225], v144 offset:16384
    s_mov_b32 s32, 0
    v_mfma_f32_16x16x32_bf16 v[148:151], a[104:107], v[216:219], v[148:151]
    ds_read_b64_tr_b16 a[226:227], v144 offset:17408
    s_mov_b32 m0, s24
    v_mfma_f32_16x16x32_bf16 v[152:155], a[100:103], v[216:219], v[152:155]
    buffer_load_dwordx4 v232, s[12:15], s32 offen offset:0  lds
    v_mfma_f32_16x16x32_bf16 v[152:155], a[108:111], v[216:219], v[152:155]
    ds_read_b64_tr_b16 a[228:229], v144 offset:16392
    ds_read_b64_tr_b16 a[230:231], v144 offset:17416
    v_mfma_f32_16x16x32_bf16 v[0:3], a[0:3], a[64:67], v[0:3]
    v_fmac_f32 v209, v189, v197
    v_fmac_f32 v208, v182, v198
    v_mfma_f32_16x16x32_bf16 v[0:3], a[32:35], a[80:83], v[0:3]
    buffer_load_dwordx4 v232, s[12:15], s32 offen offset:1024  lds
    v_mfma_f32_16x16x32_bf16 v[32:35], a[0:3], a[68:71], v[32:35]
    ds_read_b64_tr_b16 a[232:233], v144 offset:24576
    ds_read_b64_tr_b16 a[234:235], v144 offset:25600
    v_mfma_f32_16x16x32_bf16 v[32:35], a[32:35], a[84:87], v[32:35]
    v_fmac_f32 v209, v190, v198
    v_fmac_f32 v208, v183, v199
    v_mfma_f32_16x16x32_bf16 v[64:67], a[0:3], a[72:75], v[64:67]
    buffer_load_dwordx4 v233, s[12:15], s32 offen offset:2048  lds
    v_mfma_f32_16x16x32_bf16 v[64:67], a[32:35], a[88:91], v[64:67]
    ds_read_b64_tr_b16 a[236:237], v144 offset:24584
    ds_read_b64_tr_b16 a[238:239], v144 offset:25608
    v_mfma_f32_16x16x32_bf16 v[96:99], a[0:3], a[76:79], v[96:99]
    v_fmac_f32 v209, v191, v199
    v_add_f32_dpp v208, v208, v208 row_ror:8 row_mask:0xf bank_mask:0xf
    v_mfma_f32_16x16x32_bf16 v[96:99], a[32:35], a[92:95], v[96:99]
    buffer_load_dwordx4 v233, s[12:15], s32 offen offset:3072  lds
    v_mfma_f32_16x16x32_bf16 v[4:7], a[4:7], a[64:67], v[4:7]
    ds_read_b128 a[192:195], v140 offset:32768
    s_mov_b32 s32, 16384
    v_mfma_f32_16x16x32_bf16 v[4:7], a[36:39], a[80:83], v[4:7]
    ds_read_b128 a[208:211], v141 offset:32768
    s_mov_b32 m0, s25
    v_mfma_f32_16x16x32_bf16 v[36:39], a[4:7], a[68:71], v[36:39]
    ds_read_b128 a[196:199], v140 offset:34816
    ds_read_b128 a[212:215], v141 offset:34816
    v_mfma_f32_16x16x32_bf16 v[36:39], a[36:39], a[84:87], v[36:39]
    v_add_f32_dpp v209, v209, v209 row_ror:8 row_mask:0xf bank_mask:0xf
    v_add_f32_dpp v208, v208, v208 row_ror:4 row_mask:0xf bank_mask:0xf
    v_mfma_f32_16x16x32_bf16 v[68:71], a[4:7], a[72:75], v[68:71]
    buffer_load_dwordx4 v232, s[12:15], s32 offen offset:0  lds
    v_mfma_f32_16x16x32_bf16 v[68:71], a[36:39], a[88:91], v[68:71]
    ds_read_b128 a[200:203], v140 offset:36864
    ds_read_b128 a[216:219], v141 offset:36864
    v_mfma_f32_16x16x32_bf16 v[100:103], a[4:7], a[76:79], v[100:103]
    v_add_f32_dpp v209, v209, v209 row_ror:4 row_mask:0xf bank_mask:0xf
    v_add_f32_dpp v208, v208, v208 row_ror:2 row_mask:0xf bank_mask:0xf
    v_mfma_f32_16x16x32_bf16 v[100:103], a[36:39], a[92:95], v[100:103]
    buffer_load_dwordx4 v232, s[12:15], s32 offen offset:1024  lds
    v_mfma_f32_16x16x32_bf16 v[8:11], a[8:11], a[64:67], v[8:11]
    ds_read_b128 a[204:207], v140 offset:38912
    ds_read_b128 a[220:223], v141 offset:38912
    v_mfma_f32_16x16x32_bf16 v[8:11], a[40:43], a[80:83], v[8:11]
    v_add_f32_dpp v209, v209, v209 row_ror:2 row_mask:0xf bank_mask:0xf
    v_add_f32_dpp v208, v208, v208 row_ror:1 row_mask:0xf bank_mask:0xf
    v_mfma_f32_16x16x32_bf16 v[40:43], a[8:11], a[68:71], v[40:43]
    buffer_load_dwordx4 v233, s[12:15], s32 offen offset:2048  lds
    v_mfma_f32_16x16x32_bf16 v[40:43], a[40:43], a[84:87], v[40:43]
    ds_read_b64_tr_b16 a[128:129], v220 offset:16384
    ds_read_b64_tr_b16 a[130:131], v220 offset:17408
    v_mfma_f32_16x16x32_bf16 v[72:75], a[8:11], a[72:75], v[72:75]
    v_add_f32_dpp v209, v209, v209 row_ror:1 row_mask:0xf bank_mask:0xf
    v_mov_b32 v210, v208
    v_mfma_f32_16x16x32_bf16 v[72:75], a[40:43], a[88:91], v[72:75]
    buffer_load_dwordx4 v233, s[12:15], s32 offen offset:3072  lds
    v_mfma_f32_16x16x32_bf16 v[104:107], a[8:11], a[76:79], v[104:107]
    ds_read_b64_tr_b16 a[160:161], v220 offset:24576
    ds_read_b64_tr_b16 a[162:163], v220 offset:25600
    v_mfma_f32_16x16x32_bf16 v[104:107], a[40:43], a[92:95], v[104:107]
    v_mov_b32 v211, v209
    v_permlane16_swap_b32 v210, v208
    v_mfma_f32_16x16x32_bf16 v[12:15], a[12:15], a[64:67], v[12:15]
    ds_read_b64_tr_b16 a[132:133], v220 offset:16392
    ds_read_b64_tr_b16 a[134:135], v220 offset:17416
    v_mfma_f32_16x16x32_bf16 v[12:15], a[44:47], a[80:83], v[12:15]
    v_permlane16_swap_b32 v211, v209
    v_add_f32 v208, v208, v210
    v_mfma_f32_16x16x32_bf16 v[44:47], a[12:15], a[68:71], v[44:47]
    ds_read_b64_tr_b16 a[164:165], v220 offset:24584
    ds_read_b64_tr_b16 a[166:167], v220 offset:25608
    v_mfma_f32_16x16x32_bf16 v[44:47], a[44:47], a[84:87], v[44:47]
    v_add_f32 v209, v209, v211
    v_mov_b32 v210, v208
    v_mfma_f32_16x16x32_bf16 v[76:79], a[12:15], a[72:75], v[76:79]
    ds_read_b64_tr_b16 a[136:137], v221 offset:16384
    ds_read_b64_tr_b16 a[138:139], v221 offset:17408
    v_mfma_f32_16x16x32_bf16 v[76:79], a[44:47], a[88:91], v[76:79]
    v_mov_b32 v211, v209
    v_permlane32_swap_b32 v210, v208
    v_mfma_f32_16x16x32_bf16 v[108:111], a[12:15], a[76:79], v[108:111]
    ds_read_b64_tr_b16 a[168:169], v221 offset:24576
    ds_read_b64_tr_b16 a[170:171], v221 offset:25600
    v_mfma_f32_16x16x32_bf16 v[108:111], a[44:47], a[92:95], v[108:111]
    v_permlane32_swap_b32 v211, v209
    v_add_f32 v208, v208, v210
    v_mfma_f32_16x16x32_bf16 v[16:19], a[16:19], a[64:67], v[16:19]
    ds_read_b64_tr_b16 a[140:141], v221 offset:16392
    ds_read_b64_tr_b16 a[142:143], v221 offset:17416
    v_mfma_f32_16x16x32_bf16 v[16:19], a[48:51], a[80:83], v[16:19]
    v_add_f32 v209, v209, v211
    v_cvt_pk_bf16_f32 v208, v208, v209
    v_mfma_f32_16x16x32_bf16 v[48:51], a[16:19], a[68:71], v[48:51]
    ds_read_b64_tr_b16 a[172:173], v221 offset:24584
    ds_read_b64_tr_b16 a[174:175], v221 offset:25608
    v_mfma_f32_16x16x32_bf16 v[48:51], a[48:51], a[84:87], v[48:51]
    v_and_b32 v209, 0xffff0000, v208
    v_lshlrev_b32 v208, 16, v208
    v_mfma_f32_16x16x32_bf16 v[80:83], a[16:19], a[72:75], v[80:83]
    ds_read_b64_tr_b16 a[144:145], v222 offset:16384
    ds_read_b64_tr_b16 a[146:147], v222 offset:17408
    v_mfma_f32_16x16x32_bf16 v[80:83], a[48:51], a[88:91], v[80:83]
    v_ashrrev_i32 v210, 31, v208
    v_ashrrev_i32 v211, 31, v209
    v_mfma_f32_16x16x32_bf16 v[112:115], a[16:19], a[76:79], v[112:115]
    ds_read_b64_tr_b16 a[176:177], v222 offset:24576
    ds_read_b64_tr_b16 a[178:179], v222 offset:25600
    v_mfma_f32_16x16x32_bf16 v[112:115], a[48:51], a[92:95], v[112:115]
    v_or_b32 v210, 0x80000000, v210
    v_or_b32 v211, 0x80000000, v211
    v_mfma_f32_16x16x32_bf16 v[20:23], a[20:23], a[64:67], v[20:23]
    ds_read_b64_tr_b16 a[148:149], v222 offset:16392
    ds_read_b64_tr_b16 a[150:151], v222 offset:17416
    v_mfma_f32_16x16x32_bf16 v[20:23], a[52:55], a[80:83], v[20:23]
    v_xor_b32 v208, v208, v210
    v_xor_b32 v209, v209, v211
    v_mfma_f32_16x16x32_bf16 v[52:55], a[20:23], a[68:71], v[52:55]
    ds_read_b64_tr_b16 a[180:181], v222 offset:24584
    ds_read_b64_tr_b16 a[182:183], v222 offset:25608
    v_mfma_f32_16x16x32_bf16 v[52:55], a[52:55], a[84:87], v[52:55]
    v_and_b32 v208, 0xffff0000, v208
    v_and_b32 v209, 0xffff0000, v209
    v_mfma_f32_16x16x32_bf16 v[84:87], a[20:23], a[72:75], v[84:87]
    ds_read_b64_tr_b16 a[152:153], v223 offset:16384
    ds_read_b64_tr_b16 a[154:155], v223 offset:17408
    v_mfma_f32_16x16x32_bf16 v[84:87], a[52:55], a[88:91], v[84:87]
    v_mov_b32 v210, s55
    v_mov_b32 v211, s55
    v_mfma_f32_16x16x32_bf16 v[116:119], a[20:23], a[76:79], v[116:119]
    ds_read_b64_tr_b16 a[184:185], v223 offset:24576
    ds_read_b64_tr_b16 a[186:187], v223 offset:25600
    v_mfma_f32_16x16x32_bf16 v[116:119], a[52:55], a[92:95], v[116:119]
    v_sub_u32 v210, 2047, v210
    v_sub_u32 v211, 2046, v211
    v_mfma_f32_16x16x32_bf16 v[24:27], a[24:27], a[64:67], v[24:27]
    ds_read_b64_tr_b16 a[156:157], v223 offset:16392
    ds_read_b64_tr_b16 a[158:159], v223 offset:17416
    v_mfma_f32_16x16x32_bf16 v[24:27], a[56:59], a[80:83], v[24:27]
    v_or_b32 v208, v208, v210
    v_or_b32 v209, v209, v211
    v_mfma_f32_16x16x32_bf16 v[56:59], a[24:27], a[68:71], v[56:59]
    ds_read_b64_tr_b16 a[188:189], v223 offset:24584
    ds_read_b64_tr_b16 a[190:191], v223 offset:25608
    v_mfma_f32_16x16x32_bf16 v[56:59], a[56:59], a[84:87], v[56:59]
    v_max_u32 v208, v208, v209
    v_mov_b32 v210, s3
    v_mfma_f32_16x16x32_bf16 v[88:91], a[24:27], a[72:75], v[88:91]
    v_lshlrev_b32 v210, 2, v210
    v_add_u32 v210, 115216, v210
    v_mfma_f32_16x16x32_bf16 v[88:91], a[56:59], a[88:91], v[88:91]
    v_mfma_f32_16x16x32_bf16 v[120:123], a[24:27], a[76:79], v[120:123]
    v_mfma_f32_16x16x32_bf16 v[120:123], a[56:59], a[92:95], v[120:123]
    v_mfma_f32_16x16x32_bf16 v[28:31], a[28:31], a[64:67], v[28:31]
    v_mfma_f32_16x16x32_bf16 v[28:31], a[60:63], a[80:83], v[28:31]
    v_mfma_f32_16x16x32_bf16 v[60:63], a[28:31], a[68:71], v[60:63]
    v_mfma_f32_16x16x32_bf16 v[60:63], a[60:63], a[84:87], v[60:63]
    v_mfma_f32_16x16x32_bf16 v[92:95], a[28:31], a[72:75], v[92:95]
    v_mfma_f32_16x16x32_bf16 v[92:95], a[60:63], a[88:91], v[92:95]
    v_mfma_f32_16x16x32_bf16 v[124:127], a[28:31], a[76:79], v[124:127]
    v_mfma_f32_16x16x32_bf16 v[124:127], a[60:63], a[92:95], v[124:127]
    s_waitcnt vmcnt(8) lgkmcnt(0)
    s_barrier
    v_mfma_f32_16x16x32_bf16 v[148:151], a[224:227], v[216:219], v[148:151]
    buffer_load_dwordx2 v[244:245], v156, s[20:23], s54 offen offset:0 sc1
    v_mfma_f32_16x16x32_bf16 v[148:151], a[232:235], v[216:219], v[148:151]
    ds_read_b64_tr_b16 a[96:97], v144 offset:32768
    ds_read_b64_tr_b16 a[98:99], v144 offset:33792
    v_mfma_f32_16x16x32_bf16 v[152:155], a[228:231], v[216:219], v[152:155]
    s_cmp_lt_u32 s75, 172
    s_cselect_b32 s78, 1409024, 0
    v_mfma_f32_16x16x32_bf16 v[152:155], a[236:239], v[216:219], v[152:155]
    buffer_load_dwordx2 v[246:247], v156, s[20:23], s54 offen offset:128 sc1
    v_mfma_f32_16x16x32_bf16 v[0:3], a[128:131], a[192:195], v[0:3]
    ds_read_b64_tr_b16 a[100:101], v144 offset:32776
    ds_read_b64_tr_b16 a[102:103], v144 offset:33800
    v_mfma_f32_16x16x32_bf16 v[0:3], a[160:163], a[208:211], v[0:3]
    s_cselect_b32 s86, 1409024, 0
    s_mov_b32 s76, s62
    v_mfma_f32_16x16x32_bf16 v[32:35], a[128:131], a[196:199], v[32:35]
    buffer_load_dwordx2 v[248:249], v156, s[20:23], s54 offen offset:256 sc1
    v_mfma_f32_16x16x32_bf16 v[32:35], a[160:163], a[212:215], v[32:35]
    ds_read_b64_tr_b16 a[104:105], v144 offset:40960
    ds_read_b64_tr_b16 a[106:107], v144 offset:41984
    v_mfma_f32_16x16x32_bf16 v[64:67], a[128:131], a[200:203], v[64:67]
    s_mov_b32 s77, s63
    s_mov_b32 s79, 0x20000
    v_mfma_f32_16x16x32_bf16 v[64:67], a[160:163], a[216:219], v[64:67]
    buffer_load_dwordx2 v[250:251], v156, s[20:23], s54 offen offset:384 sc1
    v_mfma_f32_16x16x32_bf16 v[96:99], a[128:131], a[204:207], v[96:99]
    ds_read_b64_tr_b16 a[108:109], v144 offset:40968
    s_mov_b32 s33, 0
    v_mfma_f32_16x16x32_bf16 v[96:99], a[160:163], a[220:223], v[96:99]
    ds_read_b64_tr_b16 a[110:111], v144 offset:41992
    s_mov_b32 m0, s28
    v_mfma_f32_16x16x32_bf16 v[4:7], a[132:135], a[192:195], v[4:7]
    ds_read_b128 a[64:67], v142 offset:0
    ds_read_b128 a[80:83], v143 offset:0
    v_mfma_f32_16x16x32_bf16 v[4:7], a[164:167], a[208:211], v[4:7]
    s_mov_b32 s84, s66
    s_mov_b32 s85, s67
    v_mfma_f32_16x16x32_bf16 v[36:39], a[132:135], a[196:199], v[36:39]
    buffer_load_dwordx4 v234, s[16:19], s33 offen offset:0  lds
    v_mfma_f32_16x16x32_bf16 v[36:39], a[164:167], a[212:215], v[36:39]
    ds_read_b128 a[68:71], v142 offset:2048
    ds_read_b128 a[84:87], v143 offset:2048
    v_mfma_f32_16x16x32_bf16 v[68:71], a[132:135], a[200:203], v[68:71]
    s_mov_b32 s87, 0x20000
    s_mul_i32 s42, s3, 352256
    v_mfma_f32_16x16x32_bf16 v[68:71], a[164:167], a[216:219], v[68:71]
    buffer_load_dwordx4 v234, s[16:19], s33 offen offset:1024  lds
    v_mfma_f32_16x16x32_bf16 v[100:103], a[132:135], a[204:207], v[100:103]
    ds_read_b128 a[72:75], v142 offset:4096
    ds_read_b128 a[88:91], v143 offset:4096
    v_mfma_f32_16x16x32_bf16 v[100:103], a[164:167], a[220:223], v[100:103]
    s_lshl_b32 s43, s75, 4
    s_add_u32 s80, s42, s43
    v_mfma_f32_16x16x32_bf16 v[8:11], a[136:139], a[192:195], v[8:11]
    buffer_load_dwordx4 v235, s[16:19], s33 offen offset:2048  lds
    v_mfma_f32_16x16x32_bf16 v[8:11], a[168:171], a[208:211], v[8:11]
    ds_read_b128 a[76:79], v142 offset:6144
    ds_read_b128 a[92:95], v143 offset:6144
    v_mfma_f32_16x16x32_bf16 v[40:43], a[136:139], a[196:199], v[40:43]
    s_lshl_b32 s81, s80, 1
    s_add_u32 s81, s81, 176128
    v_mfma_f32_16x16x32_bf16 v[40:43], a[168:171], a[212:215], v[40:43]
    buffer_load_dwordx4 v235, s[16:19], s33 offen offset:3072  lds
    v_mfma_f32_16x16x32_bf16 v[72:75], a[136:139], a[200:203], v[72:75]
    ds_read_b64_tr_b16 a[0:1], v220 offset:32768
    s_mov_b32 s32, 32768
    v_mfma_f32_16x16x32_bf16 v[72:75], a[168:171], a[216:219], v[72:75]
    ds_read_b64_tr_b16 a[2:3], v220 offset:33792
    s_mov_b32 m0, s26
    v_mfma_f32_16x16x32_bf16 v[104:107], a[136:139], a[204:207], v[104:107]
    ds_read_b64_tr_b16 a[32:33], v220 offset:40960
    ds_read_b64_tr_b16 a[34:35], v220 offset:41984
    v_mfma_f32_16x16x32_bf16 v[104:107], a[168:171], a[220:223], v[104:107]
    s_lshl_b32 s40, s75, 13
    s_lshl_b32 s43, s3, 11
    v_mfma_f32_16x16x32_bf16 v[12:15], a[140:143], a[192:195], v[12:15]
    buffer_load_dwordx4 v232, s[12:15], s32 offen offset:0  lds
    v_mfma_f32_16x16x32_bf16 v[12:15], a[172:175], a[208:211], v[12:15]
    ds_read_b64_tr_b16 a[4:5], v220 offset:32776
    ds_read_b64_tr_b16 a[6:7], v220 offset:33800
    v_mfma_f32_16x16x32_bf16 v[44:47], a[140:143], a[196:199], v[44:47]
    s_add_u32 s40, s40, s43
    s_add_u32 s82, s43, 133120
    v_mfma_f32_16x16x32_bf16 v[44:47], a[172:175], a[212:215], v[44:47]
    buffer_load_dwordx4 v232, s[12:15], s32 offen offset:1024  lds
    v_mfma_f32_16x16x32_bf16 v[76:79], a[140:143], a[200:203], v[76:79]
    ds_read_b64_tr_b16 a[36:37], v220 offset:40968
    s_branch L_io3
    .p2align 12
L_iw3:
    s_branch L_iwr6
L_io3:
    ds_read_b64_tr_b16 a[38:39], v220 offset:41992
    v_mfma_f32_16x16x32_bf16 v[76:79], a[172:175], a[216:219], v[76:79]
    s_mov_b32 s83, 1024
    s_mov_b32 s39, s3
    v_mfma_f32_16x16x32_bf16 v[108:111], a[140:143], a[204:207], v[108:111]
    buffer_load_dwordx4 v233, s[12:15], s32 offen offset:2048  lds
    v_mfma_f32_16x16x32_bf16 v[108:111], a[172:175], a[220:223], v[108:111]
    ds_read_b64_tr_b16 a[8:9], v221 offset:32768
    ds_read_b64_tr_b16 a[10:11], v221 offset:33792
    v_mfma_f32_16x16x32_bf16 v[16:19], a[144:147], a[192:195], v[16:19]
    v_mov_b32 v164, 115216
    v_mov_b32 v165, s70
    v_mfma_f32_16x16x32_bf16 v[16:19], a[176:179], a[208:211], v[16:19]
    buffer_load_dwordx4 v233, s[12:15], s32 offen offset:3072  lds
    v_mfma_f32_16x16x32_bf16 v[48:51], a[144:147], a[196:199], v[48:51]
    ds_read_b64_tr_b16 a[40:41], v221 offset:40960
    ds_read_b64_tr_b16 a[42:43], v221 offset:41984
    v_mfma_f32_16x16x32_bf16 v[48:51], a[176:179], a[212:215], v[48:51]
    s_mov_b32 s4, s56
    s_mov_b32 s5, s57
    v_mfma_f32_16x16x32_bf16 v[80:83], a[144:147], a[200:203], v[80:83]
    ds_read_b64_tr_b16 a[12:13], v221 offset:32776
    ds_read_b64_tr_b16 a[14:15], v221 offset:33800
    v_mfma_f32_16x16x32_bf16 v[80:83], a[176:179], a[216:219], v[80:83]
    s_mov_b32 s6, 4194304
    s_mov_b32 s7, 0x20000
    v_mfma_f32_16x16x32_bf16 v[112:115], a[144:147], a[204:207], v[112:115]
    ds_read_b64_tr_b16 a[44:45], v221 offset:40968
    ds_read_b64_tr_b16 a[46:47], v221 offset:41992
    v_mfma_f32_16x16x32_bf16 v[112:115], a[176:179], a[220:223], v[112:115]
    s_lshl_b32 s37, s2, 2
    s_add_u32 s37, s37, s3
    v_mfma_f32_16x16x32_bf16 v[20:23], a[148:151], a[192:195], v[20:23]
    ds_read_b64_tr_b16 a[16:17], v222 offset:32768
    ds_read_b64_tr_b16 a[18:19], v222 offset:33792
    v_mfma_f32_16x16x32_bf16 v[20:23], a[180:183], a[208:211], v[20:23]
    s_lshl_b32 s37, s37, 12
    v_lshlrev_b32 v253, 2, v252
    v_mfma_f32_16x16x32_bf16 v[52:55], a[148:151], a[196:199], v[52:55]
    ds_read_b64_tr_b16 a[48:49], v222 offset:40960
    ds_read_b64_tr_b16 a[50:51], v222 offset:41984
    v_mfma_f32_16x16x32_bf16 v[52:55], a[180:183], a[212:215], v[52:55]
    s_lshr_b32 s58, s2, 3
    s_lshl_b32 s38, s58, 13
    v_mfma_f32_16x16x32_bf16 v[84:87], a[148:151], a[200:203], v[84:87]
    ds_read_b64_tr_b16 a[20:21], v222 offset:32776
    ds_read_b64_tr_b16 a[22:23], v222 offset:33800
    v_mfma_f32_16x16x32_bf16 v[84:87], a[180:183], a[216:219], v[84:87]
    s_lshl_b32 s58, s58, 7
    s_lshl_b32 s38, s38, 2
    v_mfma_f32_16x16x32_bf16 v[116:119], a[148:151], a[204:207], v[116:119]
    ds_read_b64_tr_b16 a[52:53], v222 offset:40968
    ds_read_b64_tr_b16 a[54:55], v222 offset:41992
    v_mfma_f32_16x16x32_bf16 v[116:119], a[180:183], a[220:223], v[116:119]
    s_lshl_b32 s43, s3, 13
    s_add_u32 s38, s38, s43
    v_mfma_f32_16x16x32_bf16 v[24:27], a[152:155], a[192:195], v[24:27]
    ds_read_b64_tr_b16 a[24:25], v223 offset:32768
    ds_read_b64_tr_b16 a[26:27], v223 offset:33792
    v_mfma_f32_16x16x32_bf16 v[24:27], a[184:187], a[208:211], v[24:27]
    s_lshl_b32 s43, s59, 20
    s_add_u32 s38, s38, s43
    v_mfma_f32_16x16x32_bf16 v[56:59], a[152:155], a[196:199], v[56:59]
    ds_read_b64_tr_b16 a[56:57], v223 offset:40960
    ds_read_b64_tr_b16 a[58:59], v223 offset:41984
    v_mfma_f32_16x16x32_bf16 v[56:59], a[184:187], a[212:215], v[56:59]
    ds_read_b64_tr_b16 a[28:29], v223 offset:32776
    ds_read_b64_tr_b16 a[30:31], v223 offset:33800
    v_mfma_f32_16x16x32_bf16 v[88:91], a[152:155], a[200:203], v[88:91]
    ds_read_b64_tr_b16 a[60:61], v223 offset:40968
    ds_read_b64_tr_b16 a[62:63], v223 offset:41992
    v_mfma_f32_16x16x32_bf16 v[88:91], a[184:187], a[216:219], v[88:91]
    s_waitcnt lgkmcnt(15)
    ds_write_b32 v210, v208
    v_mfma_f32_16x16x32_bf16 v[148:151], a[96:99], v[216:219], v[148:151]
    v_mfma_f32_16x16x32_bf16 v[148:151], a[104:107], v[216:219], v[148:151]
    v_mfma_f32_16x16x32_bf16 v[152:155], a[100:103], v[216:219], v[152:155]
    v_mfma_f32_16x16x32_bf16 v[152:155], a[108:111], v[216:219], v[152:155]
    v_mfma_f32_16x16x32_bf16 v[120:123], a[152:155], a[204:207], v[120:123]
    v_mfma_f32_16x16x32_bf16 v[120:123], a[184:187], a[220:223], v[120:123]
    v_mfma_f32_16x16x32_bf16 v[28:31], a[156:159], a[192:195], v[28:31]
    v_mfma_f32_16x16x32_bf16 v[28:31], a[188:191], a[208:211], v[28:31]
    ds_write_b128 v146, v[148:151]
    v_mfma_f32_16x16x32_bf16 v[60:63], a[156:159], a[196:199], v[60:63]
    ds_write_b128 v146, v[152:155] offset:64
    v_mfma_f32_16x16x32_bf16 v[60:63], a[188:191], a[212:215], v[60:63]
    v_mfma_f32_16x16x32_bf16 v[92:95], a[156:159], a[200:203], v[92:95]
    v_mfma_f32_16x16x32_bf16 v[92:95], a[188:191], a[216:219], v[92:95]
    v_mfma_f32_16x16x32_bf16 v[124:127], a[156:159], a[204:207], v[124:127]
    v_mfma_f32_16x16x32_bf16 v[124:127], a[188:191], a[220:223], v[124:127]
    s_waitcnt lgkmcnt(0)
    s_barrier
    v_mfma_f32_16x16x32_bf16 v[0:3], a[0:3], a[64:67], v[0:3]
    ds_read_b128 v[160:163], v164
    v_xor_b32 v220, 128, v224
    v_mfma_f32_16x16x32_bf16 v[0:3], a[32:35], a[80:83], v[0:3]
    ds_read_b128 v[192:195], v147 offset:0
    v_xor_b32 v221, 160, v224
    v_mfma_f32_16x16x32_bf16 v[4:7], a[4:7], a[64:67], v[4:7]
    ds_read_b128 v[196:199], v147 offset:64
    v_xor_b32 v222, 192, v224
    v_mfma_f32_16x16x32_bf16 v[4:7], a[36:39], a[80:83], v[4:7]
    ds_read_b128 v[200:203], v147 offset:128
    v_xor_b32 v223, 224, v224
    v_mfma_f32_16x16x32_bf16 v[8:11], a[8:11], a[64:67], v[8:11]
    ds_read_b128 v[204:207], v147 offset:192
    v_mfma_f32_16x16x32_bf16 v[8:11], a[40:43], a[80:83], v[8:11]
    ds_read_b128 v[208:211], v147 offset:256
    v_mfma_f32_16x16x32_bf16 v[12:15], a[12:15], a[64:67], v[12:15]
    ds_read_b128 v[212:215], v147 offset:320
    s_lshl_b32 s42, s2, 3
    s_add_u32 s42, s42, 16793600
    s_waitcnt lgkmcnt(6)
    v_max3_u32 v160, v160, v161, v162
    v_mfma_f32_16x16x32_bf16 v[12:15], a[44:47], a[80:83], v[12:15]
    ds_read_b128 v[176:179], v147 offset:384
    v_max_u32 v164, v160, v163
    v_mfma_f32_16x16x32_bf16 v[16:19], a[16:19], a[64:67], v[16:19]
    ds_read_b128 v[180:183], v147 offset:448
    v_mfma_f32_16x16x32_bf16 v[16:19], a[48:51], a[80:83], v[16:19]
    buffer_store_dwordx2 v[164:165], v255, s[20:23], s42 offen sc1
    v_mfma_f32_16x16x32_bf16 v[20:23], a[20:23], a[64:67], v[20:23]
    v_mfma_f32_16x16x32_bf16 v[20:23], a[52:55], a[80:83], v[20:23]
    v_mfma_f32_16x16x32_bf16 v[24:27], a[24:27], a[64:67], v[24:27]
    v_mfma_f32_16x16x32_bf16 v[24:27], a[56:59], a[80:83], v[24:27]
    v_mfma_f32_16x16x32_bf16 v[28:31], a[28:31], a[64:67], v[28:31]
    v_mfma_f32_16x16x32_bf16 v[28:31], a[60:63], a[80:83], v[28:31]
    v_mfma_f32_16x16x32_bf16 v[32:35], a[0:3], a[68:71], v[32:35]
    v_mfma_f32_16x16x32_bf16 v[32:35], a[32:35], a[84:87], v[32:35]
    v_mfma_f32_16x16x32_bf16 v[36:39], a[4:7], a[68:71], v[36:39]
    v_mfma_f32_16x16x32_bf16 v[36:39], a[36:39], a[84:87], v[36:39]
    v_mfma_f32_16x16x32_bf16 v[40:43], a[8:11], a[68:71], v[40:43]
    s_waitcnt vmcnt(9) lgkmcnt(0)
    s_barrier
    v_mfma_f32_16x16x32_bf16 v[40:43], a[40:43], a[84:87], v[40:43]
    v_cmp_ne_u32 vcc, s70, v245
    v_cmp_ne_u32 s[42:43], s70, v247
    s_nop 0
    s_or_b64 vcc, vcc, s[42:43]
    v_cmp_ne_u32 s[42:43], s70, v249
    s_nop 0
    s_or_b64 vcc, vcc, s[42:43]
    v_cmp_ne_u32 s[42:43], s70, v251
    s_nop 0
    s_or_b64 vcc, vcc, s[42:43]
    s_cbranch_vccnz L_st_slow
L_st_ok:
    v_mfma_f32_16x16x32_bf16 v[44:47], a[12:15], a[68:71], v[44:47]
    ds_read_b128 a[192:195], v228 offset:0
    v_lshlrev_b32 v245, 16, v244
    v_mfma_f32_16x16x32_bf16 v[44:47], a[44:47], a[84:87], v[44:47]
    s_mov_b32 s33, 16384
    s_mov_b32 m0, s29
    ds_read_b128 a[196:199], v229 offset:0
    v_lshlrev_b32 v247, 16, v246
    s_lshl_b32 s42, s73, 8
    v_mfma_f32_16x16x32_bf16 v[48:51], a[16:19], a[68:71], v[48:51]
    buffer_load_dwordx4 v234, s[16:19], s33 offen offset:0  lds
    s_lshl_b32 s43, s3, 14
    v_mfma_f32_16x16x32_bf16 v[48:51], a[48:51], a[84:87], v[48:51]
    ds_read_b128 a[200:203], v230 offset:0
    v_rcp_f32 v245, v245
    s_add_u32 s42, s42, s43
    v_mfma_f32_16x16x32_bf16 v[52:55], a[20:23], a[68:71], v[52:55]
    ds_read_b128 a[204:207], v231 offset:0
    v_rcp_f32 v247, v247
    s_lshl_b32 s43, s59, 20
    v_mfma_f32_16x16x32_bf16 v[52:55], a[52:55], a[84:87], v[52:55]
    ds_read_b128 a[208:211], v228 offset:1024
    v_and_b32 v244, 0xffff0000, v244
    s_add_u32 s42, s42, s43
    v_mfma_f32_16x16x32_bf16 v[56:59], a[24:27], a[68:71], v[56:59]
    buffer_load_dwordx4 v234, s[16:19], s33 offen offset:1024  lds
    s_sub_u32 s10, 4194304, s42
    v_mfma_f32_16x16x32_bf16 v[56:59], a[56:59], a[84:87], v[56:59]
    ds_read_b128 a[212:215], v229 offset:1024
    v_and_b32 v246, 0xffff0000, v246
    s_add_u32 s8, s56, s42
    s_addc_u32 s9, s57, 0
    s_mov_b32 s11, 0x20000
    v_mfma_f32_16x16x32_bf16 v[60:63], a[28:31], a[68:71], v[60:63]
    ds_read_b128 a[216:219], v230 offset:1024
    v_mul_f32 v245, 0x3e0293ee, v245
    v_mfma_f32_16x16x32_bf16 v[60:63], a[60:63], a[84:87], v[60:63]
    ds_read_b128 a[220:223], v231 offset:1024
    v_mul_f32 v247, 0x3e0293ee, v247
    v_mfma_f32_16x16x32_bf16 v[64:67], a[0:3], a[72:75], v[64:67]
    ds_read_b128 a[224:227], v228 offset:8192
    v_lshlrev_b32 v249, 16, v248
    v_mfma_f32_16x16x32_bf16 v[64:67], a[32:35], a[88:91], v[64:67]
    buffer_load_dwordx4 v235, s[16:19], s33 offen offset:2048  lds
    v_mfma_f32_16x16x32_bf16 v[68:71], a[4:7], a[72:75], v[68:71]
    ds_read_b128 a[228:231], v229 offset:8192
    v_lshlrev_b32 v251, 16, v250
    v_pk_fma_f32 v[0:1], v[244:245], v[192:193], v[0:1] op_sel_hi:[0,1,1] neg_lo:[1,0,0] neg_hi:[1,0,0]
    v_pk_fma_f32 v[2:3], v[244:245], v[194:195], v[2:3] op_sel_hi:[0,1,1] neg_lo:[1,0,0] neg_hi:[1,0,0]
    v_pk_fma_f32 v[4:5], v[244:245], v[196:197], v[4:5] op_sel_hi:[0,1,1] neg_lo:[1,0,0] neg_hi:[1,0,0]
    v_pk_fma_f32 v[6:7], v[244:245], v[198:199], v[6:7] op_sel_hi:[0,1,1] neg_lo:[1,0,0] neg_hi:[1,0,0]
    v_pk_fma_f32 v[8:9], v[244:245], v[200:201], v[8:9] op_sel_hi:[0,1,1] neg_lo:[1,0,0] neg_hi:[1,0,0]
    v_pk_fma_f32 v[10:11], v[244:245], v[202:203], v[10:11] op_sel_hi:[0,1,1] neg_lo:[1,0,0] neg_hi:[1,0,0]
    v_pk_fma_f32 v[12:13], v[244:245], v[204:205], v[12:13] op_sel_hi:[0,1,1] neg_lo:[1,0,0] neg_hi:[1,0,0]
    v_pk_fma_f32 v[14:15], v[244:245], v[206:207], v[14:15] op_sel_hi:[0,1,1] neg_lo:[1,0,0] neg_hi:[1,0,0]
    v_pk_fma_f32 v[16:17], v[244:245], v[208:209], v[16:17] op_sel_hi:[0,1,1] neg_lo:[1,0,0] neg_hi:[1,0,0]
    v_pk_fma_f32 v[18:19], v[244:245], v[210:211], v[18:19] op_sel_hi:[0,1,1] neg_lo:[1,0,0] neg_hi:[1,0,0]
    v_pk_fma_f32 v[20:21], v[244:245], v[212:213], v[20:21] op_sel_hi:[0,1,1] neg_lo:[1,0,0] neg_hi:[1,0,0]
    v_pk_fma_f32 v[22:23], v[244:245], v[214:215], v[22:23] op_sel_hi:[0,1,1] neg_lo:[1,0,0] neg_hi:[1,0,0]
    v_pk_fma_f32 v[24:25], v[244:245], v[176:177], v[24:25] op_sel_hi:[0,1,1] neg_lo:[1,0,0] neg_hi:[1,0,0]
    v_pk_fma_f32 v[26:27], v[244:245], v[178:179], v[26:27] op_sel_hi:[0,1,1] neg_lo:[1,0,0] neg_hi:[1,0,0]
    v_pk_fma_f32 v[28:29], v[244:245], v[180:181], v[28:29] op_sel_hi:[0,1,1] neg_lo:[1,0,0] neg_hi:[1,0,0]
    v_pk_fma_f32 v[30:31], v[244:245], v[182:183], v[30:31] op_sel_hi:[0,1,1] neg_lo:[1,0,0] neg_hi:[1,0,0]
    v_pk_mul_f32 v[0:1], v[0:1], v[244:245] op_sel:[0,1] op_sel_hi:[1,1]
    v_pk_mul_f32 v[2:3], v[2:3], v[244:245] op_sel:[0,1] op_sel_hi:[1,1]
    v_pk_mul_f32 v[4:5], v[4:5], v[244:245] op_sel:[0,1] op_sel_hi:[1,1]
    v_pk_mul_f32 v[6:7], v[6:7], v[244:245] op_sel:[0,1] op_sel_hi:[1,1]
    v_pk_mul_f32 v[8:9], v[8:9], v[244:245] op_sel:[0,1] op_sel_hi:[1,1]
    v_pk_mul_f32 v[10:11], v[10:11], v[244:245] op_sel:[0,1] op_sel_hi:[1,1]
    v_pk_mul_f32 v[12:13], v[12:13], v[244:245] op_sel:[0,1] op_sel_hi:[1,1]
    v_pk_mul_f32 v[14:15], v[14:15], v[244:245] op_sel:[0,1] op_sel_hi:[1,1]
    v_pk_mul_f32 v[16:17], v[16:17], v[244:245] op_sel:[0,1] op_sel_hi:[1,1]
    v_pk_mul_f32 v[18:19], v[18:19], v[244:245] op_sel:[0,1] op_sel_hi:[1,1]
    v_pk_mul_f32 v[20:21], v[20:21], v[244:245] op_sel:[0,1] op_sel_hi:[1,1]
    v_pk_mul_f32 v[22:23], v[22:23], v[244:245] op_sel:[0,1] op_sel_hi:[1,1]
    v_pk_mul_f32 v[24:25], v[24:25], v[244:245] op_sel:[0,1] op_sel_hi:[1,1]
    v_pk_mul_f32 v[26:27], v[26:27], v[244:245] op_sel:[0,1] op_sel_hi:[1,1]
    v_pk_mul_f32 v[28:29], v[28:29], v[244:245] op_sel:[0,1] op_sel_hi:[1,1]
    v_pk_mul_f32 v[30:31], v[30:31], v[244:245] op_sel:[0,1] op_sel_hi:[1,1]
    v_pk_fma_f32 v[32:33], v[246:247], v[192:193], v[32:33] op_sel_hi:[0,1,1] neg_lo:[1,0,0] neg_hi:[1,0,0]
    v_pk_fma_f32 v[34:35], v[246:247], v[194:195], v[34:35] op_sel_hi:[0,1,1] neg_lo:[1,0,0] neg_hi:[1,0,0]
    v_pk_fma_f32 v[36:37], v[246:247], v[196:197], v[36:37] op_sel_hi:[0,1,1] neg_lo:[1,0,0] neg_hi:[1,0,0]
    v_pk_fma_f32 v[38:39], v[246:247], v[198:199], v[38:39] op_sel_hi:[0,1,1] neg_lo:[1,0,0] neg_hi:[1,0,0]
    v_pk_fma_f32 v[40:41], v[246:247], v[200:201], v[40:41] op_sel_hi:[0,1,1] neg_lo:[1,0,0] neg_hi:[1,0,0]
    v_pk_fma_f32 v[42:43], v[246:247], v[202:203], v[42:43] op_sel_hi:[0,1,1] neg_lo:[1,0,0] neg_hi:[1,0,0]
    v_pk_fma_f32 v[44:45], v[246:247], v[204:205], v[44:45] op_sel_hi:[0,1,1] neg_lo:[1,0,0] neg_hi:[1,0,0]
    v_pk_fma_f32 v[46:47], v[246:247], v[206:207], v[46:47] op_sel_hi:[0,1,1] neg_lo:[1,0,0] neg_hi:[1,0,0]
    v_pk_fma_f32 v[48:49], v[246:247], v[208:209], v[48:49] op_sel_hi:[0,1,1] neg_lo:[1,0,0] neg_hi:[1,0,0]
    v_pk_fma_f32 v[50:51], v[246:247], v[210:211], v[50:51] op_sel_hi:[0,1,1] neg_lo:[1,0,0] neg_hi:[1,0,0]
    v_pk_fma_f32 v[52:53], v[246:247], v[212:213], v[52:53] op_sel_hi:[0,1,1] neg_lo:[1,0,0] neg_hi:[1,0,0]
    v_pk_fma_f32 v[54:55], v[246:247], v[214:215], v[54:55] op_sel_hi:[0,1,1] neg_lo:[1,0,0] neg_hi:[1,0,0]
    v_pk_fma_f32 v[56:57], v[246:247], v[176:177], v[56:57] op_sel_hi:[0,1,1] neg_lo:[1,0,0] neg_hi:[1,0,0]
    v_pk_fma_f32 v[58:59], v[246:247], v[178:179], v[58:59] op_sel_hi:[0,1,1] neg_lo:[1,0,0] neg_hi:[1,0,0]
    v_pk_fma_f32 v[60:61], v[246:247], v[180:181], v[60:61] op_sel_hi:[0,1,1] neg_lo:[1,0,0] neg_hi:[1,0,0]
    v_pk_fma_f32 v[62:63], v[246:247], v[182:183], v[62:63] op_sel_hi:[0,1,1] neg_lo:[1,0,0] neg_hi:[1,0,0]
    v_pk_mul_f32 v[32:33], v[32:33], v[246:247] op_sel:[0,1] op_sel_hi:[1,1]
    v_pk_mul_f32 v[34:35], v[34:35], v[246:247] op_sel:[0,1] op_sel_hi:[1,1]
    v_pk_mul_f32 v[36:37], v[36:37], v[246:247] op_sel:[0,1] op_sel_hi:[1,1]
    v_pk_mul_f32 v[38:39], v[38:39], v[246:247] op_sel:[0,1] op_sel_hi:[1,1]
    v_pk_mul_f32 v[40:41], v[40:41], v[246:247] op_sel:[0,1] op_sel_hi:[1,1]
    v_pk_mul_f32 v[42:43], v[42:43], v[246:247] op_sel:[0,1] op_sel_hi:[1,1]
    v_pk_mul_f32 v[44:45], v[44:45], v[246:247] op_sel:[0,1] op_sel_hi:[1,1]
    v_pk_mul_f32 v[46:47], v[46:47], v[246:247] op_sel:[0,1] op_sel_hi:[1,1]
    v_pk_mul_f32 v[48:49], v[48:49], v[246:247] op_sel:[0,1] op_sel_hi:[1,1]
    v_pk_mul_f32 v[50:51], v[50:51], v[246:247] op_sel:[0,1] op_sel_hi:[1,1]
    v_pk_mul_f32 v[52:53], v[52:53], v[246:247] op_sel:[0,1] op_sel_hi:[1,1]
    v_pk_mul_f32 v[54:55], v[54:55], v[246:247] op_sel:[0,1] op_sel_hi:[1,1]
    v_pk_mul_f32 v[56:57], v[56:57], v[246:247] op_sel:[0,1] op_sel_hi:[1,1]
    v_pk_mul_f32 v[58:59], v[58:59], v[246:247] op_sel:[0,1] op_sel_hi:[1,1]
    v_pk_mul_f32 v[60:61], v[60:61], v[246:247] op_sel:[0,1] op_sel_hi:[1,1]
    v_pk_mul_f32 v[62:63], v[62:63], v[246:247] op_sel:[0,1] op_sel_hi:[1,1]
    s_nop 1
    v_mfma_f32_16x16x32_bf16 v[68:71], a[36:39], a[88:91], v[68:71]
    ds_read_b128 a[232:235], v230 offset:8192
    v_rcp_f32 v249, v249
    v_mfma_f32_16x16x32_bf16 v[72:75], a[8:11], a[72:75], v[72:75]
    ds_read_b128 a[236:239], v231 offset:8192
    v_rcp_f32 v251, v251
    v_mfma_f32_16x16x32_bf16 v[72:75], a[40:43], a[88:91], v[72:75]
    buffer_load_dwordx4 v235, s[16:19], s33 offen offset:3072  lds
    v_mfma_f32_16x16x32_bf16 v[76:79], a[12:15], a[72:75], v[76:79]
    ds_read_b128 a[240:243], v228 offset:9216
    v_and_b32 v248, 0xffff0000, v248
    v_mfma_f32_16x16x32_bf16 v[76:79], a[44:47], a[88:91], v[76:79]
    ds_read_b128 a[244:247], v229 offset:9216
    v_and_b32 v250, 0xffff0000, v250
    v_mfma_f32_16x16x32_bf16 v[80:83], a[16:19], a[72:75], v[80:83]
    ds_read_b128 a[248:251], v230 offset:9216
    v_mul_f32 v249, 0x3e0293ee, v249
    v_mfma_f32_16x16x32_bf16 v[80:83], a[48:51], a[88:91], v[80:83]
    s_mov_b32 s32, 49152
    s_mov_b32 m0, s27
    ds_read_b128 a[252:255], v231 offset:9216
    v_mul_f32 v251, 0x3e0293ee, v251
    v_mfma_f32_16x16x32_bf16 v[84:87], a[20:23], a[72:75], v[84:87]
    buffer_load_dwordx4 v232, s[12:15], s32 offen offset:0  lds
    v_mfma_f32_16x16x32_bf16 v[84:87], a[52:55], a[88:91], v[84:87]
    ds_read_b128 a[128:131], v228 offset:16384
    v_cvt_pk_bf16_f32 v128, v0, v1
    v_mfma_f32_16x16x32_bf16 v[88:91], a[24:27], a[72:75], v[88:91]
    ds_read_b128 a[132:135], v229 offset:16384
    v_cvt_pk_bf16_f32 v129, v2, v3
    v_mfma_f32_16x16x32_bf16 v[88:91], a[56:59], a[88:91], v[88:91]
    ds_read_b128 a[136:139], v230 offset:16384
    v_cvt_pk_bf16_f32 v130, v4, v5
    v_mfma_f32_16x16x32_bf16 v[92:95], a[28:31], a[72:75], v[92:95]
    buffer_load_dwordx4 v232, s[12:15], s32 offen offset:1024  lds
    v_mfma_f32_16x16x32_bf16 v[92:95], a[60:63], a[88:91], v[92:95]
    ds_read_b128 a[140:143], v231 offset:16384
    v_cvt_pk_bf16_f32 v131, v6, v7
    v_mfma_f32_16x16x32_bf16 v[96:99], a[0:3], a[76:79], v[96:99]
    ds_read_b128 a[144:147], v228 offset:17408
    v_cvt_pk_bf16_f32 v132, v8, v9
    v_mfma_f32_16x16x32_bf16 v[96:99], a[32:35], a[92:95], v[96:99]
    ds_read_b128 a[148:151], v229 offset:17408
    v_cvt_pk_bf16_f32 v133, v10, v11
    v_mfma_f32_16x16x32_bf16 v[100:103], a[4:7], a[76:79], v[100:103]
    ds_read_b128 a[152:155], v230 offset:17408
    v_cvt_pk_bf16_f32 v134, v12, v13
    v_mfma_f32_16x16x32_bf16 v[100:103], a[36:39], a[92:95], v[100:103]
    buffer_load_dwordx4 v233, s[12:15], s32 offen offset:2048  lds
    v_mfma_f32_16x16x32_bf16 v[104:107], a[8:11], a[76:79], v[104:107]
    ds_read_b128 a[156:159], v231 offset:17408
    v_pk_fma_f32 v[64:65], v[248:249], v[192:193], v[64:65] op_sel_hi:[0,1,1] neg_lo:[1,0,0] neg_hi:[1,0,0]
    v_pk_fma_f32 v[66:67], v[248:249], v[194:195], v[66:67] op_sel_hi:[0,1,1] neg_lo:[1,0,0] neg_hi:[1,0,0]
    v_pk_fma_f32 v[68:69], v[248:249], v[196:197], v[68:69] op_sel_hi:[0,1,1] neg_lo:[1,0,0] neg_hi:[1,0,0]
    v_pk_fma_f32 v[70:71], v[248:249], v[198:199], v[70:71] op_sel_hi:[0,1,1] neg_lo:[1,0,0] neg_hi:[1,0,0]
    v_pk_fma_f32 v[72:73], v[248:249], v[200:201], v[72:73] op_sel_hi:[0,1,1] neg_lo:[1,0,0] neg_hi:[1,0,0]
    v_pk_fma_f32 v[74:75], v[248:249], v[202:203], v[74:75] op_sel_hi:[0,1,1] neg_lo:[1,0,0] neg_hi:[1,0,0]
    v_pk_fma_f32 v[76:77], v[248:249], v[204:205], v[76:77] op_sel_hi:[0,1,1] neg_lo:[1,0,0] neg_hi:[1,0,0]
    v_pk_fma_f32 v[78:79], v[248:249], v[206:207], v[78:79] op_sel_hi:[0,1,1] neg_lo:[1,0,0] neg_hi:[1,0,0]
    v_pk_fma_f32 v[80:81], v[248:249], v[208:209], v[80:81] op_sel_hi:[0,1,1] neg_lo:[1,0,0] neg_hi:[1,0,0]
    v_pk_fma_f32 v[82:83], v[248:249], v[210:211], v[82:83] op_sel_hi:[0,1,1] neg_lo:[1,0,0] neg_hi:[1,0,0]
    v_pk_fma_f32 v[84:85], v[248:249], v[212:213], v[84:85] op_sel_hi:[0,1,1] neg_lo:[1,0,0] neg_hi:[1,0,0]
    v_pk_fma_f32 v[86:87], v[248:249], v[214:215], v[86:87] op_sel_hi:[0,1,1] neg_lo:[1,0,0] neg_hi:[1,0,0]
    v_pk_fma_f32 v[88:89], v[248:249], v[176:177], v[88:89] op_sel_hi:[0,1,1] neg_lo:[1,0,0] neg_hi:[1,0,0]
    v_pk_fma_f32 v[90:91], v[248:249], v[178:179], v[90:91] op_sel_hi:[0,1,1] neg_lo:[1,0,0] neg_hi:[1,0,0]
    v_pk_fma_f32 v[92:93], v[248:249], v[180:181], v[92:93] op_sel_hi:[0,1,1] neg_lo:[1,0,0] neg_hi:[1,0,0]
    v_pk_fma_f32 v[94:95], v[248:249], v[182:183], v[94:95] op_sel_hi:[0,1,1] neg_lo:[1,0,0] neg_hi:[1,0,0]
    v_pk_mul_f32 v[64:65], v[64:65], v[248:249] op_sel:[0,1] op_sel_hi:[1,1]
    v_pk_mul_f32 v[66:67], v[66:67], v[248:249] op_sel:[0,1] op_sel_hi:[1,1]
    v_pk_mul_f32 v[68:69], v[68:69], v[248:249] op_sel:[0,1] op_sel_hi:[1,1]
    v_pk_mul_f32 v[70:71], v[70:71], v[248:249] op_sel:[0,1] op_sel_hi:[1,1]
    v_pk_mul_f32 v[72:73], v[72:73], v[248:249] op_sel:[0,1] op_sel_hi:[1,1]
    v_pk_mul_f32 v[74:75], v[74:75], v[248:249] op_sel:[0,1] op_sel_hi:[1,1]
    v_pk_mul_f32 v[76:77], v[76:77], v[248:249] op_sel:[0,1] op_sel_hi:[1,1]
    v_pk_mul_f32 v[78:79], v[78:79], v[248:249] op_sel:[0,1] op_sel_hi:[1,1]
    v_pk_mul_f32 v[80:81], v[80:81], v[248:249] op_sel:[0,1] op_sel_hi:[1,1]
    v_pk_mul_f32 v[82:83], v[82:83], v[248:249] op_sel:[0,1] op_sel_hi:[1,1]
    v_pk_mul_f32 v[84:85], v[84:85], v[248:249] op_sel:[0,1] op_sel_hi:[1,1]
    v_pk_mul_f32 v[86:87], v[86:87], v[248:249] op_sel:[0,1] op_sel_hi:[1,1]
    v_pk_mul_f32 v[88:89], v[88:89], v[248:249] op_sel:[0,1] op_sel_hi:[1,1]
    v_pk_mul_f32 v[90:91], v[90:91], v[248:249] op_sel:[0,1] op_sel_hi:[1,1]
    v_pk_mul_f32 v[92:93], v[92:93], v[248:249] op_sel:[0,1] op_sel_hi:[1,1]
    v_pk_mul_f32 v[94:95], v[94:95], v[248:249] op_sel:[0,1] op_sel_hi:[1,1]
    v_cvt_pk_bf16_f32 v135, v14, v15
    s_nop 0
    v_mfma_f32_16x16x32_bf16 v[104:107], a[40:43], a[92:95], v[104:107]
    ds_read_b128 a[160:163], v228 offset:24576
    v_cvt_pk_bf16_f32 v136, v16, v17
    v_mfma_f32_16x16x32_bf16 v[108:111], a[12:15], a[76:79], v[108:111]
    ds_read_b128 a[164:167], v229 offset:24576
    v_cvt_pk_bf16_f32 v137, v18, v19
    v_mfma_f32_16x16x32_bf16 v[108:111], a[44:47], a[92:95], v[108:111]
    buffer_load_dwordx4 v233, s[12:15], s32 offen offset:3072  lds
    v_mfma_f32_16x16x32_bf16 v[112:115], a[16:19], a[76:79], v[112:115]
    ds_read_b128 a[168:171], v230 offset:24576
    v_cvt_pk_bf16_f32 v138, v20, v21
    v_mfma_f32_16x16x32_bf16 v[112:115], a[48:51], a[92:95], v[112:115]
    ds_read_b128 a[172:175], v231 offset:24576
    v_cvt_pk_bf16_f32 v139, v22, v23
    v_mfma_f32_16x16x32_bf16 v[116:119], a[20:23], a[76:79], v[116:119]
    ds_read_b128 a[176:179], v228 offset:25600
    v_cvt_pk_bf16_f32 v140, v24, v25
    v_mfma_f32_16x16x32_bf16 v[116:119], a[52:55], a[92:95], v[116:119]
    s_branch L_io4
    .p2align 12
L_iw4:
    s_branch L_iwr7
L_io4:
    s_mov_b32 s33, 32768
    s_mov_b32 m0, s30
    ds_read_b128 a[180:183], v229 offset:25600
    v_cvt_pk_bf16_f32 v141, v26, v27
    v_mfma_f32_16x16x32_bf16 v[120:123], a[24:27], a[76:79], v[120:123]
    buffer_load_dwordx4 v234, s[16:19], s33 offen offset:0  lds
    v_mfma_f32_16x16x32_bf16 v[120:123], a[56:59], a[92:95], v[120:123]
    ds_read_b128 a[184:187], v230 offset:25600
    v_cvt_pk_bf16_f32 v142, v28, v29
    v_mfma_f32_16x16x32_bf16 v[124:127], a[28:31], a[76:79], v[124:127]
    ds_read_b128 a[188:191], v231 offset:25600
    v_cvt_pk_bf16_f32 v143, v30, v31
    v_mfma_f32_16x16x32_bf16 v[124:127], a[60:63], a[92:95], v[124:127]
    s_waitcnt lgkmcnt(15)
    s_barrier
    v_cvt_pk_bf16_f32 v144, v32, v33
    v_mfma_f32_16x16x32_bf16 v[0:3], a[192:195], v[128:131], 0
    buffer_load_dwordx4 v234, s[16:19], s33 offen offset:1024  lds
    v_mfma_f32_16x16x32_bf16 v[0:3], a[196:199], v[132:135], v[0:3]
    v_cvt_pk_bf16_f32 v145, v34, v35
    v_cvt_pk_bf16_f32 v146, v36, v37
    v_mfma_f32_16x16x32_bf16 v[0:3], a[200:203], v[136:139], v[0:3]
    v_pk_fma_f32 v[96:97], v[250:251], v[192:193], v[96:97] op_sel_hi:[0,1,1] neg_lo:[1,0,0] neg_hi:[1,0,0]
    v_pk_fma_f32 v[98:99], v[250:251], v[194:195], v[98:99] op_sel_hi:[0,1,1] neg_lo:[1,0,0] neg_hi:[1,0,0]
    v_pk_fma_f32 v[100:101], v[250:251], v[196:197], v[100:101] op_sel_hi:[0,1,1] neg_lo:[1,0,0] neg_hi:[1,0,0]
    v_pk_fma_f32 v[102:103], v[250:251], v[198:199], v[102:103] op_sel_hi:[0,1,1] neg_lo:[1,0,0] neg_hi:[1,0,0]
    v_pk_fma_f32 v[104:105], v[250:251], v[200:201], v[104:105] op_sel_hi:[0,1,1] neg_lo:[1,0,0] neg_hi:[1,0,0]
    v_pk_fma_f32 v[106:107], v[250:251], v[202:203], v[106:107] op_sel_hi:[0,1,1] neg_lo:[1,0,0] neg_hi:[1,0,0]
    v_pk_fma_f32 v[108:109], v[250:251], v[204:205], v[108:109] op_sel_hi:[0,1,1] neg_lo:[1,0,0] neg_hi:[1,0,0]
    v_pk_fma_f32 v[110:111], v[250:251], v[206:207], v[110:111] op_sel_hi:[0,1,1] neg_lo:[1,0,0] neg_hi:[1,0,0]
    v_pk_fma_f32 v[112:113], v[250:251], v[208:209], v[112:113] op_sel_hi:[0,1,1] neg_lo:[1,0,0] neg_hi:[1,0,0]
    v_pk_fma_f32 v[114:115], v[250:251], v[210:211], v[114:115] op_sel_hi:[0,1,1] neg_lo:[1,0,0] neg_hi:[1,0,0]
    v_pk_fma_f32 v[116:117], v[250:251], v[212:213], v[116:117] op_sel_hi:[0,1,1] neg_lo:[1,0,0] neg_hi:[1,0,0]
    v_pk_fma_f32 v[118:119], v[250:251], v[214:215], v[118:119] op_sel_hi:[0,1,1] neg_lo:[1,0,0] neg_hi:[1,0,0]
    v_pk_fma_f32 v[120:121], v[250:251], v[176:177], v[120:121] op_sel_hi:[0,1,1] neg_lo:[1,0,0] neg_hi:[1,0,0]
    v_pk_fma_f32 v[122:123], v[250:251], v[178:179], v[122:123] op_sel_hi:[0,1,1] neg_lo:[1,0,0] neg_hi:[1,0,0]
    v_pk_fma_f32 v[124:125], v[250:251], v[180:181], v[124:125] op_sel_hi:[0,1,1] neg_lo:[1,0,0] neg_hi:[1,0,0]
    v_pk_fma_f32 v[126:127], v[250:251], v[182:183], v[126:127] op_sel_hi:[0,1,1] neg_lo:[1,0,0] neg_hi:[1,0,0]
    v_pk_mul_f32 v[96:97], v[96:97], v[250:251] op_sel:[0,1] op_sel_hi:[1,1]
    v_pk_mul_f32 v[98:99], v[98:99], v[250:251] op_sel:[0,1] op_sel_hi:[1,1]
    v_pk_mul_f32 v[100:101], v[100:101], v[250:251] op_sel:[0,1] op_sel_hi:[1,1]
    v_pk_mul_f32 v[102:103], v[102:103], v[250:251] op_sel:[0,1] op_sel_hi:[1,1]
    v_pk_mul_f32 v[104:105], v[104:105], v[250:251] op_sel:[0,1] op_sel_hi:[1,1]
    v_pk_mul_f32 v[106:107], v[106:107], v[250:251] op_sel:[0,1] op_sel_hi:[1,1]
    v_pk_mul_f32 v[108:109], v[108:109], v[250:251] op_sel:[0,1] op_sel_hi:[1,1]
    v_pk_mul_f32 v[110:111], v[110:111], v[250:251] op_sel:[0,1] op_sel_hi:[1,1]
    v_pk_mul_f32 v[112:113], v[112:113], v[250:251] op_sel:[0,1] op_sel_hi:[1,1]
    v_pk_mul_f32 v[114:115], v[114:115], v[250:251] op_sel:[0,1] op_sel_hi:[1,1]
    v_pk_mul_f32 v[116:117], v[116:117], v[250:251] op_sel:[0,1] op_sel_hi:[1,1]
    v_pk_mul_f32 v[118:119], v[118:119], v[250:251] op_sel:[0,1] op_sel_hi:[1,1]
    v_pk_mul_f32 v[120:121], v[120:121], v[250:251] op_sel:[0,1] op_sel_hi:[1,1]
    v_pk_mul_f32 v[122:123], v[122:123], v[250:251] op_sel:[0,1] op_sel_hi:[1,1]
    v_pk_mul_f32 v[124:125], v[124:125], v[250:251] op_sel:[0,1] op_sel_hi:[1,1]
    v_pk_mul_f32 v[126:127], v[126:127], v[250:251] op_sel:[0,1] op_sel_hi:[1,1]
    v_cvt_pk_bf16_f32 v147, v38, v39
    v_cvt_pk_bf16_f32 v148, v40, v41
    v_cvt_pk_bf16_f32 v149, v42, v43
    v_cvt_pk_bf16_f32 v150, v44, v45
    v_cvt_pk_bf16_f32 v151, v46, v47
    v_cvt_pk_bf16_f32 v152, v48, v49
    v_cvt_pk_bf16_f32 v153, v50, v51
    v_cvt_pk_bf16_f32 v154, v52, v53
    v_cvt_pk_bf16_f32 v155, v54, v55
    v_cvt_pk_bf16_f32 v156, v56, v57
    v_cvt_pk_bf16_f32 v157, v58, v59
    v_cvt_pk_bf16_f32 v158, v60, v61
    v_cvt_pk_bf16_f32 v159, v62, v63
    v_mfma_f32_16x16x32_bf16 v[0:3], a[204:207], v[140:143], v[0:3]
    v_cvt_pk_bf16_f32 v160, v64, v65
    v_cvt_pk_bf16_f32 v161, v66, v67
    v_mfma_f32_16x16x32_bf16 v[16:19], a[192:195], v[144:147], 0
    v_cvt_pk_bf16_f32 v162, v68, v69
    v_cvt_pk_bf16_f32 v163, v70, v71
    v_mfma_f32_16x16x32_bf16 v[16:19], a[196:199], v[148:151], v[16:19]
    buffer_load_dwordx4 v235, s[16:19], s33 offen offset:2048  lds
    v_mfma_f32_16x16x32_bf16 v[16:19], a[200:203], v[152:155], v[16:19]
    v_cvt_pk_bf16_f32 v164, v72, v73
    v_cvt_pk_bf16_f32 v165, v74, v75
    v_cvt_pk_bf16_f32 v166, v76, v77
    v_cvt_pk_bf16_f32 v167, v78, v79
    v_cvt_pk_bf16_f32 v168, v80, v81
    v_cvt_pk_bf16_f32 v169, v82, v83
    v_cvt_pk_bf16_f32 v170, v84, v85
    v_cvt_pk_bf16_f32 v171, v86, v87
    v_cvt_pk_bf16_f32 v172, v88, v89
    v_cvt_pk_bf16_f32 v173, v90, v91
    v_cvt_pk_bf16_f32 v174, v92, v93
    v_cvt_pk_bf16_f32 v175, v94, v95
    v_mfma_f32_16x16x32_bf16 v[16:19], a[204:207], v[156:159], v[16:19]
    v_cvt_pk_bf16_f32 v176, v96, v97
    v_cvt_pk_bf16_f32 v177, v98, v99
    v_mfma_f32_16x16x32_bf16 v[32:35], a[192:195], v[160:163], 0
    v_cvt_pk_bf16_f32 v178, v100, v101
    v_cvt_pk_bf16_f32 v179, v102, v103
    v_mfma_f32_16x16x32_bf16 v[32:35], a[196:199], v[164:167], v[32:35]
    buffer_load_dwordx4 v235, s[16:19], s33 offen offset:3072  lds
    v_mfma_f32_16x16x32_bf16 v[32:35], a[200:203], v[168:171], v[32:35]
    v_cvt_pk_bf16_f32 v180, v104, v105
    v_cvt_pk_bf16_f32 v181, v106, v107
    v_cvt_pk_bf16_f32 v182, v108, v109
    v_cvt_pk_bf16_f32 v183, v110, v111
    v_cvt_pk_bf16_f32 v184, v112, v113
    v_cvt_pk_bf16_f32 v185, v114, v115
    v_cvt_pk_bf16_f32 v186, v116, v117
    v_cvt_pk_bf16_f32 v187, v118, v119
    v_cvt_pk_bf16_f32 v188, v120, v121
    v_cvt_pk_bf16_f32 v189, v122, v123
    v_cvt_pk_bf16_f32 v190, v124, v125
    v_cvt_pk_bf16_f32 v191, v126, v127
    v_mfma_f32_16x16x32_bf16 v[32:35], a[204:207], v[172:175], v[32:35]
    v_mov_b32 v208, 0xff800000
    v_mov_b32 v209, 0xff800000
    v_mov_b32 v210, 0xff800000
    v_mov_b32 v211, 0xff800000
    s_cmp_lg_u32 s74, 0
    s_cbranch_scc1 L_maxpass
L_maxdone:
    v_mfma_f32_16x16x32_bf16 v[48:51], a[192:195], v[176:179], 0
    v_max3_f32 v244, v0, v1, v2
    v_max3_f32 v245, v16, v17, v18
    v_mfma_f32_16x16x32_bf16 v[48:51], a[196:199], v[180:183], v[48:51]
    s_add_u32 m0, s82, 16384
    v_max3_f32 v244, v244, v3, v208
    v_max3_f32 v245, v245, v19, v209
    v_mfma_f32_16x16x32_bf16 v[48:51], a[200:203], v[184:187], v[48:51]
    buffer_load_dwordx4 v252, s[84:87], s40 offen offset:0  lds
    v_mov_b32 v248, v244
    v_mov_b32 v249, v245
    s_nop 0
    v_permlane16_swap_b32 v248, v244
    v_permlane16_swap_b32 v249, v245
    v_max_f32 v244, v244, v248
    v_max_f32 v245, v245, v249
    v_mov_b32 v248, v244
    v_mov_b32 v249, v245
    s_nop 0
    v_permlane32_swap_b32 v248, v244
    v_permlane32_swap_b32 v249, v245
    v_max_f32 v244, v244, v248
    v_max_f32 v245, v245, v249
    v_xor_b32 v192, 0x80000000, v244
    v_xor_b32 v193, 0x80000000, v244
    v_xor_b32 v194, 0x80000000, v244
    v_xor_b32 v195, 0x80000000, v244
    v_mfma_f32_16x16x32_bf16 v[48:51], a[204:207], v[188:191], v[48:51]
    v_sub_f32 v0, v0, v244
    v_sub_f32 v1, v1, v244
    v_mfma_f32_16x16x32_bf16 v[4:7], a[208:211], v[128:131], v[192:195]
    v_sub_f32 v2, v2, v244
    v_sub_f32 v3, v3, v244
    v_mfma_f32_16x16x32_bf16 v[4:7], a[212:215], v[132:135], v[4:7]
    v_xor_b32 v196, 0x80000000, v245
    v_xor_b32 v197, 0x80000000, v245
    v_exp_f32 v0, v0
    v_mfma_f32_16x16x32_bf16 v[4:7], a[216:219], v[136:139], v[4:7]
    buffer_load_dwordx4 v252, s[84:87], s40 offen offset:1024  lds
    v_exp_f32 v1, v1
    v_mfma_f32_16x16x32_bf16 v[4:7], a[220:223], v[140:143], v[4:7]
    v_xor_b32 v198, 0x80000000, v245
    v_xor_b32 v199, 0x80000000, v245
    v_add_f32 v236, v236, v0
    v_mfma_f32_16x16x32_bf16 v[8:11], a[224:227], v[128:131], v[192:195]
    v_sub_f32 v16, v16, v245
    v_sub_f32 v17, v17, v245
    v_mfma_f32_16x16x32_bf16 v[8:11], a[228:231], v[132:135], v[8:11]
    v_sub_f32 v18, v18, v245
    v_sub_f32 v19, v19, v245
    v_exp_f32 v2, v2
    v_add_f32 v236, v236, v1
    v_mfma_f32_16x16x32_bf16 v[8:11], a[232:235], v[136:139], v[8:11]
    s_mov_b32 s33, 49152
    s_mov_b32 m0, s31
    v_max3_f32 v246, v32, v33, v34
    v_max3_f32 v247, v48, v49, v50
    v_cvt_pk_bf16_f32 v0, v0, v1
    v_mfma_f32_16x16x32_bf16 v[8:11], a[236:239], v[140:143], v[8:11]
    buffer_load_dwordx4 v234, s[16:19], s33 offen offset:0  lds
    v_exp_f32 v3, v3
    v_mfma_f32_16x16x32_bf16 v[12:15], a[240:243], v[128:131], v[192:195]
    v_max3_f32 v246, v246, v35, v210
    v_max3_f32 v247, v247, v51, v211
    v_add_f32 v236, v236, v2
    v_mfma_f32_16x16x32_bf16 v[12:15], a[244:247], v[132:135], v[12:15]
    v_mov_b32 v250, v246
    v_mov_b32 v251, v247
    v_mfma_f32_16x16x32_bf16 v[12:15], a[248:251], v[136:139], v[12:15]
    v_permlane16_swap_b32 v250, v246
    v_permlane16_swap_b32 v251, v247
    v_exp_f32 v4, v4
    v_add_f32 v236, v236, v3
    v_mfma_f32_16x16x32_bf16 v[12:15], a[252:255], v[140:143], v[12:15]
    buffer_load_dwordx4 v234, s[16:19], s33 offen offset:1024  lds
    v_cvt_pk_bf16_f32 v1, v2, v3
    v_mfma_f32_16x16x32_bf16 v[20:23], a[208:211], v[144:147], v[196:199]
    v_max_f32 v246, v246, v250
    v_max_f32 v247, v247, v251
    v_exp_f32 v5, v5
    v_mfma_f32_16x16x32_bf16 v[20:23], a[212:215], v[148:151], v[20:23]
    v_mov_b32 v250, v246
    v_mov_b32 v251, v247
    v_add_f32 v236, v236, v4
    v_mfma_f32_16x16x32_bf16 v[20:23], a[216:219], v[152:155], v[20:23]
    v_permlane32_swap_b32 v250, v246
    v_permlane32_swap_b32 v251, v247
    v_mfma_f32_16x16x32_bf16 v[20:23], a[220:223], v[156:159], v[20:23]
    v_max_f32 v246, v246, v250
    v_max_f32 v247, v247, v251
    v_exp_f32 v6, v6
    v_add_f32 v236, v236, v5
    v_mfma_f32_16x16x32_bf16 v[24:27], a[224:227], v[144:147], v[196:199]
    buffer_load_dwordx4 v235, s[16:19], s33 offen offset:2048  lds
    v_cvt_pk_bf16_f32 v2, v4, v5
    v_mfma_f32_16x16x32_bf16 v[24:27], a[228:231], v[148:151], v[24:27]
    v_xor_b32 v200, 0x80000000, v246
    v_xor_b32 v201, 0x80000000, v246
    v_exp_f32 v7, v7
    v_mfma_f32_16x16x32_bf16 v[24:27], a[232:235], v[152:155], v[24:27]
    v_xor_b32 v202, 0x80000000, v246
    v_xor_b32 v203, 0x80000000, v246
    v_add_f32 v236, v236, v6
    v_mfma_f32_16x16x32_bf16 v[24:27], a[236:239], v[156:159], v[24:27]
    v_sub_f32 v32, v32, v246
    v_sub_f32 v33, v33, v246
    v_mfma_f32_16x16x32_bf16 v[28:31], a[240:243], v[144:147], v[196:199]
    buffer_load_dwordx4 v235, s[16:19], s33 offen offset:3072  lds
    v_exp_f32 v8, v8
    v_add_f32 v236, v236, v7
    v_mfma_f32_16x16x32_bf16 v[28:31], a[244:247], v[148:151], v[28:31]
    v_sub_f32 v34, v34, v246
    v_sub_f32 v35, v35, v246
    v_cvt_pk_bf16_f32 v3, v6, v7
    v_mfma_f32_16x16x32_bf16 v[28:31], a[248:251], v[152:155], v[28:31]
    v_xor_b32 v204, 0x80000000, v247
    v_xor_b32 v205, 0x80000000, v247
    v_exp_f32 v9, v9
    v_mfma_f32_16x16x32_bf16 v[28:31], a[252:255], v[156:159], v[28:31]
    v_xor_b32 v206, 0x80000000, v247
    v_xor_b32 v207, 0x80000000, v247
    v_add_f32 v236, v236, v8
    v_mfma_f32_16x16x32_bf16 v[36:39], a[208:211], v[160:163], v[200:203]
    s_mov_b32 s32, 65536
    s_mov_b32 m0, s24
    v_sub_f32 v48, v48, v247
    v_sub_f32 v49, v49, v247
    v_mfma_f32_16x16x32_bf16 v[36:39], a[212:215], v[164:167], v[36:39]
    buffer_load_dwordx4 v232, s[12:15], s32 offen offset:0  lds
    v_exp_f32 v10, v10
    v_add_f32 v236, v236, v9
    v_mfma_f32_16x16x32_bf16 v[36:39], a[216:219], v[168:171], v[36:39]
    v_sub_f32 v50, v50, v247
    v_sub_f32 v51, v51, v247
    v_cvt_pk_bf16_f32 v8, v8, v9
    v_mfma_f32_16x16x32_bf16 v[36:39], a[220:223], v[172:175], v[36:39]
    v_exp_f32 v11, v11
    v_add_f32 v236, v236, v10
    v_mfma_f32_16x16x32_bf16 v[40:43], a[224:227], v[160:163], v[200:203]
    v_exp_f32 v12, v12
    v_add_f32 v236, v236, v11
    v_cvt_pk_bf16_f32 v9, v10, v11
    v_mfma_f32_16x16x32_bf16 v[40:43], a[228:231], v[164:167], v[40:43]
    buffer_load_dwordx4 v232, s[12:15], s32 offen offset:1024  lds
    v_mfma_f32_16x16x32_bf16 v[40:43], a[232:235], v[168:171], v[40:43]
    v_exp_f32 v13, v13
    v_add_f32 v236, v236, v12
    v_exp_f32 v14, v14
    v_mfma_f32_16x16x32_bf16 v[40:43], a[236:239], v[172:175], v[40:43]
    v_add_f32 v236, v236, v13
    v_cvt_pk_bf16_f32 v10, v12, v13
    v_mfma_f32_16x16x32_bf16 v[44:47], a[240:243], v[160:163], v[200:203]
    v_exp_f32 v15, v15
    v_add_f32 v236, v236, v14
    v_exp_f32 v16, v16
    v_mfma_f32_16x16x32_bf16 v[44:47], a[244:247], v[164:167], v[44:47]
    v_add_f32 v236, v236, v15
    v_cvt_pk_bf16_f32 v11, v14, v15
    v_mfma_f32_16x16x32_bf16 v[44:47], a[248:251], v[168:171], v[44:47]
    buffer_load_dwordx4 v233, s[12:15], s32 offen offset:2048  lds
    v_exp_f32 v17, v17
    v_mfma_f32_16x16x32_bf16 v[44:47], a[252:255], v[172:175], v[44:47]
    v_exp_f32 v18, v18
    v_cvt_pk_bf16_f32 v16, v16, v17
    v_mfma_f32_16x16x32_bf16 v[52:55], a[208:211], v[176:179], v[204:207]
    v_exp_f32 v19, v19
    v_exp_f32 v20, v20
    v_mfma_f32_16x16x32_bf16 v[52:55], a[212:215], v[180:183], v[52:55]
    v_cvt_pk_bf16_f32 v17, v18, v19
    v_exp_f32 v21, v21
    v_mfma_f32_16x16x32_bf16 v[52:55], a[216:219], v[184:187], v[52:55]
    buffer_load_dwordx4 v233, s[12:15], s32 offen offset:3072  lds
    v_exp_f32 v22, v22
    v_mfma_f32_16x16x32_bf16 v[52:55], a[220:223], v[188:191], v[52:55]
    v_cvt_pk_bf16_f32 v18, v20, v21
    v_exp_f32 v23, v23
    v_mfma_f32_16x16x32_bf16 v[56:59], a[224:227], v[176:179], v[204:207]
    v_exp_f32 v24, v24
    v_cvt_pk_bf16_f32 v19, v22, v23
    v_mfma_f32_16x16x32_bf16 v[56:59], a[228:231], v[180:183], v[56:59]
    v_exp_f32 v25, v25
    v_exp_f32 v26, v26
    v_mfma_f32_16x16x32_bf16 v[56:59], a[232:235], v[184:187], v[56:59]
    s_mov_b32 s32, 81920
    s_mov_b32 s33, 65536
    v_cvt_pk_bf16_f32 v24, v24, v25
    v_exp_f32 v27, v27
    v_mfma_f32_16x16x32_bf16 v[56:59], a[236:239], v[188:191], v[56:59]
    v_exp_f32 v28, v28
    v_cvt_pk_bf16_f32 v25, v26, v27
    v_mfma_f32_16x16x32_bf16 v[60:63], a[240:243], v[176:179], v[204:207]
    v_exp_f32 v29, v29
    v_exp_f32 v30, v30
    v_mfma_f32_16x16x32_bf16 v[60:63], a[244:247], v[180:183], v[60:63]
    v_cvt_pk_bf16_f32 v26, v28, v29
    v_exp_f32 v31, v31
    v_mfma_f32_16x16x32_bf16 v[60:63], a[248:251], v[184:187], v[60:63]
    v_exp_f32 v32, v32
    v_exp_f32 v33, v33
    v_mfma_f32_16x16x32_bf16 v[60:63], a[252:255], v[188:191], v[60:63]
    v_exp_f32 v34, v34
    s_waitcnt vmcnt(27) lgkmcnt(0)
    s_barrier
    v_exp_f32 v35, v35
    v_mfma_f32_16x16x32_bf16 v[64:67], a[128:131], v[128:131], v[192:195]
    ds_read_b64_tr_b16 a[192:193], v220 offset:0
    v_cvt_pk_bf16_f32 v27, v30, v31
    v_mfma_f32_16x16x32_bf16 v[64:67], a[132:135], v[132:135], v[64:67]
    v_exp_f32 v36, v36
    v_mfma_f32_16x16x32_bf16 v[64:67], a[136:139], v[136:139], v[64:67]
    ds_read_b64_tr_b16 a[194:195], v220 offset:1024
    v_add_f32 v238, v238, v32
    v_mfma_f32_16x16x32_bf16 v[64:67], a[140:143], v[140:143], v[64:67]
    v_exp_f32 v37, v37
    v_mfma_f32_16x16x32_bf16 v[68:71], a[144:147], v[128:131], v[192:195]
    ds_read_b64_tr_b16 a[224:225], v220 offset:8192
    v_add_f32 v238, v238, v33
    v_mfma_f32_16x16x32_bf16 v[68:71], a[148:151], v[132:135], v[68:71]
    v_exp_f32 v38, v38
    v_mfma_f32_16x16x32_bf16 v[68:71], a[152:155], v[136:139], v[68:71]
    ds_read_b64_tr_b16 a[226:227], v220 offset:9216
    v_cvt_pk_bf16_f32 v32, v32, v33
    v_mfma_f32_16x16x32_bf16 v[68:71], a[156:159], v[140:143], v[68:71]
    ds_read_b64_tr_b16 a[196:197], v221 offset:0
    v_add_f32 v238, v238, v34
    v_mfma_f32_16x16x32_bf16 v[72:75], a[160:163], v[128:131], v[192:195]
    v_exp_f32 v39, v39
    v_mfma_f32_16x16x32_bf16 v[72:75], a[164:167], v[132:135], v[72:75]
    ds_read_b64_tr_b16 a[198:199], v221 offset:1024
    v_add_f32 v238, v238, v35
    v_mfma_f32_16x16x32_bf16 v[72:75], a[168:171], v[136:139], v[72:75]
    v_exp_f32 v40, v40
    v_mfma_f32_16x16x32_bf16 v[72:75], a[172:175], v[140:143], v[72:75]
    ds_read_b64_tr_b16 a[228:229], v221 offset:8192
    v_cvt_pk_bf16_f32 v33, v34, v35
    v_mfma_f32_16x16x32_bf16 v[76:79], a[176:179], v[128:131], v[192:195]
    v_exp_f32 v41, v41
    v_mfma_f32_16x16x32_bf16 v[76:79], a[180:183], v[132:135], v[76:79]
    ds_read_b64_tr_b16 a[230:231], v221 offset:9216
    v_add_f32 v238, v238, v36
    v_mfma_f32_16x16x32_bf16 v[76:79], a[184:187], v[136:139], v[76:79]
    ds_read_b64_tr_b16 a[200:201], v222 offset:0
    v_add_f32 v238, v238, v37
    v_mfma_f32_16x16x32_bf16 v[76:79], a[188:191], v[140:143], v[76:79]
    v_exp_f32 v42, v42
    v_mfma_f32_16x16x32_bf16 v[80:83], a[128:131], v[144:147], v[196:199]
    ds_read_b64_tr_b16 a[202:203], v222 offset:1024
    v_cvt_pk_bf16_f32 v34, v36, v37
    v_mfma_f32_16x16x32_bf16 v[80:83], a[132:135], v[148:151], v[80:83]
    v_exp_f32 v43, v43
    v_mfma_f32_16x16x32_bf16 v[80:83], a[136:139], v[152:155], v[80:83]
    ds_read_b64_tr_b16 a[232:233], v222 offset:8192
    v_add_f32 v238, v238, v38
    v_mfma_f32_16x16x32_bf16 v[80:83], a[140:143], v[156:159], v[80:83]
    v_exp_f32 v44, v44
    v_mfma_f32_16x16x32_bf16 v[84:87], a[144:147], v[144:147], v[196:199]
    ds_read_b64_tr_b16 a[234:235], v222 offset:9216
    v_add_f32 v238, v238, v39
    v_mfma_f32_16x16x32_bf16 v[84:87], a[148:151], v[148:151], v[84:87]
    ds_read_b64_tr_b16 a[204:205], v223 offset:0
    v_cvt_pk_bf16_f32 v35, v38, v39
    v_mfma_f32_16x16x32_bf16 v[84:87], a[152:155], v[152:155], v[84:87]
    v_exp_f32 v45, v45
    v_mfma_f32_16x16x32_bf16 v[84:87], a[156:159], v[156:159], v[84:87]
    ds_read_b64_tr_b16 a[206:207], v223 offset:1024
    v_add_f32 v238, v238, v40
    v_mfma_f32_16x16x32_bf16 v[88:91], a[160:163], v[144:147], v[196:199]
    v_exp_f32 v46, v46
    v_mfma_f32_16x16x32_bf16 v[88:91], a[164:167], v[148:151], v[88:91]
    ds_read_b64_tr_b16 a[236:237], v223 offset:8192
    v_add_f32 v238, v238, v41
    v_mfma_f32_16x16x32_bf16 v[88:91], a[168:171], v[152:155], v[88:91]
    v_exp_f32 v47, v47
    v_mfma_f32_16x16x32_bf16 v[88:91], a[172:175], v[156:159], v[88:91]
    ds_read_b64_tr_b16 a[238:239], v223 offset:9216
    v_cvt_pk_bf16_f32 v40, v40, v41
    v_mfma_f32_16x16x32_bf16 v[92:95], a[176:179], v[144:147], v[196:199]
    ds_read_b64_tr_b16 a[208:209], v224 offset:0
    v_add_f32 v238, v238, v42
    v_mfma_f32_16x16x32_bf16 v[92:95], a[180:183], v[148:151], v[92:95]
    v_exp_f32 v48, v48
    v_mfma_f32_16x16x32_bf16 v[92:95], a[184:187], v[152:155], v[92:95]
    ds_read_b64_tr_b16 a[210:211], v224 offset:1024
    s_branch L_io5
    .p2align 12
L_iw5:
    s_branch L_iwr7
L_io5:
    v_add_f32 v238, v238, v43
    v_mfma_f32_16x16x32_bf16 v[92:95], a[188:191], v[156:159], v[92:95]
    v_exp_f32 v49, v49
    v_mfma_f32_16x16x32_bf16 v[96:99], a[128:131], v[160:163], v[200:203]
    ds_read_b64_tr_b16 a[240:241], v224 offset:8192
    v_cvt_pk_bf16_f32 v41, v42, v43
    v_mfma_f32_16x16x32_bf16 v[96:99], a[132:135], v[164:167], v[96:99]
    v_exp_f32 v50, v50
    v_mfma_f32_16x16x32_bf16 v[96:99], a[136:139], v[168:171], v[96:99]
    ds_read_b64_tr_b16 a[242:243], v224 offset:9216
    v_add_f32 v238, v238, v44
    v_mfma_f32_16x16x32_bf16 v[96:99], a[140:143], v[172:175], v[96:99]
    ds_read_b64_tr_b16 a[212:213], v225 offset:0
    v_add_f32 v238, v238, v45
    v_mfma_f32_16x16x32_bf16 v[100:103], a[144:147], v[160:163], v[200:203]
    v_exp_f32 v51, v51
    v_mfma_f32_16x16x32_bf16 v[100:103], a[148:151], v[164:167], v[100:103]
    ds_read_b64_tr_b16 a[214:215], v225 offset:1024
    v_cvt_pk_bf16_f32 v42, v44, v45
    v_mfma_f32_16x16x32_bf16 v[100:103], a[152:155], v[168:171], v[100:103]
    v_exp_f32 v52, v52
    v_mfma_f32_16x16x32_bf16 v[100:103], a[156:159], v[172:175], v[100:103]
    ds_read_b64_tr_b16 a[244:245], v225 offset:8192
    v_add_f32 v238, v238, v46
    v_mfma_f32_16x16x32_bf16 v[104:107], a[160:163], v[160:163], v[200:203]
    v_exp_f32 v53, v53
    v_mfma_f32_16x16x32_bf16 v[104:107], a[164:167], v[164:167], v[104:107]
    ds_read_b64_tr_b16 a[246:247], v225 offset:9216
    v_add_f32 v238, v238, v47
    v_mfma_f32_16x16x32_bf16 v[104:107], a[168:171], v[168:171], v[104:107]
    ds_read_b64_tr_b16 a[216:217], v226 offset:0
    v_cvt_pk_bf16_f32 v43, v46, v47
    v_mfma_f32_16x16x32_bf16 v[104:107], a[172:175], v[172:175], v[104:107]
    v_exp_f32 v54, v54
    v_mfma_f32_16x16x32_bf16 v[108:111], a[176:179], v[160:163], v[200:203]
    ds_read_b64_tr_b16 a[218:219], v226 offset:1024
    v_cvt_pk_bf16_f32 v48, v48, v49
    v_mfma_f32_16x16x32_bf16 v[108:111], a[180:183], v[164:167], v[108:111]
    v_exp_f32 v55, v55
    v_mfma_f32_16x16x32_bf16 v[108:111], a[184:187], v[168:171], v[108:111]
    ds_read_b64_tr_b16 a[248:249], v226 offset:8192
    v_cvt_pk_bf16_f32 v49, v50, v51
    v_mfma_f32_16x16x32_bf16 v[108:111], a[188:191], v[172:175], v[108:111]
    v_exp_f32 v56, v56
    v_mfma_f32_16x16x32_bf16 v[112:115], a[128:131], v[176:179], v[204:207]
    ds_read_b64_tr_b16 a[250:251], v226 offset:9216
    v_cvt_pk_bf16_f32 v50, v52, v53
    v_mfma_f32_16x16x32_bf16 v[112:115], a[132:135], v[180:183], v[112:115]
    ds_read_b64_tr_b16 a[220:221], v227 offset:0
    v_cvt_pk_bf16_f32 v51, v54, v55
    v_mfma_f32_16x16x32_bf16 v[112:115], a[136:139], v[184:187], v[112:115]
    v_exp_f32 v57, v57
    v_mfma_f32_16x16x32_bf16 v[112:115], a[140:143], v[188:191], v[112:115]
    ds_read_b64_tr_b16 a[222:223], v227 offset:1024
    v_cvt_pk_bf16_f32 v56, v56, v57
    v_mfma_f32_16x16x32_bf16 v[116:119], a[144:147], v[176:179], v[204:207]
    v_exp_f32 v58, v58
    v_mfma_f32_16x16x32_bf16 v[116:119], a[148:151], v[180:183], v[116:119]
    v_exp_f32 v59, v59
    v_mfma_f32_16x16x32_bf16 v[116:119], a[152:155], v[184:187], v[116:119]
    ds_read_b64_tr_b16 a[252:253], v227 offset:8192
    v_cvt_pk_bf16_f32 v57, v58, v59
    v_mfma_f32_16x16x32_bf16 v[116:119], a[156:159], v[188:191], v[116:119]
    ds_read_b64_tr_b16 a[254:255], v227 offset:9216
    v_mfma_f32_16x16x32_bf16 v[120:123], a[160:163], v[176:179], v[204:207]
    v_exp_f32 v60, v60
    v_mfma_f32_16x16x32_bf16 v[120:123], a[164:167], v[180:183], v[120:123]
    v_exp_f32 v61, v61
    v_mfma_f32_16x16x32_bf16 v[120:123], a[168:171], v[184:187], v[120:123]
    v_exp_f32 v62, v62
    v_mfma_f32_16x16x32_bf16 v[120:123], a[172:175], v[188:191], v[120:123]
    v_exp_f32 v63, v63
    v_mfma_f32_16x16x32_bf16 v[124:127], a[176:179], v[176:179], v[204:207]
    v_cvt_pk_bf16_f32 v58, v60, v61
    v_cvt_pk_bf16_f32 v59, v62, v63
    v_mfma_f32_16x16x32_bf16 v[124:127], a[180:183], v[180:183], v[124:127]
    s_mov_b32 m0, 162304
    v_mfma_f32_16x16x32_bf16 v[124:127], a[184:187], v[184:187], v[124:127]
    buffer_load_dword v253, s[4:7], s37 offen lds
    v_mfma_f32_16x16x32_bf16 v[124:127], a[188:191], v[188:191], v[124:127]
    s_waitcnt vmcnt(19) lgkmcnt(0)
    s_barrier
    v_mfma_f32_16x16x32_bf16 a[0:3], a[192:195], v[0:3], 0
    v_exp_f32 v64, v64
    v_mfma_f32_16x16x32_bf16 a[0:3], a[224:227], v[8:11], a[0:3]
    v_exp_f32 v65, v65
    v_mfma_f32_16x16x32_bf16 a[4:7], a[196:199], v[0:3], 0
    v_add_f32 v236, v236, v64
    v_add_f32 v236, v236, v65
    v_mfma_f32_16x16x32_bf16 a[4:7], a[228:231], v[8:11], a[4:7]
    s_mov_b32 m0, s28
    v_exp_f32 v66, v66
    v_mfma_f32_16x16x32_bf16 a[8:11], a[200:203], v[0:3], 0
    buffer_load_dwordx4 v234, s[16:19], s33 offen offset:0  lds
    v_mfma_f32_16x16x32_bf16 a[8:11], a[232:235], v[8:11], a[8:11]
    ds_read_b128 a[128:131], v228 offset:32768
    v_cvt_pk_bf16_f32 v64, v64, v65
    v_mfma_f32_16x16x32_bf16 a[12:15], a[204:207], v[0:3], 0
    v_exp_f32 v67, v67
    v_mfma_f32_16x16x32_bf16 a[12:15], a[236:239], v[8:11], a[12:15]
    ds_read_b128 a[132:135], v229 offset:32768
    v_add_f32 v236, v236, v66
    v_mfma_f32_16x16x32_bf16 a[16:19], a[208:211], v[0:3], 0
    v_add_f32 v236, v236, v67
    v_cvt_pk_bf16_f32 v65, v66, v67
    v_mfma_f32_16x16x32_bf16 a[16:19], a[240:243], v[8:11], a[16:19]
    v_exp_f32 v68, v68
    v_mfma_f32_16x16x32_bf16 a[20:23], a[212:215], v[0:3], 0
    v_exp_f32 v69, v69
    v_mfma_f32_16x16x32_bf16 a[20:23], a[244:247], v[8:11], a[20:23]
    ds_read_b128 a[136:139], v230 offset:32768
    v_add_f32 v236, v236, v68
    v_mfma_f32_16x16x32_bf16 a[24:27], a[216:219], v[0:3], 0
    buffer_load_dwordx4 v234, s[16:19], s33 offen offset:1024  lds
    v_mfma_f32_16x16x32_bf16 a[24:27], a[248:251], v[8:11], a[24:27]
    v_add_f32 v236, v236, v69
    v_cvt_pk_bf16_f32 v66, v68, v69
    v_mfma_f32_16x16x32_bf16 a[28:31], a[220:223], v[0:3], 0
    v_exp_f32 v70, v70
    v_mfma_f32_16x16x32_bf16 a[28:31], a[252:255], v[8:11], a[28:31]
    ds_read_b128 a[140:143], v231 offset:32768
    v_add_f32 v236, v236, v70
    v_mfma_f32_16x16x32_bf16 a[32:35], a[192:195], v[16:19], 0
    v_exp_f32 v71, v71
    v_mfma_f32_16x16x32_bf16 a[32:35], a[224:227], v[24:27], a[32:35]
    v_add_f32 v236, v236, v71
    v_cvt_pk_bf16_f32 v67, v70, v71
    v_mfma_f32_16x16x32_bf16 a[36:39], a[196:199], v[16:19], 0
    v_exp_f32 v72, v72
    v_mfma_f32_16x16x32_bf16 a[36:39], a[228:231], v[24:27], a[36:39]
    ds_read_b128 a[144:147], v228 offset:33792
    v_add_f32 v236, v236, v72
    v_mfma_f32_16x16x32_bf16 a[40:43], a[200:203], v[16:19], 0
    buffer_load_dwordx4 v235, s[16:19], s33 offen offset:2048  lds
    v_mfma_f32_16x16x32_bf16 a[40:43], a[232:235], v[24:27], a[40:43]
    v_exp_f32 v73, v73
    v_mfma_f32_16x16x32_bf16 a[44:47], a[204:207], v[16:19], 0
    ds_read_b128 a[148:151], v229 offset:33792
    v_add_f32 v236, v236, v73
    v_mfma_f32_16x16x32_bf16 a[44:47], a[236:239], v[24:27], a[44:47]
    v_exp_f32 v74, v74
    v_mfma_f32_16x16x32_bf16 a[48:51], a[208:211], v[16:19], 0
    v_cvt_pk_bf16_f32 v72, v72, v73
    v_add_f32 v236, v236, v74
    v_mfma_f32_16x16x32_bf16 a[48:51], a[240:243], v[24:27], a[48:51]
    v_exp_f32 v75, v75
    v_mfma_f32_16x16x32_bf16 a[52:55], a[212:215], v[16:19], 0
    ds_read_b128 a[152:155], v230 offset:33792
    v_add_f32 v236, v236, v75
    v_mfma_f32_16x16x32_bf16 a[52:55], a[244:247], v[24:27], a[52:55]
    v_exp_f32 v76, v76
    v_mfma_f32_16x16x32_bf16 a[56:59], a[216:219], v[16:19], 0
    buffer_load_dwordx4 v235, s[16:19], s33 offen offset:3072  lds
    v_mfma_f32_16x16x32_bf16 a[56:59], a[248:251], v[24:27], a[56:59]
    ds_read_b128 a[156:159], v231 offset:33792
    v_cvt_pk_bf16_f32 v73, v74, v75
    v_mfma_f32_16x16x32_bf16 a[60:63], a[220:223], v[16:19], 0
    v_exp_f32 v77, v77
    v_mfma_f32_16x16x32_bf16 a[60:63], a[252:255], v[24:27], a[60:63]
    v_add_f32 v236, v236, v76
    v_add_f32 v236, v236, v77
    v_mfma_f32_16x16x32_bf16 v[208:211], v[216:219], v[16:19], 0
    ds_read_b128 a[160:163], v228 offset:40960
    v_cvt_pk_bf16_f32 v74, v76, v77
    v_mfma_f32_16x16x32_bf16 v[208:211], v[216:219], v[24:27], v[208:211]
    v_exp_f32 v78, v78
    v_mfma_f32_16x16x32_bf16 a[64:67], a[192:195], v[32:35], 0
    s_add_u32 s33, s33, 16384
    v_exp_f32 v79, v79
    v_mfma_f32_16x16x32_bf16 a[64:67], a[224:227], v[40:43], a[64:67]
    s_mov_b32 m0, s25
    v_exp_f32 v80, v80
    v_mfma_f32_16x16x32_bf16 a[68:71], a[196:199], v[32:35], 0
    buffer_load_dwordx4 v232, s[12:15], s32 offen offset:0  lds
    v_mfma_f32_16x16x32_bf16 a[68:71], a[228:231], v[40:43], a[68:71]
    ds_read_b128 a[164:167], v229 offset:40960
    v_add_f32 v236, v236, v78
    v_mfma_f32_16x16x32_bf16 a[72:75], a[200:203], v[32:35], 0
    v_add_f32 v236, v236, v79
    v_cvt_pk_bf16_f32 v75, v78, v79
    v_mfma_f32_16x16x32_bf16 a[72:75], a[232:235], v[40:43], a[72:75]
    v_exp_f32 v81, v81
    v_mfma_f32_16x16x32_bf16 a[76:79], a[204:207], v[32:35], 0
    ds_read_b128 a[168:171], v230 offset:40960
    v_cvt_pk_bf16_f32 v80, v80, v81
    v_mfma_f32_16x16x32_bf16 a[76:79], a[236:239], v[40:43], a[76:79]
    v_exp_f32 v82, v82
    v_mfma_f32_16x16x32_bf16 a[80:83], a[208:211], v[32:35], 0
    v_exp_f32 v83, v83
    v_mfma_f32_16x16x32_bf16 a[80:83], a[240:243], v[40:43], a[80:83]
    ds_read_b128 a[172:175], v231 offset:40960
    v_cvt_pk_bf16_f32 v81, v82, v83
    v_mfma_f32_16x16x32_bf16 a[84:87], a[212:215], v[32:35], 0
    buffer_load_dwordx4 v232, s[12:15], s32 offen offset:1024  lds
    v_mfma_f32_16x16x32_bf16 a[84:87], a[244:247], v[40:43], a[84:87]
    v_exp_f32 v84, v84
    v_mfma_f32_16x16x32_bf16 a[88:91], a[216:219], v[32:35], 0
    v_exp_f32 v85, v85
    v_mfma_f32_16x16x32_bf16 a[88:91], a[248:251], v[40:43], a[88:91]
    ds_read_b128 a[176:179], v228 offset:41984
    v_cvt_pk_bf16_f32 v82, v84, v85
    v_mfma_f32_16x16x32_bf16 a[92:95], a[220:223], v[32:35], 0
    v_exp_f32 v86, v86
    v_mfma_f32_16x16x32_bf16 a[92:95], a[252:255], v[40:43], a[92:95]
    v_exp_f32 v87, v87
    v_mfma_f32_16x16x32_bf16 a[96:99], a[192:195], v[48:51], 0
    ds_read_b128 a[180:183], v229 offset:41984
    v_cvt_pk_bf16_f32 v83, v86, v87
    v_mfma_f32_16x16x32_bf16 a[96:99], a[224:227], v[56:59], a[96:99]
    v_exp_f32 v88, v88
    v_mfma_f32_16x16x32_bf16 a[100:103], a[196:199], v[48:51], 0
    buffer_load_dwordx4 v233, s[12:15], s32 offen offset:2048  lds
    v_mfma_f32_16x16x32_bf16 a[100:103], a[228:231], v[56:59], a[100:103]
    v_exp_f32 v89, v89
    v_mfma_f32_16x16x32_bf16 a[104:107], a[200:203], v[48:51], 0
    ds_read_b128 a[184:187], v230 offset:41984
    v_cvt_pk_bf16_f32 v88, v88, v89
    v_mfma_f32_16x16x32_bf16 a[104:107], a[232:235], v[56:59], a[104:107]
    v_exp_f32 v90, v90
    v_mfma_f32_16x16x32_bf16 a[108:111], a[204:207], v[48:51], 0
    ds_read_b128 a[188:191], v231 offset:41984
    v_mfma_f32_16x16x32_bf16 a[108:111], a[236:239], v[56:59], a[108:111]
    v_exp_f32 v91, v91
    v_mfma_f32_16x16x32_bf16 a[112:115], a[208:211], v[48:51], 0
    v_exp_f32 v92, v92
    v_mfma_f32_16x16x32_bf16 a[112:115], a[240:243], v[56:59], a[112:115]
    v_exp_f32 v93, v93
    v_mfma_f32_16x16x32_bf16 a[116:119], a[212:215], v[48:51], 0
    buffer_load_dwordx4 v233, s[12:15], s32 offen offset:3072  lds
    v_mfma_f32_16x16x32_bf16 a[116:119], a[244:247], v[56:59], a[116:119]
    s_add_u32 s32, s32, 16384
    v_exp_f32 v94, v94
    v_mfma_f32_16x16x32_bf16 a[120:123], a[216:219], v[48:51], 0
    v_cvt_pk_bf16_f32 v89, v90, v91
    v_cvt_pk_bf16_f32 v90, v92, v93
    v_mfma_f32_16x16x32_bf16 a[120:123], a[248:251], v[56:59], a[120:123]
    v_exp_f32 v95, v95
    v_mfma_f32_16x16x32_bf16 a[124:127], a[220:223], v[48:51], 0
    v_exp_f32 v96, v96
    v_mfma_f32_16x16x32_bf16 a[124:127], a[252:255], v[56:59], a[124:127]
    v_exp_f32 v97, v97
    v_mfma_f32_16x16x32_bf16 v[212:215], v[216:219], v[48:51], 0
    v_exp_f32 v98, v98
    v_mfma_f32_16x16x32_bf16 v[212:215], v[216:219], v[56:59], v[212:215]
    s_waitcnt lgkmcnt(0)
    v_exp_f32 v99, v99
    v_lshlrev_b32 v253, 3, v252
    s_lshl_b32 s42, s36, 2
    s_add_u32 s42, s42, s3
    s_lshl_b32 s42, s42, 19
    s_lshl_b32 s43, s35, 14
    s_add_u32 s37, s42, s43
    s_getpc_b64 s[84:85]
L_pc1:
    s_mov_b32 s86, L_codeend-L_pc1
    s_mov_b32 s34, 0
    .p2align 6
L_loop:
    v_mfma_f32_16x16x32_bf16 v[0:3], a[128:131], v[128:131], v[192:195]
    ds_read_b64_tr_b16 a[192:193], v220 offset:16384
    v_cvt_pk_bf16_f32 v91, v94, v95
    v_mfma_f32_16x16x32_bf16 v[0:3], a[132:135], v[132:135], v[0:3]
    v_exp_f32 v100, v100
    v_mfma_f32_16x16x32_bf16 v[0:3], a[136:139], v[136:139], v[0:3]
    ds_read_b64_tr_b16 a[194:195], v220 offset:17408
    v_add_f32 v238, v238, v96
    v_mfma_f32_16x16x32_bf16 v[0:3], a[140:143], v[140:143], v[0:3]
    v_exp_f32 v101, v101
    v_mfma_f32_16x16x32_bf16 v[4:7], a[144:147], v[128:131], v[192:195]
    ds_read_b64_tr_b16 a[224:225], v220 offset:24576
    v_add_f32 v238, v238, v97
    v_mfma_f32_16x16x32_bf16 v[4:7], a[148:151], v[132:135], v[4:7]
    v_exp_f32 v102, v102
    v_mfma_f32_16x16x32_bf16 v[4:7], a[152:155], v[136:139], v[4:7]
    ds_read_b64_tr_b16 a[226:227], v220 offset:25600
    v_cvt_pk_bf16_f32 v96, v96, v97
    v_mfma_f32_16x16x32_bf16 v[4:7], a[156:159], v[140:143], v[4:7]
    ds_read_b64_tr_b16 a[196:197], v221 offset:16384
    v_add_f32 v238, v238, v98
    v_mfma_f32_16x16x32_bf16 v[8:11], a[160:163], v[128:131], v[192:195]
    v_exp_f32 v103, v103
    v_mfma_f32_16x16x32_bf16 v[8:11], a[164:167], v[132:135], v[8:11]
    ds_read_b64_tr_b16 a[198:199], v221 offset:17408
    v_add_f32 v238, v238, v99
    v_mfma_f32_16x16x32_bf16 v[8:11], a[168:171], v[136:139], v[8:11]
    v_exp_f32 v104, v104
    v_mfma_f32_16x16x32_bf16 v[8:11], a[172:175], v[140:143], v[8:11]
    ds_read_b64_tr_b16 a[228:229], v221 offset:24576
    v_cvt_pk_bf16_f32 v97, v98, v99
    v_mfma_f32_16x16x32_bf16 v[12:15], a[176:179], v[128:131], v[192:195]
    v_exp_f32 v105, v105
    v_mfma_f32_16x16x32_bf16 v[12:15], a[180:183], v[132:135], v[12:15]
    ds_read_b64_tr_b16 a[230:231], v221 offset:25600
    v_add_f32 v238, v238, v100
    v_mfma_f32_16x16x32_bf16 v[12:15], a[184:187], v[136:139], v[12:15]
    ds_read_b64_tr_b16 a[200:201], v222 offset:16384
    v_add_f32 v238, v238, v101
    v_mfma_f32_16x16x32_bf16 v[12:15], a[188:191], v[140:143], v[12:15]
    v_exp_f32 v106, v106
    v_mfma_f32_16x16x32_bf16 v[16:19], a[128:131], v[144:147], v[196:199]
    ds_read_b64_tr_b16 a[202:203], v222 offset:17408
    v_cvt_pk_bf16_f32 v98, v100, v101
    v_mfma_f32_16x16x32_bf16 v[16:19], a[132:135], v[148:151], v[16:19]
    v_exp_f32 v107, v107
    v_mfma_f32_16x16x32_bf16 v[16:19], a[136:139], v[152:155], v[16:19]
    ds_read_b64_tr_b16 a[232:233], v222 offset:24576
    v_add_f32 v238, v238, v102
    v_mfma_f32_16x16x32_bf16 v[16:19], a[140:143], v[156:159], v[16:19]
    v_exp_f32 v108, v108
    v_mfma_f32_16x16x32_bf16 v[20:23], a[144:147], v[144:147], v[196:199]
    ds_read_b64_tr_b16 a[234:235], v222 offset:25600
    v_add_f32 v238, v238, v103
    v_mfma_f32_16x16x32_bf16 v[20:23], a[148:151], v[148:151], v[20:23]
    ds_read_b64_tr_b16 a[204:205], v223 offset:16384
    v_cvt_pk_bf16_f32 v99, v102, v103
    v_mfma_f32_16x16x32_bf16 v[20:23], a[152:155], v[152:155], v[20:23]
    v_exp_f32 v109, v109
    v_mfma_f32_16x16x32_bf16 v[20:23], a[156:159], v[156:159], v[20:23]
    ds_read_b64_tr_b16 a[206:207], v223 offset:17408
    v_add_f32 v238, v238, v104
    v_mfma_f32_16x16x32_bf16 v[24:27], a[160:163], v[144:147], v[196:199]
    v_exp_f32 v110, v110
    v_mfma_f32_16x16x32_bf16 v[24:27], a[164:167], v[148:151], v[24:27]
    ds_read_b64_tr_b16 a[236:237], v223 offset:24576
    v_add_f32 v238, v238, v105
    v_mfma_f32_16x16x32_bf16 v[24:27], a[168:171], v[152:155], v[24:27]
    v_exp_f32 v111, v111
    v_mfma_f32_16x16x32_bf16 v[24:27], a[172:175], v[156:159], v[24:27]
    ds_read_b64_tr_b16 a[238:239], v223 offset:25600
    v_cvt_pk_bf16_f32 v104, v104, v105
    v_mfma_f32_16x16x32_bf16 v[28:31], a[176:179], v[144:147], v[196:199]
    ds_read_b64_tr_b16 a[208:209], v224 offset:16384
    v_add_f32 v238, v238, v106
    v_mfma_f32_16x16x32_bf16 v[28:31], a[180:183], v[148:151], v[28:31]
    v_exp_f32 v112, v112
    v_mfma_f32_16x16x32_bf16 v[28:31], a[184:187], v[152:155], v[28:31]
    ds_read_b64_tr_b16 a[210:211], v224 offset:17408
    v_add_f32 v238, v238, v107
    v_mfma_f32_16x16x32_bf16 v[28:31], a[188:191], v[156:159], v[28:31]
    v_exp_f32 v113, v113
    v_mfma_f32_16x16x32_bf16 v[32:35], a[128:131], v[160:163], v[200:203]
    ds_read_b64_tr_b16 a[240:241], v224 offset:24576
    v_cvt_pk_bf16_f32 v105, v106, v107
    v_mfma_f32_16x16x32_bf16 v[32:35], a[132:135], v[164:167], v[32:35]
    v_exp_f32 v114, v114
    v_mfma_f32_16x16x32_bf16 v[32:35], a[136:139], v[168:171], v[32:35]
    ds_read_b64_tr_b16 a[242:243], v224 offset:25600
    v_add_f32 v238, v238, v108
    v_mfma_f32_16x16x32_bf16 v[32:35], a[140:143], v[172:175], v[32:35]
    ds_read_b64_tr_b16 a[212:213], v225 offset:16384
    v_add_f32 v238, v238, v109
    v_mfma_f32_16x16x32_bf16 v[36:39], a[144:147], v[160:163], v[200:203]
    v_exp_f32 v115, v115
    v_mfma_f32_16x16x32_bf16 v[36:39], a[148:151], v[164:167], v[36:39]
    ds_read_b64_tr_b16 a[214:215], v225 offset:17408
    v_cvt_pk_bf16_f32 v106, v108, v109
    v_mfma_f32_16x16x32_bf16 v[36:39], a[152:155], v[168:171], v[36:39]
    v_exp_f32 v116, v116
    v_mfma_f32_16x16x32_bf16 v[36:39], a[156:159], v[172:175], v[36:39]
    ds_read_b64_tr_b16 a[244:245], v225 offset:24576
    v_add_f32 v238, v238, v110
    v_mfma_f32_16x16x32_bf16 v[40:43], a[160:163], v[160:163], v[200:203]
    v_exp_f32 v117, v117
    v_mfma_f32_16x16x32_bf16 v[40:43], a[164:167], v[164:167], v[40:43]
    ds_read_b64_tr_b16 a[246:247], v225 offset:25600
    v_add_f32 v238, v238, v111
    v_mfma_f32_16x16x32_bf16 v[40:43], a[168:171], v[168:171], v[40:43]
    ds_read_b64_tr_b16 a[216:217], v226 offset:16384
    v_cvt_pk_bf16_f32 v107, v110, v111
    v_mfma_f32_16x16x32_bf16 v[40:43], a[172:175], v[172:175], v[40:43]
    v_exp_f32 v118, v118
    v_mfma_f32_16x16x32_bf16 v[44:47], a[176:179], v[160:163], v[200:203]
    ds_read_b64_tr_b16 a[218:219], v226 offset:17408
    v_cvt_pk_bf16_f32 v112, v112, v113
    v_mfma_f32_16x16x32_bf16 v[44:47], a[180:183], v[164:167], v[44:47]
    v_exp_f32 v119, v119
    v_mfma_f32_16x16x32_bf16 v[44:47], a[184:187], v[168:171], v[44:47]
    ds_read_b64_tr_b16 a[248:249], v226 offset:24576
    v_cvt_pk_bf16_f32 v113, v114, v115
    v_mfma_f32_16x16x32_bf16 v[44:47], a[188:191], v[172:175], v[44:47]
    v_exp_f32 v120, v120
    v_mfma_f32_16x16x32_bf16 v[48:51], a[128:131], v[176:179], v[204:207]
    ds_read_b64_tr_b16 a[250:251], v226 offset:25600
    v_cvt_pk_bf16_f32 v114, v116, v117
    v_mfma_f32_16x16x32_bf16 v[48:51], a[132:135], v[180:183], v[48:51]
    ds_read_b64_tr_b16 a[220:221], v227 offset:16384
    v_cvt_pk_bf16_f32 v115, v118, v119
    v_mfma_f32_16x16x32_bf16 v[48:51], a[136:139], v[184:187], v[48:51]
    v_exp_f32 v121, v121
    v_mfma_f32_16x16x32_bf16 v[48:51], a[140:143], v[188:191], v[48:51]
    ds_read_b64_tr_b16 a[222:223], v227 offset:17408
    v_cvt_pk_bf16_f32 v120, v120, v121
    v_mfma_f32_16x16x32_bf16 v[52:55], a[144:147], v[176:179], v[204:207]
    v_exp_f32 v122, v122
    v_mfma_f32_16x16x32_bf16 v[52:55], a[148:151], v[180:183], v[52:55]
    v_exp_f32 v123, v123
    v_mfma_f32_16x16x32_bf16 v[52:55], a[152:155], v[184:187], v[52:55]
    ds_read_b64_tr_b16 a[252:253], v227 offset:24576
    v_cvt_pk_bf16_f32 v121, v122, v123
    v_mfma_f32_16x16x32_bf16 v[52:55], a[156:159], v[188:191], v[52:55]
    ds_read_b64_tr_b16 a[254:255], v227 offset:25600
    v_mfma_f32_16x16x32_bf16 v[56:59], a[160:163], v[176:179], v[204:207]
    v_exp_f32 v124, v124
    v_mfma_f32_16x16x32_bf16 v[56:59], a[164:167], v[180:183], v[56:59]
    v_exp_f32 v125, v125
    v_mfma_f32_16x16x32_bf16 v[56:59], a[168:171], v[184:187], v[56:59]
    v_exp_f32 v126, v126
    v_mfma_f32_16x16x32_bf16 v[56:59], a[172:175], v[188:191], v[56:59]
    v_exp_f32 v127, v127
    v_mfma_f32_16x16x32_bf16 v[60:63], a[176:179], v[176:179], v[204:207]
    s_cmp_eq_u32 s39, 0
    v_cvt_pk_bf16_f32 v122, v124, v125
    v_cvt_pk_bf16_f32 v123, v126, v127
    v_mfma_f32_16x16x32_bf16 v[60:63], a[180:183], v[180:183], v[60:63]
    s_cselect_b32 s42, s80, 1073741824
    s_cselect_b32 m0, s82, 162304
    v_mfma_f32_16x16x32_bf16 v[60:63], a[184:187], v[184:187], v[60:63]
    buffer_load_dwordx4 v254, s[76:79], s42 offen offset:0  lds
    v_mfma_f32_16x16x32_bf16 v[60:63], a[188:191], v[188:191], v[60:63]
    s_waitcnt vmcnt(19) lgkmcnt(0)
    s_barrier
    v_mfma_f32_16x16x32_bf16 a[0:3], a[192:195], v[64:67], a[0:3]
    v_exp_f32 v0, v0
    v_mfma_f32_16x16x32_bf16 a[0:3], a[224:227], v[72:75], a[0:3]
    v_exp_f32 v1, v1
    v_mfma_f32_16x16x32_bf16 a[4:7], a[196:199], v[64:67], a[4:7]
    v_add_f32 v236, v236, v0
    v_add_f32 v236, v236, v1
    v_mfma_f32_16x16x32_bf16 a[4:7], a[228:231], v[72:75], a[4:7]
    s_mov_b32 m0, s29
    v_exp_f32 v2, v2
    v_mfma_f32_16x16x32_bf16 a[8:11], a[200:203], v[64:67], a[8:11]
    buffer_load_dwordx4 v234, s[16:19], s33 offen offset:0  lds
    v_mfma_f32_16x16x32_bf16 a[8:11], a[232:235], v[72:75], a[8:11]
    ds_read_b128 a[128:131], v228 offset:49152
    v_cvt_pk_bf16_f32 v0, v0, v1
    v_mfma_f32_16x16x32_bf16 a[12:15], a[204:207], v[64:67], a[12:15]
    v_exp_f32 v3, v3
    v_mfma_f32_16x16x32_bf16 a[12:15], a[236:239], v[72:75], a[12:15]
    ds_read_b128 a[132:135], v229 offset:49152
    v_add_f32 v236, v236, v2
    v_mfma_f32_16x16x32_bf16 a[16:19], a[208:211], v[64:67], a[16:19]
    v_add_f32 v236, v236, v3
    v_cvt_pk_bf16_f32 v1, v2, v3
    v_mfma_f32_16x16x32_bf16 a[16:19], a[240:243], v[72:75], a[16:19]
    v_exp_f32 v4, v4
    v_mfma_f32_16x16x32_bf16 a[20:23], a[212:215], v[64:67], a[20:23]
    v_exp_f32 v5, v5
    v_mfma_f32_16x16x32_bf16 a[20:23], a[244:247], v[72:75], a[20:23]
    ds_read_b128 a[136:139], v230 offset:49152
    v_add_f32 v236, v236, v4
    v_mfma_f32_16x16x32_bf16 a[24:27], a[216:219], v[64:67], a[24:27]
    buffer_load_dwordx4 v234, s[16:19], s33 offen offset:1024  lds
    v_mfma_f32_16x16x32_bf16 a[24:27], a[248:251], v[72:75], a[24:27]
    v_add_f32 v236, v236, v5
    v_cvt_pk_bf16_f32 v2, v4, v5
    v_mfma_f32_16x16x32_bf16 a[28:31], a[220:223], v[64:67], a[28:31]
    v_exp_f32 v6, v6
    v_mfma_f32_16x16x32_bf16 a[28:31], a[252:255], v[72:75], a[28:31]
    ds_read_b128 a[140:143], v231 offset:49152
    v_add_f32 v236, v236, v6
    v_mfma_f32_16x16x32_bf16 a[32:35], a[192:195], v[80:83], a[32:35]
    v_exp_f32 v7, v7
    v_mfma_f32_16x16x32_bf16 a[32:35], a[224:227], v[88:91], a[32:35]
    v_add_f32 v236, v236, v7
    v_cvt_pk_bf16_f32 v3, v6, v7
    v_mfma_f32_16x16x32_bf16 a[36:39], a[196:199], v[80:83], a[36:39]
    v_exp_f32 v8, v8
    v_mfma_f32_16x16x32_bf16 a[36:39], a[228:231], v[88:91], a[36:39]
    ds_read_b128 a[144:147], v228 offset:50176
    v_add_f32 v236, v236, v8
    v_mfma_f32_16x16x32_bf16 a[40:43], a[200:203], v[80:83], a[40:43]
    buffer_load_dwordx4 v235, s[16:19], s33 offen offset:2048  lds
    v_mfma_f32_16x16x32_bf16 a[40:43], a[232:235], v[88:91], a[40:43]
    v_exp_f32 v9, v9
    v_mfma_f32_16x16x32_bf16 a[44:47], a[204:207], v[80:83], a[44:47]
    ds_read_b128 a[148:151], v229 offset:50176
    v_add_f32 v236, v236, v9
    v_mfma_f32_16x16x32_bf16 a[44:47], a[236:239], v[88:91], a[44:47]
    v_exp_f32 v10, v10
    v_mfma_f32_16x16x32_bf16 a[48:51], a[208:211], v[80:83], a[48:51]
    v_cvt_pk_bf16_f32 v8, v8, v9
    v_add_f32 v236, v236, v10
    v_mfma_f32_16x16x32_bf16 a[48:51], a[240:243], v[88:91], a[48:51]
    v_exp_f32 v11, v11
    v_mfma_f32_16x16x32_bf16 a[52:55], a[212:215], v[80:83], a[52:55]
    ds_read_b128 a[152:155], v230 offset:50176
    v_add_f32 v236, v236, v11
    v_mfma_f32_16x16x32_bf16 a[52:55], a[244:247], v[88:91], a[52:55]
    v_exp_f32 v12, v12
    v_mfma_f32_16x16x32_bf16 a[56:59], a[216:219], v[80:83], a[56:59]
    buffer_load_dwordx4 v235, s[16:19], s33 offen offset:3072  lds
    v_mfma_f32_16x16x32_bf16 a[56:59], a[248:251], v[88:91], a[56:59]
    ds_read_b128 a[156:159], v231 offset:50176
    v_cvt_pk_bf16_f32 v9, v10, v11
    v_mfma_f32_16x16x32_bf16 a[60:63], a[220:223], v[80:83], a[60:63]
    v_exp_f32 v13, v13
    v_mfma_f32_16x16x32_bf16 a[60:63], a[252:255], v[88:91], a[60:63]
    v_add_f32 v236, v236, v12
    v_add_f32 v236, v236, v13
    v_mfma_f32_16x16x32_bf16 v[208:211], v[216:219], v[80:83], v[208:211]
    ds_read_b128 a[160:163], v228 offset:57344
    v_cvt_pk_bf16_f32 v10, v12, v13
    v_mfma_f32_16x16x32_bf16 v[208:211], v[216:219], v[88:91], v[208:211]
    v_exp_f32 v14, v14
    v_mfma_f32_16x16x32_bf16 a[64:67], a[192:195], v[96:99], a[64:67]
    s_add_u32 s33, s33, 16384
    v_exp_f32 v15, v15
    v_mfma_f32_16x16x32_bf16 a[64:67], a[224:227], v[104:107], a[64:67]
    s_mov_b32 m0, s26
    v_exp_f32 v16, v16
    v_mfma_f32_16x16x32_bf16 a[68:71], a[196:199], v[96:99], a[68:71]
    buffer_load_dwordx4 v232, s[12:15], s32 offen offset:0  lds
    v_mfma_f32_16x16x32_bf16 a[68:71], a[228:231], v[104:107], a[68:71]
    ds_read_b128 a[164:167], v229 offset:57344
    v_add_f32 v236, v236, v14
    v_mfma_f32_16x16x32_bf16 a[72:75], a[200:203], v[96:99], a[72:75]
    v_add_f32 v236, v236, v15
    v_cvt_pk_bf16_f32 v11, v14, v15
    v_mfma_f32_16x16x32_bf16 a[72:75], a[232:235], v[104:107], a[72:75]
    v_exp_f32 v17, v17
    v_mfma_f32_16x16x32_bf16 a[76:79], a[204:207], v[96:99], a[76:79]
    ds_read_b128 a[168:171], v230 offset:57344
    v_cvt_pk_bf16_f32 v16, v16, v17
    v_mfma_f32_16x16x32_bf16 a[76:79], a[236:239], v[104:107], a[76:79]
    v_exp_f32 v18, v18
    v_mfma_f32_16x16x32_bf16 a[80:83], a[208:211], v[96:99], a[80:83]
    v_exp_f32 v19, v19
    v_mfma_f32_16x16x32_bf16 a[80:83], a[240:243], v[104:107], a[80:83]
    ds_read_b128 a[172:175], v231 offset:57344
    v_cvt_pk_bf16_f32 v17, v18, v19
    v_mfma_f32_16x16x32_bf16 a[84:87], a[212:215], v[96:99], a[84:87]
    buffer_load_dwordx4 v232, s[12:15], s32 offen offset:1024  lds
    v_mfma_f32_16x16x32_bf16 a[84:87], a[244:247], v[104:107], a[84:87]
    v_exp_f32 v20, v20
    v_mfma_f32_16x16x32_bf16 a[88:91], a[216:219], v[96:99], a[88:91]
    v_exp_f32 v21, v21
    v_mfma_f32_16x16x32_bf16 a[88:91], a[248:251], v[104:107], a[88:91]
    ds_read_b128 a[176:179], v228 offset:58368
    v_cvt_pk_bf16_f32 v18, v20, v21
    v_mfma_f32_16x16x32_bf16 a[92:95], a[220:223], v[96:99], a[92:95]
    v_exp_f32 v22, v22
    v_mfma_f32_16x16x32_bf16 a[92:95], a[252:255], v[104:107], a[92:95]
    v_exp_f32 v23, v23
    v_mfma_f32_16x16x32_bf16 a[96:99], a[192:195], v[112:115], a[96:99]
    ds_read_b128 a[180:183], v229 offset:58368
    v_cvt_pk_bf16_f32 v19, v22, v23
    v_mfma_f32_16x16x32_bf16 a[96:99], a[224:227], v[120:123], a[96:99]
    v_exp_f32 v24, v24
    v_mfma_f32_16x16x32_bf16 a[100:103], a[196:199], v[112:115], a[100:103]
    buffer_load_dwordx4 v233, s[12:15], s32 offen offset:2048  lds
    v_mfma_f32_16x16x32_bf16 a[100:103], a[228:231], v[120:123], a[100:103]
    v_exp_f32 v25, v25
    v_mfma_f32_16x16x32_bf16 a[104:107], a[200:203], v[112:115], a[104:107]
    ds_read_b128 a[184:187], v230 offset:58368
    v_cvt_pk_bf16_f32 v24, v24, v25
    v_mfma_f32_16x16x32_bf16 a[104:107], a[232:235], v[120:123], a[104:107]
    v_exp_f32 v26, v26
    v_mfma_f32_16x16x32_bf16 a[108:111], a[204:207], v[112:115], a[108:111]
    ds_read_b128 a[188:191], v231 offset:58368
    v_mfma_f32_16x16x32_bf16 a[108:111], a[236:239], v[120:123], a[108:111]
    v_exp_f32 v27, v27
    v_mfma_f32_16x16x32_bf16 a[112:115], a[208:211], v[112:115], a[112:115]
    v_exp_f32 v28, v28
    v_mfma_f32_16x16x32_bf16 a[112:115], a[240:243], v[120:123], a[112:115]
    v_exp_f32 v29, v29
    v_mfma_f32_16x16x32_bf16 a[116:119], a[212:215], v[112:115], a[116:119]
    buffer_load_dwordx4 v233, s[12:15], s32 offen offset:3072  lds
    v_mfma_f32_16x16x32_bf16 a[116:119], a[244:247], v[120:123], a[116:119]
    s_add_u32 s32, s32, 16384
    v_exp_f32 v30, v30
    v_mfma_f32_16x16x32_bf16 a[120:123], a[216:219], v[112:115], a[120:123]
    v_cvt_pk_bf16_f32 v25, v26, v27
    v_cvt_pk_bf16_f32 v26, v28, v29
    v_mfma_f32_16x16x32_bf16 a[120:123], a[248:251], v[120:123], a[120:123]
    v_exp_f32 v31, v31
    v_mfma_f32_16x16x32_bf16 a[124:127], a[220:223], v[112:115], a[124:127]
    v_exp_f32 v32, v32
    v_mfma_f32_16x16x32_bf16 a[124:127], a[252:255], v[120:123], a[124:127]
    v_exp_f32 v33, v33
    v_mfma_f32_16x16x32_bf16 v[212:215], v[216:219], v[112:115], v[212:215]
    v_exp_f32 v34, v34
    v_mfma_f32_16x16x32_bf16 v[212:215], v[216:219], v[120:123], v[212:215]
    s_waitcnt lgkmcnt(0)
    v_exp_f32 v35, v35
    v_mfma_f32_16x16x32_bf16 v[64:67], a[128:131], v[128:131], v[192:195]
    ds_read_b64_tr_b16 a[192:193], v220 offset:32768
    v_cvt_pk_bf16_f32 v27, v30, v31
    v_mfma_f32_16x16x32_bf16 v[64:67], a[132:135], v[132:135], v[64:67]
    v_exp_f32 v36, v36
    v_mfma_f32_16x16x32_bf16 v[64:67], a[136:139], v[136:139], v[64:67]
    ds_read_b64_tr_b16 a[194:195], v220 offset:33792
    v_add_f32 v238, v238, v32
    v_mfma_f32_16x16x32_bf16 v[64:67], a[140:143], v[140:143], v[64:67]
    v_exp_f32 v37, v37
    v_mfma_f32_16x16x32_bf16 v[68:71], a[144:147], v[128:131], v[192:195]
    ds_read_b64_tr_b16 a[224:225], v220 offset:40960
    v_add_f32 v238, v238, v33
    v_mfma_f32_16x16x32_bf16 v[68:71], a[148:151], v[132:135], v[68:71]
    v_exp_f32 v38, v38
    v_mfma_f32_16x16x32_bf16 v[68:71], a[152:155], v[136:139], v[68:71]
    ds_read_b64_tr_b16 a[226:227], v220 offset:41984
    v_cvt_pk_bf16_f32 v32, v32, v33
    v_mfma_f32_16x16x32_bf16 v[68:71], a[156:159], v[140:143], v[68:71]
    ds_read_b64_tr_b16 a[196:197], v221 offset:32768
    v_add_f32 v238, v238, v34
    v_mfma_f32_16x16x32_bf16 v[72:75], a[160:163], v[128:131], v[192:195]
    v_exp_f32 v39, v39
    v_mfma_f32_16x16x32_bf16 v[72:75], a[164:167], v[132:135], v[72:75]
    ds_read_b64_tr_b16 a[198:199], v221 offset:33792
    v_add_f32 v238, v238, v35
    v_mfma_f32_16x16x32_bf16 v[72:75], a[168:171], v[136:139], v[72:75]
L_ix0:
    s_cbranch_execz L_iwr1
    v_exp_f32 v40, v40
    v_mfma_f32_16x16x32_bf16 v[72:75], a[172:175], v[140:143], v[72:75]
    ds_read_b64_tr_b16 a[228:229], v221 offset:40960
    v_cvt_pk_bf16_f32 v33, v34, v35
    v_mfma_f32_16x16x32_bf16 v[76:79], a[176:179], v[128:131], v[192:195]
    v_exp_f32 v41, v41
    v_mfma_f32_16x16x32_bf16 v[76:79], a[180:183], v[132:135], v[76:79]
    ds_read_b64_tr_b16 a[230:231], v221 offset:41984
    v_add_f32 v238, v238, v36
    v_mfma_f32_16x16x32_bf16 v[76:79], a[184:187], v[136:139], v[76:79]
    ds_read_b64_tr_b16 a[200:201], v222 offset:32768
    v_add_f32 v238, v238, v37
    v_mfma_f32_16x16x32_bf16 v[76:79], a[188:191], v[140:143], v[76:79]
    v_exp_f32 v42, v42
    v_mfma_f32_16x16x32_bf16 v[80:83], a[128:131], v[144:147], v[196:199]
    ds_read_b64_tr_b16 a[202:203], v222 offset:33792
    v_cvt_pk_bf16_f32 v34, v36, v37
    v_mfma_f32_16x16x32_bf16 v[80:83], a[132:135], v[148:151], v[80:83]
    v_exp_f32 v43, v43
    v_mfma_f32_16x16x32_bf16 v[80:83], a[136:139], v[152:155], v[80:83]
    ds_read_b64_tr_b16 a[232:233], v222 offset:40960
    v_add_f32 v238, v238, v38
    v_mfma_f32_16x16x32_bf16 v[80:83], a[140:143], v[156:159], v[80:83]
    v_exp_f32 v44, v44
    v_mfma_f32_16x16x32_bf16 v[84:87], a[144:147], v[144:147], v[196:199]
    ds_read_b64_tr_b16 a[234:235], v222 offset:41984
    v_add_f32 v238, v238, v39
    v_mfma_f32_16x16x32_bf16 v[84:87], a[148:151], v[148:151], v[84:87]
    ds_read_b64_tr_b16 a[204:205], v223 offset:32768
    v_cvt_pk_bf16_f32 v35, v38, v39
    v_mfma_f32_16x16x32_bf16 v[84:87], a[152:155], v[152:155], v[84:87]
    v_exp_f32 v45, v45
    v_mfma_f32_16x16x32_bf16 v[84:87], a[156:159], v[156:159], v[84:87]
    ds_read_b64_tr_b16 a[206:207], v223 offset:33792
    v_add_f32 v238, v238, v40
    v_mfma_f32_16x16x32_bf16 v[88:91], a[160:163], v[144:147], v[196:199]
    v_exp_f32 v46, v46
    v_mfma_f32_16x16x32_bf16 v[88:91], a[164:167], v[148:151], v[88:91]
    ds_read_b64_tr_b16 a[236:237], v223 offset:40960
    v_add_f32 v238, v238, v41
    v_mfma_f32_16x16x32_bf16 v[88:91], a[168:171], v[152:155], v[88:91]
    v_exp_f32 v47, v47
    v_mfma_f32_16x16x32_bf16 v[88:91], a[172:175], v[156:159], v[88:91]
    ds_read_b64_tr_b16 a[238:239], v223 offset:41984
    v_cvt_pk_bf16_f32 v40, v40, v41
    v_mfma_f32_16x16x32_bf16 v[92:95], a[176:179], v[144:147], v[196:199]
    ds_read_b64_tr_b16 a[208:209], v224 offset:32768
    v_add_f32 v238, v238, v42
    v_mfma_f32_16x16x32_bf16 v[92:95], a[180:183], v[148:151], v[92:95]
    v_exp_f32 v48, v48
    v_mfma_f32_16x16x32_bf16 v[92:95], a[184:187], v[152:155], v[92:95]
    ds_read_b64_tr_b16 a[210:211], v224 offset:33792
    v_add_f32 v238, v238, v43
    v_mfma_f32_16x16x32_bf16 v[92:95], a[188:191], v[156:159], v[92:95]
    v_exp_f32 v49, v49
    v_mfma_f32_16x16x32_bf16 v[96:99], a[128:131], v[160:163], v[200:203]
    ds_read_b64_tr_b16 a[240:241], v224 offset:40960
    v_cvt_pk_bf16_f32 v41, v42, v43
    v_mfma_f32_16x16x32_bf16 v[96:99], a[132:135], v[164:167], v[96:99]
    v_exp_f32 v50, v50
    v_mfma_f32_16x16x32_bf16 v[96:99], a[136:139], v[168:171], v[96:99]
    ds_read_b64_tr_b16 a[242:243], v224 offset:41984
    v_add_f32 v238, v238, v44
    v_mfma_f32_16x16x32_bf16 v[96:99], a[140:143], v[172:175], v[96:99]
    ds_read_b64_tr_b16 a[212:213], v225 offset:32768
    v_add_f32 v238, v238, v45
    v_mfma_f32_16x16x32_bf16 v[100:103], a[144:147], v[160:163], v[200:203]
    v_exp_f32 v51, v51
    v_mfma_f32_16x16x32_bf16 v[100:103], a[148:151], v[164:167], v[100:103]
    ds_read_b64_tr_b16 a[214:215], v225 offset:33792
    v_cvt_pk_bf16_f32 v42, v44, v45
    v_mfma_f32_16x16x32_bf16 v[100:103], a[152:155], v[168:171], v[100:103]
    v_exp_f32 v52, v52
    v_mfma_f32_16x16x32_bf16 v[100:103], a[156:159], v[172:175], v[100:103]
    ds_read_b64_tr_b16 a[244:245], v225 offset:40960
    v_add_f32 v238, v238, v46
    v_mfma_f32_16x16x32_bf16 v[104:107], a[160:163], v[160:163], v[200:203]
    v_exp_f32 v53, v53
    v_mfma_f32_16x16x32_bf16 v[104:107], a[164:167], v[164:167], v[104:107]
    ds_read_b64_tr_b16 a[246:247], v225 offset:41984
    v_add_f32 v238, v238, v47
    v_mfma_f32_16x16x32_bf16 v[104:107], a[168:171], v[168:171], v[104:107]
    ds_read_b64_tr_b16 a[216:217], v226 offset:32768
    v_cvt_pk_bf16_f32 v43, v46, v47
    v_mfma_f32_16x16x32_bf16 v[104:107], a[172:175], v[172:175], v[104:107]
    v_exp_f32 v54, v54
    v_mfma_f32_16x16x32_bf16 v[108:111], a[176:179], v[160:163], v[200:203]
    ds_read_b64_tr_b16 a[218:219], v226 offset:33792
    v_cvt_pk_bf16_f32 v48, v48, v49
    v_mfma_f32_16x16x32_bf16 v[108:111], a[180:183], v[164:167], v[108:111]
    v_exp_f32 v55, v55
    v_mfma_f32_16x16x32_bf16 v[108:111], a[184:187], v[168:171], v[108:111]
    ds_read_b64_tr_b16 a[248:249], v226 offset:40960
    v_cvt_pk_bf16_f32 v49, v50, v51
    v_mfma_f32_16x16x32_bf16 v[108:111], a[188:191], v[172:175], v[108:111]
    v_exp_f32 v56, v56
    v_mfma_f32_16x16x32_bf16 v[112:115], a[128:131], v[176:179], v[204:207]
    ds_read_b64_tr_b16 a[250:251], v226 offset:41984
    v_cvt_pk_bf16_f32 v50, v52, v53
    v_mfma_f32_16x16x32_bf16 v[112:115], a[132:135], v[180:183], v[112:115]
    ds_read_b64_tr_b16 a[220:221], v227 offset:32768
    v_cvt_pk_bf16_f32 v51, v54, v55
    v_mfma_f32_16x16x32_bf16 v[112:115], a[136:139], v[184:187], v[112:115]
    v_exp_f32 v57, v57
    v_mfma_f32_16x16x32_bf16 v[112:115], a[140:143], v[188:191], v[112:115]
    ds_read_b64_tr_b16 a[222:223], v227 offset:33792
    v_cvt_pk_bf16_f32 v56, v56, v57
    v_mfma_f32_16x16x32_bf16 v[116:119], a[144:147], v[176:179], v[204:207]
    v_exp_f32 v58, v58
    v_mfma_f32_16x16x32_bf16 v[116:119], a[148:151], v[180:183], v[116:119]
    v_exp_f32 v59, v59
    v_mfma_f32_16x16x32_bf16 v[116:119], a[152:155], v[184:187], v[116:119]
    ds_read_b64_tr_b16 a[252:253], v227 offset:40960
    v_cvt_pk_bf16_f32 v57, v58, v59
    v_mfma_f32_16x16x32_bf16 v[116:119], a[156:159], v[188:191], v[116:119]
    ds_read_b64_tr_b16 a[254:255], v227 offset:41984
    v_mfma_f32_16x16x32_bf16 v[120:123], a[160:163], v[176:179], v[204:207]
    v_exp_f32 v60, v60
    v_mfma_f32_16x16x32_bf16 v[120:123], a[164:167], v[180:183], v[120:123]
    v_exp_f32 v61, v61
    v_mfma_f32_16x16x32_bf16 v[120:123], a[168:171], v[184:187], v[120:123]
    v_exp_f32 v62, v62
    v_mfma_f32_16x16x32_bf16 v[120:123], a[172:175], v[188:191], v[120:123]
    v_exp_f32 v63, v63
    v_mfma_f32_16x16x32_bf16 v[124:127], a[176:179], v[176:179], v[204:207]
    s_cmp_eq_u32 s39, 1
    v_cvt_pk_bf16_f32 v58, v60, v61
    v_cvt_pk_bf16_f32 v59, v62, v63
    v_mfma_f32_16x16x32_bf16 v[124:127], a[180:183], v[180:183], v[124:127]
    s_cselect_b32 s42, s80, 1073741824
    s_cselect_b32 m0, s82, 162304
    v_mfma_f32_16x16x32_bf16 v[124:127], a[184:187], v[184:187], v[124:127]
    buffer_load_dwordx4 v254, s[76:79], s42 offen offset:0  lds
    v_mfma_f32_16x16x32_bf16 v[124:127], a[188:191], v[188:191], v[124:127]
    s_waitcnt vmcnt(19) lgkmcnt(0)
    s_barrier
    v_mfma_f32_16x16x32_bf16 a[0:3], a[192:195], v[0:3], a[0:3]
    v_exp_f32 v64, v64
    v_mfma_f32_16x16x32_bf16 a[0:3], a[224:227], v[8:11], a[0:3]
    v_exp_f32 v65, v65
    v_mfma_f32_16x16x32_bf16 a[4:7], a[196:199], v[0:3], a[4:7]
    v_add_f32 v236, v236, v64
    v_add_f32 v236, v236, v65
    v_mfma_f32_16x16x32_bf16 a[4:7], a[228:231], v[8:11], a[4:7]
    s_mov_b32 m0, s30
    v_exp_f32 v66, v66
    v_mfma_f32_16x16x32_bf16 a[8:11], a[200:203], v[0:3], a[8:11]
    buffer_load_dwordx4 v234, s[16:19], s33 offen offset:0  lds
    v_mfma_f32_16x16x32_bf16 a[8:11], a[232:235], v[8:11], a[8:11]
    ds_read_b128 a[128:131], v228 offset:0
    v_cvt_pk_bf16_f32 v64, v64, v65
    v_mfma_f32_16x16x32_bf16 a[12:15], a[204:207], v[0:3], a[12:15]
    v_exp_f32 v67, v67
    v_mfma_f32_16x16x32_bf16 a[12:15], a[236:239], v[8:11], a[12:15]
    ds_read_b128 a[132:135], v229 offset:0
    v_add_f32 v236, v236, v66
    v_mfma_f32_16x16x32_bf16 a[16:19], a[208:211], v[0:3], a[16:19]
    v_add_f32 v236, v236, v67
    v_cvt_pk_bf16_f32 v65, v66, v67
    v_mfma_f32_16x16x32_bf16 a[16:19], a[240:243], v[8:11], a[16:19]
    v_exp_f32 v68, v68
    v_mfma_f32_16x16x32_bf16 a[20:23], a[212:215], v[0:3], a[20:23]
    v_exp_f32 v69, v69
    v_mfma_f32_16x16x32_bf16 a[20:23], a[244:247], v[8:11], a[20:23]
    ds_read_b128 a[136:139], v230 offset:0
    v_add_f32 v236, v236, v68
    v_mfma_f32_16x16x32_bf16 a[24:27], a[216:219], v[0:3], a[24:27]
    buffer_load_dwordx4 v234, s[16:19], s33 offen offset:1024  lds
    v_mfma_f32_16x16x32_bf16 a[24:27], a[248:251], v[8:11], a[24:27]
    v_add_f32 v236, v236, v69
    v_cvt_pk_bf16_f32 v66, v68, v69
    v_mfma_f32_16x16x32_bf16 a[28:31], a[220:223], v[0:3], a[28:31]
    v_exp_f32 v70, v70
    v_mfma_f32_16x16x32_bf16 a[28:31], a[252:255], v[8:11], a[28:31]
    ds_read_b128 a[140:143], v231 offset:0
    v_add_f32 v236, v236, v70
    v_mfma_f32_16x16x32_bf16 a[32:35], a[192:195], v[16:19], a[32:35]
    v_exp_f32 v71, v71
    v_mfma_f32_16x16x32_bf16 a[32:35], a[224:227], v[24:27], a[32:35]
    v_add_f32 v236, v236, v71
    v_cvt_pk_bf16_f32 v67, v70, v71
    v_mfma_f32_16x16x32_bf16 a[36:39], a[196:199], v[16:19], a[36:39]
    v_exp_f32 v72, v72
    v_mfma_f32_16x16x32_bf16 a[36:39], a[228:231], v[24:27], a[36:39]
    ds_read_b128 a[144:147], v228 offset:1024
    v_add_f32 v236, v236, v72
    v_mfma_f32_16x16x32_bf16 a[40:43], a[200:203], v[16:19], a[40:43]
    buffer_load_dwordx4 v235, s[16:19], s33 offen offset:2048  lds
    v_mfma_f32_16x16x32_bf16 a[40:43], a[232:235], v[24:27], a[40:43]
    v_exp_f32 v73, v73
    v_mfma_f32_16x16x32_bf16 a[44:47], a[204:207], v[16:19], a[44:47]
    ds_read_b128 a[148:151], v229 offset:1024
    v_add_f32 v236, v236, v73
    v_mfma_f32_16x16x32_bf16 a[44:47], a[236:239], v[24:27], a[44:47]
    v_exp_f32 v74, v74
    v_mfma_f32_16x16x32_bf16 a[48:51], a[208:211], v[16:19], a[48:51]
    v_cvt_pk_bf16_f32 v72, v72, v73
    v_add_f32 v236, v236, v74
    v_mfma_f32_16x16x32_bf16 a[48:51], a[240:243], v[24:27], a[48:51]
    v_exp_f32 v75, v75
    v_mfma_f32_16x16x32_bf16 a[52:55], a[212:215], v[16:19], a[52:55]
    ds_read_b128 a[152:155], v230 offset:1024
    v_add_f32 v236, v236, v75
    v_mfma_f32_16x16x32_bf16 a[52:55], a[244:247], v[24:27], a[52:55]
    v_exp_f32 v76, v76
    v_mfma_f32_16x16x32_bf16 a[56:59], a[216:219], v[16:19], a[56:59]
    buffer_load_dwordx4 v235, s[16:19], s33 offen offset:3072  lds
    v_mfma_f32_16x16x32_bf16 a[56:59], a[248:251], v[24:27], a[56:59]
    ds_read_b128 a[156:159], v231 offset:1024
    v_cvt_pk_bf16_f32 v73, v74, v75
    v_mfma_f32_16x16x32_bf16 a[60:63], a[220:223], v[16:19], a[60:63]
    v_exp_f32 v77, v77
    v_mfma_f32_16x16x32_bf16 a[60:63], a[252:255], v[24:27], a[60:63]
    v_add_f32 v236, v236, v76
    v_add_f32 v236, v236, v77
    v_mfma_f32_16x16x32_bf16 v[208:211], v[216:219], v[16:19], v[208:211]
    ds_read_b128 a[160:163], v228 offset:8192
    v_cvt_pk_bf16_f32 v74, v76, v77
    v_mfma_f32_16x16x32_bf16 v[208:211], v[216:219], v[24:27], v[208:211]
    v_exp_f32 v78, v78
    v_mfma_f32_16x16x32_bf16 a[64:67], a[192:195], v[32:35], a[64:67]
    s_add_u32 s33, s33, 16384
    v_exp_f32 v79, v79
    v_mfma_f32_16x16x32_bf16 a[64:67], a[224:227], v[40:43], a[64:67]
    s_mov_b32 m0, s27
    v_exp_f32 v80, v80
    v_mfma_f32_16x16x32_bf16 a[68:71], a[196:199], v[32:35], a[68:71]
    buffer_load_dwordx4 v232, s[12:15], s32 offen offset:0  lds
    v_mfma_f32_16x16x32_bf16 a[68:71], a[228:231], v[40:43], a[68:71]
    ds_read_b128 a[164:167], v229 offset:8192
    v_add_f32 v236, v236, v78
    v_mfma_f32_16x16x32_bf16 a[72:75], a[200:203], v[32:35], a[72:75]
    v_add_f32 v236, v236, v79
    v_cvt_pk_bf16_f32 v75, v78, v79
    v_mfma_f32_16x16x32_bf16 a[72:75], a[232:235], v[40:43], a[72:75]
    v_exp_f32 v81, v81
    v_mfma_f32_16x16x32_bf16 a[76:79], a[204:207], v[32:35], a[76:79]
    ds_read_b128 a[168:171], v230 offset:8192
    v_cvt_pk_bf16_f32 v80, v80, v81
    v_mfma_f32_16x16x32_bf16 a[76:79], a[236:239], v[40:43], a[76:79]
    v_exp_f32 v82, v82
    v_mfma_f32_16x16x32_bf16 a[80:83], a[208:211], v[32:35], a[80:83]
    v_exp_f32 v83, v83
    v_mfma_f32_16x16x32_bf16 a[80:83], a[240:243], v[40:43], a[80:83]
    ds_read_b128 a[172:175], v231 offset:8192
    v_cvt_pk_bf16_f32 v81, v82, v83
    v_mfma_f32_16x16x32_bf16 a[84:87], a[212:215], v[32:35], a[84:87]
    buffer_load_dwordx4 v232, s[12:15], s32 offen offset:1024  lds
    v_mfma_f32_16x16x32_bf16 a[84:87], a[244:247], v[40:43], a[84:87]
    v_exp_f32 v84, v84
    v_mfma_f32_16x16x32_bf16 a[88:91], a[216:219], v[32:35], a[88:91]
    v_exp_f32 v85, v85
    v_mfma_f32_16x16x32_bf16 a[88:91], a[248:251], v[40:43], a[88:91]
    ds_read_b128 a[176:179], v228 offset:9216
    v_cvt_pk_bf16_f32 v82, v84, v85
    v_mfma_f32_16x16x32_bf16 a[92:95], a[220:223], v[32:35], a[92:95]
    v_exp_f32 v86, v86
    v_mfma_f32_16x16x32_bf16 a[92:95], a[252:255], v[40:43], a[92:95]
    v_exp_f32 v87, v87
    v_mfma_f32_16x16x32_bf16 a[96:99], a[192:195], v[48:51], a[96:99]
    ds_read_b128 a[180:183], v229 offset:9216
    v_cvt_pk_bf16_f32 v83, v86, v87
    v_mfma_f32_16x16x32_bf16 a[96:99], a[224:227], v[56:59], a[96:99]
    v_exp_f32 v88, v88
    v_mfma_f32_16x16x32_bf16 a[100:103], a[196:199], v[48:51], a[100:103]
    buffer_load_dwordx4 v233, s[12:15], s32 offen offset:2048  lds
    v_mfma_f32_16x16x32_bf16 a[100:103], a[228:231], v[56:59], a[100:103]
    v_exp_f32 v89, v89
    v_mfma_f32_16x16x32_bf16 a[104:107], a[200:203], v[48:51], a[104:107]
    ds_read_b128 a[184:187], v230 offset:9216
    v_cvt_pk_bf16_f32 v88, v88, v89
    v_mfma_f32_16x16x32_bf16 a[104:107], a[232:235], v[56:59], a[104:107]
    v_exp_f32 v90, v90
    v_mfma_f32_16x16x32_bf16 a[108:111], a[204:207], v[48:51], a[108:111]
    ds_read_b128 a[188:191], v231 offset:9216
    v_mfma_f32_16x16x32_bf16 a[108:111], a[236:239], v[56:59], a[108:111]
    v_exp_f32 v91, v91
    v_mfma_f32_16x16x32_bf16 a[112:115], a[208:211], v[48:51], a[112:115]
    v_exp_f32 v92, v92
    v_mfma_f32_16x16x32_bf16 a[112:115], a[240:243], v[56:59], a[112:115]
    v_exp_f32 v93, v93
    v_mfma_f32_16x16x32_bf16 a[116:119], a[212:215], v[48:51], a[116:119]
    buffer_load_dwordx4 v233, s[12:15], s32 offen offset:3072  lds
    v_mfma_f32_16x16x32_bf16 a[116:119], a[244:247], v[56:59], a[116:119]
    s_add_u32 s32, s32, 16384
    v_exp_f32 v94, v94
    v_mfma_f32_16x16x32_bf16 a[120:123], a[216:219], v[48:51], a[120:123]
    v_cvt_pk_bf16_f32 v89, v90, v91
    v_cvt_pk_bf16_f32 v90, v92, v93
    v_mfma_f32_16x16x32_bf16 a[120:123], a[248:251], v[56:59], a[120:123]
    v_exp_f32 v95, v95
    v_mfma_f32_16x16x32_bf16 a[124:127], a[220:223], v[48:51], a[124:127]
    v_exp_f32 v96, v96
    v_mfma_f32_16x16x32_bf16 a[124:127], a[252:255], v[56:59], a[124:127]
    v_exp_f32 v97, v97
    v_mfma_f32_16x16x32_bf16 v[212:215], v[216:219], v[48:51], v[212:215]
    v_exp_f32 v98, v98
    v_mfma_f32_16x16x32_bf16 v[212:215], v[216:219], v[56:59], v[212:215]
    s_waitcnt lgkmcnt(0)
    v_exp_f32 v99, v99
    v_mfma_f32_16x16x32_bf16 v[0:3], a[128:131], v[128:131], v[192:195]
    ds_read_b64_tr_b16 a[192:193], v220 offset:49152
    v_cvt_pk_bf16_f32 v91, v94, v95
    v_mfma_f32_16x16x32_bf16 v[0:3], a[132:135], v[132:135], v[0:3]
    v_exp_f32 v100, v100
    v_mfma_f32_16x16x32_bf16 v[0:3], a[136:139], v[136:139], v[0:3]
    ds_read_b64_tr_b16 a[194:195], v220 offset:50176
    v_add_f32 v238, v238, v96
    v_mfma_f32_16x16x32_bf16 v[0:3], a[140:143], v[140:143], v[0:3]
    v_exp_f32 v101, v101
    v_mfma_f32_16x16x32_bf16 v[4:7], a[144:147], v[128:131], v[192:195]
    ds_read_b64_tr_b16 a[224:225], v220 offset:57344
    v_add_f32 v238, v238, v97
    v_mfma_f32_16x16x32_bf16 v[4:7], a[148:151], v[132:135], v[4:7]
    v_exp_f32 v102, v102
    v_mfma_f32_16x16x32_bf16 v[4:7], a[152:155], v[136:139], v[4:7]
    ds_read_b64_tr_b16 a[226:227], v220 offset:58368
    v_cvt_pk_bf16_f32 v96, v96, v97
    v_mfma_f32_16x16x32_bf16 v[4:7], a[156:159], v[140:143], v[4:7]
    ds_read_b64_tr_b16 a[196:197], v221 offset:49152
    v_add_f32 v238, v238, v98
    v_mfma_f32_16x16x32_bf16 v[8:11], a[160:163], v[128:131], v[192:195]
    v_exp_f32 v103, v103
    v_mfma_f32_16x16x32_bf16 v[8:11], a[164:167], v[132:135], v[8:11]
    ds_read_b64_tr_b16 a[198:199], v221 offset:50176
    v_add_f32 v238, v238, v99
    v_mfma_f32_16x16x32_bf16 v[8:11], a[168:171], v[136:139], v[8:11]
    v_exp_f32 v104, v104
    v_mfma_f32_16x16x32_bf16 v[8:11], a[172:175], v[140:143], v[8:11]
    ds_read_b64_tr_b16 a[228:229], v221 offset:57344
    v_cvt_pk_bf16_f32 v97, v98, v99
    v_mfma_f32_16x16x32_bf16 v[12:15], a[176:179], v[128:131], v[192:195]
    v_exp_f32 v105, v105
    v_mfma_f32_16x16x32_bf16 v[12:15], a[180:183], v[132:135], v[12:15]
    ds_read_b64_tr_b16 a[230:231], v221 offset:58368
    v_add_f32 v238, v238, v100
    v_mfma_f32_16x16x32_bf16 v[12:15], a[184:187], v[136:139], v[12:15]
    ds_read_b64_tr_b16 a[200:201], v222 offset:49152
    v_add_f32 v238, v238, v101
    v_mfma_f32_16x16x32_bf16 v[12:15], a[188:191], v[140:143], v[12:15]
    v_exp_f32 v106, v106
    v_mfma_f32_16x16x32_bf16 v[16:19], a[128:131], v[144:147], v[196:199]
    ds_read_b64_tr_b16 a[202:203], v222 offset:50176
    v_cvt_pk_bf16_f32 v98, v100, v101
    v_mfma_f32_16x16x32_bf16 v[16:19], a[132:135], v[148:151], v[16:19]
    v_exp_f32 v107, v107
    v_mfma_f32_16x16x32_bf16 v[16:19], a[136:139], v[152:155], v[16:19]
    ds_read_b64_tr_b16 a[232:233], v222 offset:57344
    v_add_f32 v238, v238, v102
    v_mfma_f32_16x16x32_bf16 v[16:19], a[140:143], v[156:159], v[16:19]
    v_exp_f32 v108, v108
    v_mfma_f32_16x16x32_bf16 v[20:23], a[144:147], v[144:147], v[196:199]
    ds_read_b64_tr_b16 a[234:235], v222 offset:58368
    v_add_f32 v238, v238, v103
    v_mfma_f32_16x16x32_bf16 v[20:23], a[148:151], v[148:151], v[20:23]
    ds_read_b64_tr_b16 a[204:205], v223 offset:49152
    v_cvt_pk_bf16_f32 v99, v102, v103
    v_mfma_f32_16x16x32_bf16 v[20:23], a[152:155], v[152:155], v[20:23]
    v_exp_f32 v109, v109
    v_mfma_f32_16x16x32_bf16 v[20:23], a[156:159], v[156:159], v[20:23]
    ds_read_b64_tr_b16 a[206:207], v223 offset:50176
    v_add_f32 v238, v238, v104
    v_mfma_f32_16x16x32_bf16 v[24:27], a[160:163], v[144:147], v[196:199]
    v_exp_f32 v110, v110
    v_mfma_f32_16x16x32_bf16 v[24:27], a[164:167], v[148:151], v[24:27]
    ds_read_b64_tr_b16 a[236:237], v223 offset:57344
    v_add_f32 v238, v238, v105
    v_mfma_f32_16x16x32_bf16 v[24:27], a[168:171], v[152:155], v[24:27]
    v_exp_f32 v111, v111
    v_mfma_f32_16x16x32_bf16 v[24:27], a[172:175], v[156:159], v[24:27]
    ds_read_b64_tr_b16 a[238:239], v223 offset:58368
    v_cvt_pk_bf16_f32 v104, v104, v105
    v_mfma_f32_16x16x32_bf16 v[28:31], a[176:179], v[144:147], v[196:199]
    ds_read_b64_tr_b16 a[208:209], v224 offset:49152
    v_add_f32 v238, v238, v106
    v_mfma_f32_16x16x32_bf16 v[28:31], a[180:183], v[148:151], v[28:31]
    v_exp_f32 v112, v112
    v_mfma_f32_16x16x32_bf16 v[28:31], a[184:187], v[152:155], v[28:31]
    ds_read_b64_tr_b16 a[210:211], v224 offset:50176
    v_add_f32 v238, v238, v107
    v_mfma_f32_16x16x32_bf16 v[28:31], a[188:191], v[156:159], v[28:31]
    v_exp_f32 v113, v113
    v_mfma_f32_16x16x32_bf16 v[32:35], a[128:131], v[160:163], v[200:203]
    ds_read_b64_tr_b16 a[240:241], v224 offset:57344
    v_cvt_pk_bf16_f32 v105, v106, v107
    v_mfma_f32_16x16x32_bf16 v[32:35], a[132:135], v[164:167], v[32:35]
    v_exp_f32 v114, v114
    v_mfma_f32_16x16x32_bf16 v[32:35], a[136:139], v[168:171], v[32:35]
    ds_read_b64_tr_b16 a[242:243], v224 offset:58368
    v_add_f32 v238, v238, v108
    v_mfma_f32_16x16x32_bf16 v[32:35], a[140:143], v[172:175], v[32:35]
    ds_read_b64_tr_b16 a[212:213], v225 offset:49152
    v_add_f32 v238, v238, v109
    v_mfma_f32_16x16x32_bf16 v[36:39], a[144:147], v[160:163], v[200:203]
    v_exp_f32 v115, v115
    v_mfma_f32_16x16x32_bf16 v[36:39], a[148:151], v[164:167], v[36:39]
    ds_read_b64_tr_b16 a[214:215], v225 offset:50176
    v_cvt_pk_bf16_f32 v106, v108, v109
    v_mfma_f32_16x16x32_bf16 v[36:39], a[152:155], v[168:171], v[36:39]
    v_exp_f32 v116, v116
    v_mfma_f32_16x16x32_bf16 v[36:39], a[156:159], v[172:175], v[36:39]
    ds_read_b64_tr_b16 a[244:245], v225 offset:57344
    v_add_f32 v238, v238, v110
    v_mfma_f32_16x16x32_bf16 v[40:43], a[160:163], v[160:163], v[200:203]
    v_exp_f32 v117, v117
    v_mfma_f32_16x16x32_bf16 v[40:43], a[164:167], v[164:167], v[40:43]
    ds_read_b64_tr_b16 a[246:247], v225 offset:58368
    v_add_f32 v238, v238, v111
    v_mfma_f32_16x16x32_bf16 v[40:43], a[168:171], v[168:171], v[40:43]
    ds_read_b64_tr_b16 a[216:217], v226 offset:49152
    v_cvt_pk_bf16_f32 v107, v110, v111
    v_mfma_f32_16x16x32_bf16 v[40:43], a[172:175], v[172:175], v[40:43]
    v_exp_f32 v118, v118
    v_mfma_f32_16x16x32_bf16 v[44:47], a[176:179], v[160:163], v[200:203]
    ds_read_b64_tr_b16 a[218:219], v226 offset:50176
    v_cvt_pk_bf16_f32 v112, v112, v113
    v_mfma_f32_16x16x32_bf16 v[44:47], a[180:183], v[164:167], v[44:47]
    v_exp_f32 v119, v119
    v_mfma_f32_16x16x32_bf16 v[44:47], a[184:187], v[168:171], v[44:47]
    ds_read_b64_tr_b16 a[248:249], v226 offset:57344
    v_cvt_pk_bf16_f32 v113, v114, v115
    v_mfma_f32_16x16x32_bf16 v[44:47], a[188:191], v[172:175], v[44:47]
    v_exp_f32 v120, v120
    v_mfma_f32_16x16x32_bf16 v[48:51], a[128:131], v[176:179], v[204:207]
    ds_read_b64_tr_b16 a[250:251], v226 offset:58368
    v_cvt_pk_bf16_f32 v114, v116, v117
    v_mfma_f32_16x16x32_bf16 v[48:51], a[132:135], v[180:183], v[48:51]
    ds_read_b64_tr_b16 a[220:221], v227 offset:49152
    v_cvt_pk_bf16_f32 v115, v118, v119
    v_mfma_f32_16x16x32_bf16 v[48:51], a[136:139], v[184:187], v[48:51]
    v_exp_f32 v121, v121
    v_mfma_f32_16x16x32_bf16 v[48:51], a[140:143], v[188:191], v[48:51]
    ds_read_b64_tr_b16 a[222:223], v227 offset:50176
    v_cvt_pk_bf16_f32 v120, v120, v121
    v_mfma_f32_16x16x32_bf16 v[52:55], a[144:147], v[176:179], v[204:207]
    v_exp_f32 v122, v122
    v_mfma_f32_16x16x32_bf16 v[52:55], a[148:151], v[180:183], v[52:55]
    v_exp_f32 v123, v123
    v_mfma_f32_16x16x32_bf16 v[52:55], a[152:155], v[184:187], v[52:55]
    ds_read_b64_tr_b16 a[252:253], v227 offset:57344
    v_cvt_pk_bf16_f32 v121, v122, v123
    v_mfma_f32_16x16x32_bf16 v[52:55], a[156:159], v[188:191], v[52:55]
    ds_read_b64_tr_b16 a[254:255], v227 offset:58368
    v_mfma_f32_16x16x32_bf16 v[56:59], a[160:163], v[176:179], v[204:207]
    v_exp_f32 v124, v124
    v_mfma_f32_16x16x32_bf16 v[56:59], a[164:167], v[180:183], v[56:59]
    v_exp_f32 v125, v125
    v_mfma_f32_16x16x32_bf16 v[56:59], a[168:171], v[184:187], v[56:59]
    v_exp_f32 v126, v126
    v_mfma_f32_16x16x32_bf16 v[56:59], a[172:175], v[188:191], v[56:59]
    v_exp_f32 v127, v127
    v_mfma_f32_16x16x32_bf16 v[60:63], a[176:179], v[176:179], v[204:207]
    s_cmp_eq_u32 s39, 2
    v_cvt_pk_bf16_f32 v122, v124, v125
    v_cvt_pk_bf16_f32 v123, v126, v127
    v_mfma_f32_16x16x32_bf16 v[60:63], a[180:183], v[180:183], v[60:63]
    s_cselect_b32 s42, s80, 1073741824
    s_cselect_b32 m0, s82, 162304
    v_mfma_f32_16x16x32_bf16 v[60:63], a[184:187], v[184:187], v[60:63]
    buffer_load_dwordx4 v254, s[76:79], s42 offen offset:0  lds
    v_mfma_f32_16x16x32_bf16 v[60:63], a[188:191], v[188:191], v[60:63]
    s_waitcnt vmcnt(19) lgkmcnt(0)
    s_barrier
    v_mfma_f32_16x16x32_bf16 a[0:3], a[192:195], v[64:67], a[0:3]
    v_exp_f32 v0, v0
    v_mfma_f32_16x16x32_bf16 a[0:3], a[224:227], v[72:75], a[0:3]
    v_exp_f32 v1, v1
    v_mfma_f32_16x16x32_bf16 a[4:7], a[196:199], v[64:67], a[4:7]
    v_add_f32 v236, v236, v0
    v_add_f32 v236, v236, v1
    v_mfma_f32_16x16x32_bf16 a[4:7], a[228:231], v[72:75], a[4:7]
    s_mov_b32 m0, s31
    v_exp_f32 v2, v2
    v_mfma_f32_16x16x32_bf16 a[8:11], a[200:203], v[64:67], a[8:11]
    buffer_load_dwordx4 v234, s[16:19], s33 offen offset:0  lds
    v_mfma_f32_16x16x32_bf16 a[8:11], a[232:235], v[72:75], a[8:11]
    ds_read_b128 a[128:131], v228 offset:16384
    v_cvt_pk_bf16_f32 v0, v0, v1
    v_mfma_f32_16x16x32_bf16 a[12:15], a[204:207], v[64:67], a[12:15]
    v_exp_f32 v3, v3
    v_mfma_f32_16x16x32_bf16 a[12:15], a[236:239], v[72:75], a[12:15]
    ds_read_b128 a[132:135], v229 offset:16384
    v_add_f32 v236, v236, v2
    v_mfma_f32_16x16x32_bf16 a[16:19], a[208:211], v[64:67], a[16:19]
    v_add_f32 v236, v236, v3
    v_cvt_pk_bf16_f32 v1, v2, v3
    v_mfma_f32_16x16x32_bf16 a[16:19], a[240:243], v[72:75], a[16:19]
    v_exp_f32 v4, v4
    v_mfma_f32_16x16x32_bf16 a[20:23], a[212:215], v[64:67], a[20:23]
    v_exp_f32 v5, v5
    v_mfma_f32_16x16x32_bf16 a[20:23], a[244:247], v[72:75], a[20:23]
    ds_read_b128 a[136:139], v230 offset:16384
    v_add_f32 v236, v236, v4
    v_mfma_f32_16x16x32_bf16 a[24:27], a[216:219], v[64:67], a[24:27]
    buffer_load_dwordx4 v234, s[16:19], s33 offen offset:1024  lds
    v_mfma_f32_16x16x32_bf16 a[24:27], a[248:251], v[72:75], a[24:27]
    v_add_f32 v236, v236, v5
    v_cvt_pk_bf16_f32 v2, v4, v5
    v_mfma_f32_16x16x32_bf16 a[28:31], a[220:223], v[64:67], a[28:31]
    v_exp_f32 v6, v6
    v_mfma_f32_16x16x32_bf16 a[28:31], a[252:255], v[72:75], a[28:31]
    ds_read_b128 a[140:143], v231 offset:16384
    v_add_f32 v236, v236, v6
    v_mfma_f32_16x16x32_bf16 a[32:35], a[192:195], v[80:83], a[32:35]
    v_exp_f32 v7, v7
    v_mfma_f32_16x16x32_bf16 a[32:35], a[224:227], v[88:91], a[32:35]
    v_add_f32 v236, v236, v7
    v_cvt_pk_bf16_f32 v3, v6, v7
    v_mfma_f32_16x16x32_bf16 a[36:39], a[196:199], v[80:83], a[36:39]
    v_exp_f32 v8, v8
    v_mfma_f32_16x16x32_bf16 a[36:39], a[228:231], v[88:91], a[36:39]
    ds_read_b128 a[144:147], v228 offset:17408
    v_add_f32 v236, v236, v8
    v_mfma_f32_16x16x32_bf16 a[40:43], a[200:203], v[80:83], a[40:43]
    buffer_load_dwordx4 v235, s[16:19], s33 offen offset:2048  lds
    v_mfma_f32_16x16x32_bf16 a[40:43], a[232:235], v[88:91], a[40:43]
    v_exp_f32 v9, v9
    v_mfma_f32_16x16x32_bf16 a[44:47], a[204:207], v[80:83], a[44:47]
    ds_read_b128 a[148:151], v229 offset:17408
    v_add_f32 v236, v236, v9
    v_mfma_f32_16x16x32_bf16 a[44:47], a[236:239], v[88:91], a[44:47]
    v_exp_f32 v10, v10
    v_mfma_f32_16x16x32_bf16 a[48:51], a[208:211], v[80:83], a[48:51]
    v_cvt_pk_bf16_f32 v8, v8, v9
    v_add_f32 v236, v236, v10
    v_mfma_f32_16x16x32_bf16 a[48:51], a[240:243], v[88:91], a[48:51]
    v_exp_f32 v11, v11
    v_mfma_f32_16x16x32_bf16 a[52:55], a[212:215], v[80:83], a[52:55]
    ds_read_b128 a[152:155], v230 offset:17408
    v_add_f32 v236, v236, v11
    v_mfma_f32_16x16x32_bf16 a[52:55], a[244:247], v[88:91], a[52:55]
    v_exp_f32 v12, v12
    v_mfma_f32_16x16x32_bf16 a[56:59], a[216:219], v[80:83], a[56:59]
    buffer_load_dwordx4 v235, s[16:19], s33 offen offset:3072  lds
    v_mfma_f32_16x16x32_bf16 a[56:59], a[248:251], v[88:91], a[56:59]
    ds_read_b128 a[156:159], v231 offset:17408
    v_cvt_pk_bf16_f32 v9, v10, v11
    v_mfma_f32_16x16x32_bf16 a[60:63], a[220:223], v[80:83], a[60:63]
    v_exp_f32 v13, v13
    v_mfma_f32_16x16x32_bf16 a[60:63], a[252:255], v[88:91], a[60:63]
    v_add_f32 v236, v236, v12
    v_add_f32 v236, v236, v13
    v_mfma_f32_16x16x32_bf16 v[208:211], v[216:219], v[80:83], v[208:211]
    ds_read_b128 a[160:163], v228 offset:24576
    v_cvt_pk_bf16_f32 v10, v12, v13
    v_mfma_f32_16x16x32_bf16 v[208:211], v[216:219], v[88:91], v[208:211]
    v_exp_f32 v14, v14
    v_mfma_f32_16x16x32_bf16 a[64:67], a[192:195], v[96:99], a[64:67]
    s_add_u32 s33, s33, 16384
    v_exp_f32 v15, v15
    v_mfma_f32_16x16x32_bf16 a[64:67], a[224:227], v[104:107], a[64:67]
    s_mov_b32 m0, s24
    v_exp_f32 v16, v16
    v_mfma_f32_16x16x32_bf16 a[68:71], a[196:199], v[96:99], a[68:71]
    buffer_load_dwordx4 v232, s[12:15], s32 offen offset:0  lds
    v_mfma_f32_16x16x32_bf16 a[68:71], a[228:231], v[104:107], a[68:71]
    ds_read_b128 a[164:167], v229 offset:24576
    v_add_f32 v236, v236, v14
    v_mfma_f32_16x16x32_bf16 a[72:75], a[200:203], v[96:99], a[72:75]
    v_add_f32 v236, v236, v15
    v_cvt_pk_bf16_f32 v11, v14, v15
    v_mfma_f32_16x16x32_bf16 a[72:75], a[232:235], v[104:107], a[72:75]
    v_exp_f32 v17, v17
    v_mfma_f32_16x16x32_bf16 a[76:79], a[204:207], v[96:99], a[76:79]
    ds_read_b128 a[168:171], v230 offset:24576
    v_cvt_pk_bf16_f32 v16, v16, v17
    v_mfma_f32_16x16x32_bf16 a[76:79], a[236:239], v[104:107], a[76:79]
    v_exp_f32 v18, v18
    v_mfma_f32_16x16x32_bf16 a[80:83], a[208:211], v[96:99], a[80:83]
    v_exp_f32 v19, v19
    v_mfma_f32_16x16x32_bf16 a[80:83], a[240:243], v[104:107], a[80:83]
    ds_read_b128 a[172:175], v231 offset:24576
    v_cvt_pk_bf16_f32 v17, v18, v19
    v_mfma_f32_16x16x32_bf16 a[84:87], a[212:215], v[96:99], a[84:87]
    buffer_load_dwordx4 v232, s[12:15], s32 offen offset:1024  lds
    v_mfma_f32_16x16x32_bf16 a[84:87], a[244:247], v[104:107], a[84:87]
    v_exp_f32 v20, v20
    v_mfma_f32_16x16x32_bf16 a[88:91], a[216:219], v[96:99], a[88:91]
    v_exp_f32 v21, v21
    v_mfma_f32_16x16x32_bf16 a[88:91], a[248:251], v[104:107], a[88:91]
    ds_read_b128 a[176:179], v228 offset:25600
    v_cvt_pk_bf16_f32 v18, v20, v21
    v_mfma_f32_16x16x32_bf16 a[92:95], a[220:223], v[96:99], a[92:95]
    v_exp_f32 v22, v22
    v_mfma_f32_16x16x32_bf16 a[92:95], a[252:255], v[104:107], a[92:95]
    v_exp_f32 v23, v23
    v_mfma_f32_16x16x32_bf16 a[96:99], a[192:195], v[112:115], a[96:99]
    ds_read_b128 a[180:183], v229 offset:25600
    v_cvt_pk_bf16_f32 v19, v22, v23
    v_mfma_f32_16x16x32_bf16 a[96:99], a[224:227], v[120:123], a[96:99]
    v_exp_f32 v24, v24
    v_mfma_f32_16x16x32_bf16 a[100:103], a[196:199], v[112:115], a[100:103]
    buffer_load_dwordx4 v233, s[12:15], s32 offen offset:2048  lds
    v_mfma_f32_16x16x32_bf16 a[100:103], a[228:231], v[120:123], a[100:103]
    v_exp_f32 v25, v25
    v_mfma_f32_16x16x32_bf16 a[104:107], a[200:203], v[112:115], a[104:107]
    ds_read_b128 a[184:187], v230 offset:25600
    v_cvt_pk_bf16_f32 v24, v24, v25
    v_mfma_f32_16x16x32_bf16 a[104:107], a[232:235], v[120:123], a[104:107]
    v_exp_f32 v26, v26
    v_mfma_f32_16x16x32_bf16 a[108:111], a[204:207], v[112:115], a[108:111]
    ds_read_b128 a[188:191], v231 offset:25600
    v_mfma_f32_16x16x32_bf16 a[108:111], a[236:239], v[120:123], a[108:111]
    v_exp_f32 v27, v27
    v_mfma_f32_16x16x32_bf16 a[112:115], a[208:211], v[112:115], a[112:115]
L_ix1:
    s_cbranch_execz L_iwr1
    v_exp_f32 v28, v28
    v_mfma_f32_16x16x32_bf16 a[112:115], a[240:243], v[120:123], a[112:115]
    v_exp_f32 v29, v29
    v_mfma_f32_16x16x32_bf16 a[116:119], a[212:215], v[112:115], a[116:119]
    buffer_load_dwordx4 v233, s[12:15], s32 offen offset:3072  lds
    v_mfma_f32_16x16x32_bf16 a[116:119], a[244:247], v[120:123], a[116:119]
    s_add_u32 s32, s32, 16384
    v_exp_f32 v30, v30
    v_mfma_f32_16x16x32_bf16 a[120:123], a[216:219], v[112:115], a[120:123]
    v_cvt_pk_bf16_f32 v25, v26, v27
    v_cvt_pk_bf16_f32 v26, v28, v29
    v_mfma_f32_16x16x32_bf16 a[120:123], a[248:251], v[120:123], a[120:123]
    v_exp_f32 v31, v31
    v_mfma_f32_16x16x32_bf16 a[124:127], a[220:223], v[112:115], a[124:127]
    v_exp_f32 v32, v32
    v_mfma_f32_16x16x32_bf16 a[124:127], a[252:255], v[120:123], a[124:127]
    v_exp_f32 v33, v33
    v_mfma_f32_16x16x32_bf16 v[212:215], v[216:219], v[112:115], v[212:215]
    v_exp_f32 v34, v34
    v_mfma_f32_16x16x32_bf16 v[212:215], v[216:219], v[120:123], v[212:215]
    s_waitcnt lgkmcnt(0)
    v_exp_f32 v35, v35
    v_mfma_f32_16x16x32_bf16 v[64:67], a[128:131], v[128:131], v[192:195]
    ds_read_b64_tr_b16 a[192:193], v220 offset:0
    v_cvt_pk_bf16_f32 v27, v30, v31
    v_mfma_f32_16x16x32_bf16 v[64:67], a[132:135], v[132:135], v[64:67]
    v_exp_f32 v36, v36
    v_mfma_f32_16x16x32_bf16 v[64:67], a[136:139], v[136:139], v[64:67]
    ds_read_b64_tr_b16 a[194:195], v220 offset:1024
    v_add_f32 v238, v238, v32
    v_mfma_f32_16x16x32_bf16 v[64:67], a[140:143], v[140:143], v[64:67]
    v_exp_f32 v37, v37
    v_mfma_f32_16x16x32_bf16 v[68:71], a[144:147], v[128:131], v[192:195]
    ds_read_b64_tr_b16 a[224:225], v220 offset:8192
    v_add_f32 v238, v238, v33
    v_mfma_f32_16x16x32_bf16 v[68:71], a[148:151], v[132:135], v[68:71]
    v_exp_f32 v38, v38
    v_mfma_f32_16x16x32_bf16 v[68:71], a[152:155], v[136:139], v[68:71]
    ds_read_b64_tr_b16 a[226:227], v220 offset:9216
    v_cvt_pk_bf16_f32 v32, v32, v33
    v_mfma_f32_16x16x32_bf16 v[68:71], a[156:159], v[140:143], v[68:71]
    ds_read_b64_tr_b16 a[196:197], v221 offset:0
    v_add_f32 v238, v238, v34
    v_mfma_f32_16x16x32_bf16 v[72:75], a[160:163], v[128:131], v[192:195]
    v_exp_f32 v39, v39
    v_mfma_f32_16x16x32_bf16 v[72:75], a[164:167], v[132:135], v[72:75]
    ds_read_b64_tr_b16 a[198:199], v221 offset:1024
    v_add_f32 v238, v238, v35
    v_mfma_f32_16x16x32_bf16 v[72:75], a[168:171], v[136:139], v[72:75]
    v_exp_f32 v40, v40
    v_mfma_f32_16x16x32_bf16 v[72:75], a[172:175], v[140:143], v[72:75]
    ds_read_b64_tr_b16 a[228:229], v221 offset:8192
    v_cvt_pk_bf16_f32 v33, v34, v35
    v_mfma_f32_16x16x32_bf16 v[76:79], a[176:179], v[128:131], v[192:195]
    v_exp_f32 v41, v41
    v_mfma_f32_16x16x32_bf16 v[76:79], a[180:183], v[132:135], v[76:79]
    ds_read_b64_tr_b16 a[230:231], v221 offset:9216
    v_add_f32 v238, v238, v36
    v_mfma_f32_16x16x32_bf16 v[76:79], a[184:187], v[136:139], v[76:79]
    ds_read_b64_tr_b16 a[200:201], v222 offset:0
    v_add_f32 v238, v238, v37
    v_mfma_f32_16x16x32_bf16 v[76:79], a[188:191], v[140:143], v[76:79]
    v_exp_f32 v42, v42
    v_mfma_f32_16x16x32_bf16 v[80:83], a[128:131], v[144:147], v[196:199]
    ds_read_b64_tr_b16 a[202:203], v222 offset:1024
    v_cvt_pk_bf16_f32 v34, v36, v37
    v_mfma_f32_16x16x32_bf16 v[80:83], a[132:135], v[148:151], v[80:83]
    v_exp_f32 v43, v43
    v_mfma_f32_16x16x32_bf16 v[80:83], a[136:139], v[152:155], v[80:83]
    ds_read_b64_tr_b16 a[232:233], v222 offset:8192
    v_add_f32 v238, v238, v38
    v_mfma_f32_16x16x32_bf16 v[80:83], a[140:143], v[156:159], v[80:83]
    v_exp_f32 v44, v44
    v_mfma_f32_16x16x32_bf16 v[84:87], a[144:147], v[144:147], v[196:199]
    ds_read_b64_tr_b16 a[234:235], v222 offset:9216
    v_add_f32 v238, v238, v39
    v_mfma_f32_16x16x32_bf16 v[84:87], a[148:151], v[148:151], v[84:87]
    ds_read_b64_tr_b16 a[204:205], v223 offset:0
    v_cvt_pk_bf16_f32 v35, v38, v39
    v_mfma_f32_16x16x32_bf16 v[84:87], a[152:155], v[152:155], v[84:87]
    v_exp_f32 v45, v45
    v_mfma_f32_16x16x32_bf16 v[84:87], a[156:159], v[156:159], v[84:87]
    ds_read_b64_tr_b16 a[206:207], v223 offset:1024
    v_add_f32 v238, v238, v40
    v_mfma_f32_16x16x32_bf16 v[88:91], a[160:163], v[144:147], v[196:199]
    v_exp_f32 v46, v46
    v_mfma_f32_16x16x32_bf16 v[88:91], a[164:167], v[148:151], v[88:91]
    ds_read_b64_tr_b16 a[236:237], v223 offset:8192
    v_add_f32 v238, v238, v41
    v_mfma_f32_16x16x32_bf16 v[88:91], a[168:171], v[152:155], v[88:91]
    v_exp_f32 v47, v47
    v_mfma_f32_16x16x32_bf16 v[88:91], a[172:175], v[156:159], v[88:91]
    ds_read_b64_tr_b16 a[238:239], v223 offset:9216
    v_cvt_pk_bf16_f32 v40, v40, v41
    v_mfma_f32_16x16x32_bf16 v[92:95], a[176:179], v[144:147], v[196:199]
    ds_read_b64_tr_b16 a[208:209], v224 offset:0
    v_add_f32 v238, v238, v42
    v_mfma_f32_16x16x32_bf16 v[92:95], a[180:183], v[148:151], v[92:95]
    v_exp_f32 v48, v48
    v_mfma_f32_16x16x32_bf16 v[92:95], a[184:187], v[152:155], v[92:95]
    ds_read_b64_tr_b16 a[210:211], v224 offset:1024
    v_add_f32 v238, v238, v43
    v_mfma_f32_16x16x32_bf16 v[92:95], a[188:191], v[156:159], v[92:95]
    v_exp_f32 v49, v49
    v_mfma_f32_16x16x32_bf16 v[96:99], a[128:131], v[160:163], v[200:203]
    ds_read_b64_tr_b16 a[240:241], v224 offset:8192
    v_cvt_pk_bf16_f32 v41, v42, v43
    v_mfma_f32_16x16x32_bf16 v[96:99], a[132:135], v[164:167], v[96:99]
    v_exp_f32 v50, v50
    v_mfma_f32_16x16x32_bf16 v[96:99], a[136:139], v[168:171], v[96:99]
    ds_read_b64_tr_b16 a[242:243], v224 offset:9216
    v_add_f32 v238, v238, v44
    v_mfma_f32_16x16x32_bf16 v[96:99], a[140:143], v[172:175], v[96:99]
    ds_read_b64_tr_b16 a[212:213], v225 offset:0
    v_add_f32 v238, v238, v45
    v_mfma_f32_16x16x32_bf16 v[100:103], a[144:147], v[160:163], v[200:203]
    v_exp_f32 v51, v51
    v_mfma_f32_16x16x32_bf16 v[100:103], a[148:151], v[164:167], v[100:103]
    ds_read_b64_tr_b16 a[214:215], v225 offset:1024
    v_cvt_pk_bf16_f32 v42, v44, v45
    v_mfma_f32_16x16x32_bf16 v[100:103], a[152:155], v[168:171], v[100:103]
    v_exp_f32 v52, v52
    v_mfma_f32_16x16x32_bf16 v[100:103], a[156:159], v[172:175], v[100:103]
    ds_read_b64_tr_b16 a[244:245], v225 offset:8192
    v_add_f32 v238, v238, v46
    v_mfma_f32_16x16x32_bf16 v[104:107], a[160:163], v[160:163], v[200:203]
    v_exp_f32 v53, v53
    v_mfma_f32_16x16x32_bf16 v[104:107], a[164:167], v[164:167], v[104:107]
    ds_read_b64_tr_b16 a[246:247], v225 offset:9216
    v_add_f32 v238, v238, v47
    v_mfma_f32_16x16x32_bf16 v[104:107], a[168:171], v[168:171], v[104:107]
    ds_read_b64_tr_b16 a[216:217], v226 offset:0
    v_cvt_pk_bf16_f32 v43, v46, v47
    v_mfma_f32_16x16x32_bf16 v[104:107], a[172:175], v[172:175], v[104:107]
    v_exp_f32 v54, v54
    v_mfma_f32_16x16x32_bf16 v[108:111], a[176:179], v[160:163], v[200:203]
    ds_read_b64_tr_b16 a[218:219], v226 offset:1024
    v_cvt_pk_bf16_f32 v48, v48, v49
    v_mfma_f32_16x16x32_bf16 v[108:111], a[180:183], v[164:167], v[108:111]
    v_exp_f32 v55, v55
    v_mfma_f32_16x16x32_bf16 v[108:111], a[184:187], v[168:171], v[108:111]
    ds_read_b64_tr_b16 a[248:249], v226 offset:8192
    v_cvt_pk_bf16_f32 v49, v50, v51
    v_mfma_f32_16x16x32_bf16 v[108:111], a[188:191], v[172:175], v[108:111]
    v_exp_f32 v56, v56
    v_mfma_f32_16x16x32_bf16 v[112:115], a[128:131], v[176:179], v[204:207]
    ds_read_b64_tr_b16 a[250:251], v226 offset:9216
    v_cvt_pk_bf16_f32 v50, v52, v53
    v_mfma_f32_16x16x32_bf16 v[112:115], a[132:135], v[180:183], v[112:115]
    ds_read_b64_tr_b16 a[220:221], v227 offset:0
    v_cvt_pk_bf16_f32 v51, v54, v55
    v_mfma_f32_16x16x32_bf16 v[112:115], a[136:139], v[184:187], v[112:115]
    v_exp_f32 v57, v57
    v_mfma_f32_16x16x32_bf16 v[112:115], a[140:143], v[188:191], v[112:115]
    ds_read_b64_tr_b16 a[222:223], v227 offset:1024
    v_cvt_pk_bf16_f32 v56, v56, v57
    v_mfma_f32_16x16x32_bf16 v[116:119], a[144:147], v[176:179], v[204:207]
    v_exp_f32 v58, v58
    v_mfma_f32_16x16x32_bf16 v[116:119], a[148:151], v[180:183], v[116:119]
    v_exp_f32 v59, v59
    v_mfma_f32_16x16x32_bf16 v[116:119], a[152:155], v[184:187], v[116:119]
    ds_read_b64_tr_b16 a[252:253], v227 offset:8192
    v_cvt_pk_bf16_f32 v57, v58, v59
    v_mfma_f32_16x16x32_bf16 v[116:119], a[156:159], v[188:191], v[116:119]
    ds_read_b64_tr_b16 a[254:255], v227 offset:9216
    v_mfma_f32_16x16x32_bf16 v[120:123], a[160:163], v[176:179], v[204:207]
    v_exp_f32 v60, v60
    v_mfma_f32_16x16x32_bf16 v[120:123], a[164:167], v[180:183], v[120:123]
    v_exp_f32 v61, v61
    v_mfma_f32_16x16x32_bf16 v[120:123], a[168:171], v[184:187], v[120:123]
    v_exp_f32 v62, v62
    v_mfma_f32_16x16x32_bf16 v[120:123], a[172:175], v[188:191], v[120:123]
    v_exp_f32 v63, v63
    v_mfma_f32_16x16x32_bf16 v[124:127], a[176:179], v[176:179], v[204:207]
    s_cmp_eq_u32 s39, 3
    v_cvt_pk_bf16_f32 v58, v60, v61
    v_cvt_pk_bf16_f32 v59, v62, v63
    v_mfma_f32_16x16x32_bf16 v[124:127], a[180:183], v[180:183], v[124:127]
    s_cselect_b32 s42, s80, 1073741824
    s_cselect_b32 m0, s82, 162304
    v_mfma_f32_16x16x32_bf16 v[124:127], a[184:187], v[184:187], v[124:127]
    buffer_load_dwordx4 v254, s[76:79], s42 offen offset:0  lds
    v_mfma_f32_16x16x32_bf16 v[124:127], a[188:191], v[188:191], v[124:127]
    s_waitcnt vmcnt(19) lgkmcnt(0)
    s_barrier
    v_mfma_f32_16x16x32_bf16 a[0:3], a[192:195], v[0:3], a[0:3]
    v_exp_f32 v64, v64
    v_mfma_f32_16x16x32_bf16 a[0:3], a[224:227], v[8:11], a[0:3]
    v_exp_f32 v65, v65
    v_mfma_f32_16x16x32_bf16 a[4:7], a[196:199], v[0:3], a[4:7]
    v_add_f32 v236, v236, v64
    v_add_f32 v236, v236, v65
    v_mfma_f32_16x16x32_bf16 a[4:7], a[228:231], v[8:11], a[4:7]
    s_mov_b32 m0, s28
    v_exp_f32 v66, v66
    v_mfma_f32_16x16x32_bf16 a[8:11], a[200:203], v[0:3], a[8:11]
    buffer_load_dwordx4 v234, s[16:19], s33 offen offset:0  lds
    v_mfma_f32_16x16x32_bf16 a[8:11], a[232:235], v[8:11], a[8:11]
    ds_read_b128 a[128:131], v228 offset:32768
    v_cvt_pk_bf16_f32 v64, v64, v65
    v_mfma_f32_16x16x32_bf16 a[12:15], a[204:207], v[0:3], a[12:15]
    v_exp_f32 v67, v67
    v_mfma_f32_16x16x32_bf16 a[12:15], a[236:239], v[8:11], a[12:15]
    ds_read_b128 a[132:135], v229 offset:32768
    v_add_f32 v236, v236, v66
    v_mfma_f32_16x16x32_bf16 a[16:19], a[208:211], v[0:3], a[16:19]
    v_add_f32 v236, v236, v67
    v_cvt_pk_bf16_f32 v65, v66, v67
    v_mfma_f32_16x16x32_bf16 a[16:19], a[240:243], v[8:11], a[16:19]
    v_exp_f32 v68, v68
    v_mfma_f32_16x16x32_bf16 a[20:23], a[212:215], v[0:3], a[20:23]
    s_cmp_eq_u32 s34, 1
    v_exp_f32 v69, v69
    v_mfma_f32_16x16x32_bf16 a[20:23], a[244:247], v[8:11], a[20:23]
    s_cselect_b64 s[76:77], s[64:65], s[76:77]
    v_exp_f32 v70, v70
    v_mfma_f32_16x16x32_bf16 a[24:27], a[216:219], v[0:3], a[24:27]
    buffer_load_dwordx4 v234, s[16:19], s33 offen offset:1024  lds
    v_mfma_f32_16x16x32_bf16 a[24:27], a[248:251], v[8:11], a[24:27]
    ds_read_b128 a[136:139], v230 offset:32768
    v_add_f32 v236, v236, v68
    v_mfma_f32_16x16x32_bf16 a[28:31], a[220:223], v[0:3], a[28:31]
    ds_read_b128 a[140:143], v231 offset:32768
    v_add_f32 v236, v236, v69
    v_mfma_f32_16x16x32_bf16 a[28:31], a[252:255], v[8:11], a[28:31]
    v_cvt_pk_bf16_f32 v66, v68, v69
    v_add_f32 v236, v236, v70
    v_mfma_f32_16x16x32_bf16 a[32:35], a[192:195], v[16:19], a[32:35]
    v_exp_f32 v71, v71
    v_mfma_f32_16x16x32_bf16 a[32:35], a[224:227], v[24:27], a[32:35]
    s_sub_u32 s80, s81, s80
    v_exp_f32 v72, v72
    v_mfma_f32_16x16x32_bf16 a[36:39], a[196:199], v[16:19], a[36:39]
    s_add_u32 s82, s82, s83
    v_exp_f32 v73, v73
    v_mfma_f32_16x16x32_bf16 a[36:39], a[228:231], v[24:27], a[36:39]
    s_sub_u32 s83, 8192, s83
    v_exp_f32 v74, v74
    v_mfma_f32_16x16x32_bf16 a[40:43], a[200:203], v[16:19], a[40:43]
    buffer_load_dwordx4 v235, s[16:19], s33 offen offset:2048  lds
    v_mfma_f32_16x16x32_bf16 a[40:43], a[232:235], v[24:27], a[40:43]
    ds_read_b128 a[144:147], v228 offset:33792
    v_add_f32 v236, v236, v71
    v_mfma_f32_16x16x32_bf16 a[44:47], a[204:207], v[16:19], a[44:47]
    ds_read_b128 a[148:151], v229 offset:33792
    v_cvt_pk_bf16_f32 v67, v70, v71
    v_mfma_f32_16x16x32_bf16 a[44:47], a[236:239], v[24:27], a[44:47]
    s_cmp_ge_u32 s34, 3
    v_exp_f32 v75, v75
    v_mfma_f32_16x16x32_bf16 a[48:51], a[208:211], v[16:19], a[48:51]
    s_cselect_b64 s[76:77], s[84:85], s[76:77]
    v_exp_f32 v76, v76
    v_mfma_f32_16x16x32_bf16 a[48:51], a[240:243], v[24:27], a[48:51]
    s_cselect_b32 s78, s86, s78
    v_exp_f32 v77, v77
    v_mfma_f32_16x16x32_bf16 a[52:55], a[212:215], v[16:19], a[52:55]
    s_cselect_b32 s80, s58, s80
    v_exp_f32 v78, v78
    v_mfma_f32_16x16x32_bf16 a[52:55], a[244:247], v[24:27], a[52:55]
    s_cselect_b32 s82, 162304, s82
    v_exp_f32 v79, v79
    v_mfma_f32_16x16x32_bf16 a[56:59], a[216:219], v[16:19], a[56:59]
    buffer_load_dwordx4 v235, s[16:19], s33 offen offset:3072  lds
    v_mfma_f32_16x16x32_bf16 a[56:59], a[248:251], v[24:27], a[56:59]
    ds_read_b128 a[152:155], v230 offset:33792
    v_add_f32 v236, v236, v72
    v_mfma_f32_16x16x32_bf16 a[60:63], a[220:223], v[16:19], a[60:63]
    ds_read_b128 a[156:159], v231 offset:33792
    v_add_f32 v236, v236, v73
    v_mfma_f32_16x16x32_bf16 a[60:63], a[252:255], v[24:27], a[60:63]
    v_cvt_pk_bf16_f32 v72, v72, v73
    v_add_f32 v236, v236, v74
    v_mfma_f32_16x16x32_bf16 v[208:211], v[216:219], v[16:19], v[208:211]
    ds_read_b128 a[160:163], v228 offset:40960
    v_add_f32 v236, v236, v75
    v_mfma_f32_16x16x32_bf16 v[208:211], v[216:219], v[24:27], v[208:211]
    v_cvt_pk_bf16_f32 v73, v74, v75
    v_add_f32 v236, v236, v76
    v_mfma_f32_16x16x32_bf16 a[64:67], a[192:195], v[32:35], a[64:67]
    s_add_u32 s33, s33, 16384
    v_exp_f32 v80, v80
    v_mfma_f32_16x16x32_bf16 a[64:67], a[224:227], v[40:43], a[64:67]
    s_mov_b32 m0, s25
    v_exp_f32 v81, v81
    v_mfma_f32_16x16x32_bf16 a[68:71], a[196:199], v[32:35], a[68:71]
    buffer_load_dwordx4 v232, s[12:15], s32 offen offset:0  lds
    v_mfma_f32_16x16x32_bf16 a[68:71], a[228:231], v[40:43], a[68:71]
    ds_read_b128 a[164:167], v229 offset:40960
    v_add_f32 v236, v236, v77
    v_mfma_f32_16x16x32_bf16 a[72:75], a[200:203], v[32:35], a[72:75]
    v_cvt_pk_bf16_f32 v74, v76, v77
    v_add_f32 v236, v236, v78
    v_mfma_f32_16x16x32_bf16 a[72:75], a[232:235], v[40:43], a[72:75]
    ds_read_b128 a[168:171], v230 offset:40960
    v_add_f32 v236, v236, v79
    v_mfma_f32_16x16x32_bf16 a[76:79], a[204:207], v[32:35], a[76:79]
    v_cvt_pk_bf16_f32 v75, v78, v79
    v_cvt_pk_bf16_f32 v80, v80, v81
    v_mfma_f32_16x16x32_bf16 a[76:79], a[236:239], v[40:43], a[76:79]
    v_exp_f32 v82, v82
    v_mfma_f32_16x16x32_bf16 a[80:83], a[208:211], v[32:35], a[80:83]
    v_exp_f32 v83, v83
    v_mfma_f32_16x16x32_bf16 a[80:83], a[240:243], v[40:43], a[80:83]
    ds_read_b128 a[172:175], v231 offset:40960
    v_cvt_pk_bf16_f32 v81, v82, v83
    v_mfma_f32_16x16x32_bf16 a[84:87], a[212:215], v[32:35], a[84:87]
    buffer_load_dwordx4 v232, s[12:15], s32 offen offset:1024  lds
    v_mfma_f32_16x16x32_bf16 a[84:87], a[244:247], v[40:43], a[84:87]
    v_exp_f32 v84, v84
    v_mfma_f32_16x16x32_bf16 a[88:91], a[216:219], v[32:35], a[88:91]
    v_exp_f32 v85, v85
    v_mfma_f32_16x16x32_bf16 a[88:91], a[248:251], v[40:43], a[88:91]
    ds_read_b128 a[176:179], v228 offset:41984
    v_cvt_pk_bf16_f32 v82, v84, v85
    v_mfma_f32_16x16x32_bf16 a[92:95], a[220:223], v[32:35], a[92:95]
    v_exp_f32 v86, v86
    v_mfma_f32_16x16x32_bf16 a[92:95], a[252:255], v[40:43], a[92:95]
    v_exp_f32 v87, v87
    v_mfma_f32_16x16x32_bf16 a[96:99], a[192:195], v[48:51], a[96:99]
    ds_read_b128 a[180:183], v229 offset:41984
    v_cvt_pk_bf16_f32 v83, v86, v87
    v_mfma_f32_16x16x32_bf16 a[96:99], a[224:227], v[56:59], a[96:99]
    v_exp_f32 v88, v88
    v_mfma_f32_16x16x32_bf16 a[100:103], a[196:199], v[48:51], a[100:103]
    buffer_load_dwordx4 v233, s[12:15], s32 offen offset:2048  lds
    v_mfma_f32_16x16x32_bf16 a[100:103], a[228:231], v[56:59], a[100:103]
    v_exp_f32 v89, v89
    v_mfma_f32_16x16x32_bf16 a[104:107], a[200:203], v[48:51], a[104:107]
    ds_read_b128 a[184:187], v230 offset:41984
    v_cvt_pk_bf16_f32 v88, v88, v89
    v_mfma_f32_16x16x32_bf16 a[104:107], a[232:235], v[56:59], a[104:107]
    v_exp_f32 v90, v90
    v_mfma_f32_16x16x32_bf16 a[108:111], a[204:207], v[48:51], a[108:111]
    ds_read_b128 a[188:191], v231 offset:41984
    v_mfma_f32_16x16x32_bf16 a[108:111], a[236:239], v[56:59], a[108:111]
    v_exp_f32 v91, v91
    v_mfma_f32_16x16x32_bf16 a[112:115], a[208:211], v[48:51], a[112:115]
    v_exp_f32 v92, v92
    v_mfma_f32_16x16x32_bf16 a[112:115], a[240:243], v[56:59], a[112:115]
    v_exp_f32 v93, v93
    v_mfma_f32_16x16x32_bf16 a[116:119], a[212:215], v[48:51], a[116:119]
    buffer_load_dwordx4 v233, s[12:15], s32 offen offset:3072  lds
    v_mfma_f32_16x16x32_bf16 a[116:119], a[244:247], v[56:59], a[116:119]
    s_add_u32 s32, s32, 16384
    v_exp_f32 v94, v94
    v_mfma_f32_16x16x32_bf16 a[120:123], a[216:219], v[48:51], a[120:123]
    v_cvt_pk_bf16_f32 v89, v90, v91
    v_cvt_pk_bf16_f32 v90, v92, v93
    v_mfma_f32_16x16x32_bf16 a[120:123], a[248:251], v[56:59], a[120:123]
    v_exp_f32 v95, v95
    v_mfma_f32_16x16x32_bf16 a[124:127], a[220:223], v[48:51], a[124:127]
    v_exp_f32 v96, v96
    v_mfma_f32_16x16x32_bf16 a[124:127], a[252:255], v[56:59], a[124:127]
    v_exp_f32 v97, v97
    v_mfma_f32_16x16x32_bf16 v[212:215], v[216:219], v[48:51], v[212:215]
    v_exp_f32 v98, v98
    v_mfma_f32_16x16x32_bf16 v[212:215], v[216:219], v[56:59], v[212:215]
    s_waitcnt lgkmcnt(0)
    v_exp_f32 v99, v99
    s_add_u32 s34, s34, 1
    s_cmp_lt_u32 s34, 6
    s_cbranch_scc1 L_loop
    v_mfma_f32_16x16x32_bf16 v[0:3], a[128:131], v[128:131], v[192:195]
    ds_read_b64_tr_b16 a[192:193], v220 offset:16384
    v_cvt_pk_bf16_f32 v91, v94, v95
    v_mfma_f32_16x16x32_bf16 v[0:3], a[132:135], v[132:135], v[0:3]
    v_exp_f32 v100, v100
    v_mfma_f32_16x16x32_bf16 v[0:3], a[136:139], v[136:139], v[0:3]
    ds_read_b64_tr_b16 a[194:195], v220 offset:17408
    v_add_f32 v238, v238, v96
    v_mfma_f32_16x16x32_bf16 v[0:3], a[140:143], v[140:143], v[0:3]
    v_exp_f32 v101, v101
    v_mfma_f32_16x16x32_bf16 v[4:7], a[144:147], v[128:131], v[192:195]
    ds_read_b64_tr_b16 a[224:225], v220 offset:24576
    v_add_f32 v238, v238, v97
    v_mfma_f32_16x16x32_bf16 v[4:7], a[148:151], v[132:135], v[4:7]
    v_exp_f32 v102, v102
    v_mfma_f32_16x16x32_bf16 v[4:7], a[152:155], v[136:139], v[4:7]
    ds_read_b64_tr_b16 a[226:227], v220 offset:25600
    v_cvt_pk_bf16_f32 v96, v96, v97
    v_mfma_f32_16x16x32_bf16 v[4:7], a[156:159], v[140:143], v[4:7]
    ds_read_b64_tr_b16 a[196:197], v221 offset:16384
    v_add_f32 v238, v238, v98
    v_mfma_f32_16x16x32_bf16 v[8:11], a[160:163], v[128:131], v[192:195]
    v_exp_f32 v103, v103
    v_mfma_f32_16x16x32_bf16 v[8:11], a[164:167], v[132:135], v[8:11]
    ds_read_b64_tr_b16 a[198:199], v221 offset:17408
    v_add_f32 v238, v238, v99
    v_mfma_f32_16x16x32_bf16 v[8:11], a[168:171], v[136:139], v[8:11]
    v_exp_f32 v104, v104
    v_mfma_f32_16x16x32_bf16 v[8:11], a[172:175], v[140:143], v[8:11]
    ds_read_b64_tr_b16 a[228:229], v221 offset:24576
    v_cvt_pk_bf16_f32 v97, v98, v99
    v_mfma_f32_16x16x32_bf16 v[12:15], a[176:179], v[128:131], v[192:195]
    v_exp_f32 v105, v105
    v_mfma_f32_16x16x32_bf16 v[12:15], a[180:183], v[132:135], v[12:15]
    ds_read_b64_tr_b16 a[230:231], v221 offset:25600
    v_add_f32 v238, v238, v100
    v_mfma_f32_16x16x32_bf16 v[12:15], a[184:187], v[136:139], v[12:15]
    ds_read_b64_tr_b16 a[200:201], v222 offset:16384
    v_add_f32 v238, v238, v101
    v_mfma_f32_16x16x32_bf16 v[12:15], a[188:191], v[140:143], v[12:15]
    s_branch L_io6
    .p2align 12
L_iw6:
    s_branch L_iwr7
L_io6:
    v_exp_f32 v106, v106
    v_mfma_f32_16x16x32_bf16 v[16:19], a[128:131], v[144:147], v[196:199]
    ds_read_b64_tr_b16 a[202:203], v222 offset:17408
    v_cvt_pk_bf16_f32 v98, v100, v101
    v_mfma_f32_16x16x32_bf16 v[16:19], a[132:135], v[148:151], v[16:19]
    v_exp_f32 v107, v107
    v_mfma_f32_16x16x32_bf16 v[16:19], a[136:139], v[152:155], v[16:19]
    ds_read_b64_tr_b16 a[232:233], v222 offset:24576
    v_add_f32 v238, v238, v102
    v_mfma_f32_16x16x32_bf16 v[16:19], a[140:143], v[156:159], v[16:19]
    v_exp_f32 v108, v108
    v_mfma_f32_16x16x32_bf16 v[20:23], a[144:147], v[144:147], v[196:199]
    ds_read_b64_tr_b16 a[234:235], v222 offset:25600
    v_add_f32 v238, v238, v103
    v_mfma_f32_16x16x32_bf16 v[20:23], a[148:151], v[148:151], v[20:23]
    ds_read_b64_tr_b16 a[204:205], v223 offset:16384
    v_cvt_pk_bf16_f32 v99, v102, v103
    v_mfma_f32_16x16x32_bf16 v[20:23], a[152:155], v[152:155], v[20:23]
    v_exp_f32 v109, v109
    v_mfma_f32_16x16x32_bf16 v[20:23], a[156:159], v[156:159], v[20:23]
    ds_read_b64_tr_b16 a[206:207], v223 offset:17408
    v_add_f32 v238, v238, v104
    v_mfma_f32_16x16x32_bf16 v[24:27], a[160:163], v[144:147], v[196:199]
    v_exp_f32 v110, v110
    v_mfma_f32_16x16x32_bf16 v[24:27], a[164:167], v[148:151], v[24:27]
    ds_read_b64_tr_b16 a[236:237], v223 offset:24576
    v_add_f32 v238, v238, v105
    v_mfma_f32_16x16x32_bf16 v[24:27], a[168:171], v[152:155], v[24:27]
    v_exp_f32 v111, v111
    v_mfma_f32_16x16x32_bf16 v[24:27], a[172:175], v[156:159], v[24:27]
    ds_read_b64_tr_b16 a[238:239], v223 offset:25600
    v_cvt_pk_bf16_f32 v104, v104, v105
    v_mfma_f32_16x16x32_bf16 v[28:31], a[176:179], v[144:147], v[196:199]
    ds_read_b64_tr_b16 a[208:209], v224 offset:16384
    v_add_f32 v238, v238, v106
    v_mfma_f32_16x16x32_bf16 v[28:31], a[180:183], v[148:151], v[28:31]
    v_exp_f32 v112, v112
    v_mfma_f32_16x16x32_bf16 v[28:31], a[184:187], v[152:155], v[28:31]
    ds_read_b64_tr_b16 a[210:211], v224 offset:17408
    v_add_f32 v238, v238, v107
    v_mfma_f32_16x16x32_bf16 v[28:31], a[188:191], v[156:159], v[28:31]
    v_exp_f32 v113, v113
    v_mfma_f32_16x16x32_bf16 v[32:35], a[128:131], v[160:163], v[200:203]
    ds_read_b64_tr_b16 a[240:241], v224 offset:24576
    v_cvt_pk_bf16_f32 v105, v106, v107
    v_mfma_f32_16x16x32_bf16 v[32:35], a[132:135], v[164:167], v[32:35]
    v_exp_f32 v114, v114
    v_mfma_f32_16x16x32_bf16 v[32:35], a[136:139], v[168:171], v[32:35]
    ds_read_b64_tr_b16 a[242:243], v224 offset:25600
    v_add_f32 v238, v238, v108
    v_mfma_f32_16x16x32_bf16 v[32:35], a[140:143], v[172:175], v[32:35]
    ds_read_b64_tr_b16 a[212:213], v225 offset:16384
    v_add_f32 v238, v238, v109
    v_mfma_f32_16x16x32_bf16 v[36:39], a[144:147], v[160:163], v[200:203]
    v_exp_f32 v115, v115
    v_mfma_f32_16x16x32_bf16 v[36:39], a[148:151], v[164:167], v[36:39]
    ds_read_b64_tr_b16 a[214:215], v225 offset:17408
    v_cvt_pk_bf16_f32 v106, v108, v109
    v_mfma_f32_16x16x32_bf16 v[36:39], a[152:155], v[168:171], v[36:39]
    v_exp_f32 v116, v116
    v_mfma_f32_16x16x32_bf16 v[36:39], a[156:159], v[172:175], v[36:39]
    ds_read_b64_tr_b16 a[244:245], v225 offset:24576
    v_add_f32 v238, v238, v110
    v_mfma_f32_16x16x32_bf16 v[40:43], a[160:163], v[160:163], v[200:203]
    v_exp_f32 v117, v117
    v_mfma_f32_16x16x32_bf16 v[40:43], a[164:167], v[164:167], v[40:43]
    ds_read_b64_tr_b16 a[246:247], v225 offset:25600
    v_add_f32 v238, v238, v111
    v_mfma_f32_16x16x32_bf16 v[40:43], a[168:171], v[168:171], v[40:43]
    ds_read_b64_tr_b16 a[216:217], v226 offset:16384
    v_cvt_pk_bf16_f32 v107, v110, v111
    v_mfma_f32_16x16x32_bf16 v[40:43], a[172:175], v[172:175], v[40:43]
    v_exp_f32 v118, v118
    v_mfma_f32_16x16x32_bf16 v[44:47], a[176:179], v[160:163], v[200:203]
    ds_read_b64_tr_b16 a[218:219], v226 offset:17408
    v_cvt_pk_bf16_f32 v112, v112, v113
    v_mfma_f32_16x16x32_bf16 v[44:47], a[180:183], v[164:167], v[44:47]
    v_exp_f32 v119, v119
    v_mfma_f32_16x16x32_bf16 v[44:47], a[184:187], v[168:171], v[44:47]
    ds_read_b64_tr_b16 a[248:249], v226 offset:24576
    v_cvt_pk_bf16_f32 v113, v114, v115
    v_mfma_f32_16x16x32_bf16 v[44:47], a[188:191], v[172:175], v[44:47]
    v_exp_f32 v120, v120
    v_mfma_f32_16x16x32_bf16 v[48:51], a[128:131], v[176:179], v[204:207]
    ds_read_b64_tr_b16 a[250:251], v226 offset:25600
    v_cvt_pk_bf16_f32 v114, v116, v117
    v_mfma_f32_16x16x32_bf16 v[48:51], a[132:135], v[180:183], v[48:51]
    ds_read_b64_tr_b16 a[220:221], v227 offset:16384
    v_cvt_pk_bf16_f32 v115, v118, v119
    v_mfma_f32_16x16x32_bf16 v[48:51], a[136:139], v[184:187], v[48:51]
    v_exp_f32 v121, v121
    v_mfma_f32_16x16x32_bf16 v[48:51], a[140:143], v[188:191], v[48:51]
    ds_read_b64_tr_b16 a[222:223], v227 offset:17408
    v_cvt_pk_bf16_f32 v120, v120, v121
    v_mfma_f32_16x16x32_bf16 v[52:55], a[144:147], v[176:179], v[204:207]
    v_exp_f32 v122, v122
    v_mfma_f32_16x16x32_bf16 v[52:55], a[148:151], v[180:183], v[52:55]
    v_exp_f32 v123, v123
    v_mfma_f32_16x16x32_bf16 v[52:55], a[152:155], v[184:187], v[52:55]
    ds_read_b64_tr_b16 a[252:253], v227 offset:24576
    v_cvt_pk_bf16_f32 v121, v122, v123
    v_mfma_f32_16x16x32_bf16 v[52:55], a[156:159], v[188:191], v[52:55]
    ds_read_b64_tr_b16 a[254:255], v227 offset:25600
    v_mfma_f32_16x16x32_bf16 v[56:59], a[160:163], v[176:179], v[204:207]
    v_exp_f32 v124, v124
    v_mfma_f32_16x16x32_bf16 v[56:59], a[164:167], v[180:183], v[56:59]
    v_exp_f32 v125, v125
    v_mfma_f32_16x16x32_bf16 v[56:59], a[168:171], v[184:187], v[56:59]
    v_exp_f32 v126, v126
    v_mfma_f32_16x16x32_bf16 v[56:59], a[172:175], v[188:191], v[56:59]
    v_exp_f32 v127, v127
    v_mfma_f32_16x16x32_bf16 v[60:63], a[176:179], v[176:179], v[204:207]
    v_cvt_pk_bf16_f32 v122, v124, v125
    v_cvt_pk_bf16_f32 v123, v126, v127
    v_mfma_f32_16x16x32_bf16 v[60:63], a[180:183], v[180:183], v[60:63]
    s_mov_b32 m0, 162304
    v_mfma_f32_16x16x32_bf16 v[60:63], a[184:187], v[184:187], v[60:63]
    buffer_load_dword v253, s[4:7], s38 offen lds
    v_mfma_f32_16x16x32_bf16 v[60:63], a[188:191], v[188:191], v[60:63]
    s_waitcnt vmcnt(19) lgkmcnt(0)
    s_barrier
    v_mfma_f32_16x16x32_bf16 a[0:3], a[192:195], v[64:67], a[0:3]
    v_exp_f32 v0, v0
    v_mfma_f32_16x16x32_bf16 a[0:3], a[224:227], v[72:75], a[0:3]
    v_exp_f32 v1, v1
    v_mfma_f32_16x16x32_bf16 a[4:7], a[196:199], v[64:67], a[4:7]
    v_add_f32 v236, v236, v0
    v_add_f32 v236, v236, v1
    v_mfma_f32_16x16x32_bf16 a[4:7], a[228:231], v[72:75], a[4:7]
    s_mov_b32 m0, s29
    v_exp_f32 v2, v2
    v_mfma_f32_16x16x32_bf16 a[8:11], a[200:203], v[64:67], a[8:11]
    buffer_load_dwordx4 v234, s[16:19], s33 offen offset:0  lds
    v_mfma_f32_16x16x32_bf16 a[8:11], a[232:235], v[72:75], a[8:11]
    ds_read_b128 a[128:131], v228 offset:49152
    v_cvt_pk_bf16_f32 v0, v0, v1
    v_mfma_f32_16x16x32_bf16 a[12:15], a[204:207], v[64:67], a[12:15]
    v_exp_f32 v3, v3
    v_mfma_f32_16x16x32_bf16 a[12:15], a[236:239], v[72:75], a[12:15]
    ds_read_b128 a[132:135], v229 offset:49152
    v_add_f32 v236, v236, v2
    v_mfma_f32_16x16x32_bf16 a[16:19], a[208:211], v[64:67], a[16:19]
    v_add_f32 v236, v236, v3
    v_cvt_pk_bf16_f32 v1, v2, v3
    v_mfma_f32_16x16x32_bf16 a[16:19], a[240:243], v[72:75], a[16:19]
    v_exp_f32 v4, v4
    v_mfma_f32_16x16x32_bf16 a[20:23], a[212:215], v[64:67], a[20:23]
    v_exp_f32 v5, v5
    v_mfma_f32_16x16x32_bf16 a[20:23], a[244:247], v[72:75], a[20:23]
    ds_read_b128 a[136:139], v230 offset:49152
    v_add_f32 v236, v236, v4
    v_mfma_f32_16x16x32_bf16 a[24:27], a[216:219], v[64:67], a[24:27]
    buffer_load_dwordx4 v234, s[16:19], s33 offen offset:1024  lds
    v_mfma_f32_16x16x32_bf16 a[24:27], a[248:251], v[72:75], a[24:27]
    v_add_f32 v236, v236, v5
    v_cvt_pk_bf16_f32 v2, v4, v5
    v_mfma_f32_16x16x32_bf16 a[28:31], a[220:223], v[64:67], a[28:31]
    v_exp_f32 v6, v6
    v_mfma_f32_16x16x32_bf16 a[28:31], a[252:255], v[72:75], a[28:31]
    ds_read_b128 a[140:143], v231 offset:49152
    v_add_f32 v236, v236, v6
    v_mfma_f32_16x16x32_bf16 a[32:35], a[192:195], v[80:83], a[32:35]
    v_exp_f32 v7, v7
    v_mfma_f32_16x16x32_bf16 a[32:35], a[224:227], v[88:91], a[32:35]
    v_add_f32 v236, v236, v7
    v_cvt_pk_bf16_f32 v3, v6, v7
    v_mfma_f32_16x16x32_bf16 a[36:39], a[196:199], v[80:83], a[36:39]
    v_exp_f32 v8, v8
    v_mfma_f32_16x16x32_bf16 a[36:39], a[228:231], v[88:91], a[36:39]
    ds_read_b128 a[144:147], v228 offset:50176
    v_add_f32 v236, v236, v8
    v_mfma_f32_16x16x32_bf16 a[40:43], a[200:203], v[80:83], a[40:43]
    buffer_load_dwordx4 v235, s[16:19], s33 offen offset:2048  lds
    v_mfma_f32_16x16x32_bf16 a[40:43], a[232:235], v[88:91], a[40:43]
    v_exp_f32 v9, v9
    v_mfma_f32_16x16x32_bf16 a[44:47], a[204:207], v[80:83], a[44:47]
    ds_read_b128 a[148:151], v229 offset:50176
    v_add_f32 v236, v236, v9
    v_mfma_f32_16x16x32_bf16 a[44:47], a[236:239], v[88:91], a[44:47]
    v_exp_f32 v10, v10
    v_mfma_f32_16x16x32_bf16 a[48:51], a[208:211], v[80:83], a[48:51]
    v_cvt_pk_bf16_f32 v8, v8, v9
    v_add_f32 v236, v236, v10
    v_mfma_f32_16x16x32_bf16 a[48:51], a[240:243], v[88:91], a[48:51]
    v_exp_f32 v11, v11
    v_mfma_f32_16x16x32_bf16 a[52:55], a[212:215], v[80:83], a[52:55]
    ds_read_b128 a[152:155], v230 offset:50176
    v_add_f32 v236, v236, v11
    v_mfma_f32_16x16x32_bf16 a[52:55], a[244:247], v[88:91], a[52:55]
    v_exp_f32 v12, v12
    v_mfma_f32_16x16x32_bf16 a[56:59], a[216:219], v[80:83], a[56:59]
    buffer_load_dwordx4 v235, s[16:19], s33 offen offset:3072  lds
    v_mfma_f32_16x16x32_bf16 a[56:59], a[248:251], v[88:91], a[56:59]
    ds_read_b128 a[156:159], v231 offset:50176
    v_cvt_pk_bf16_f32 v9, v10, v11
    v_mfma_f32_16x16x32_bf16 a[60:63], a[220:223], v[80:83], a[60:63]
    v_exp_f32 v13, v13
    v_mfma_f32_16x16x32_bf16 a[60:63], a[252:255], v[88:91], a[60:63]
    v_add_f32 v236, v236, v12
    v_add_f32 v236, v236, v13
    v_mfma_f32_16x16x32_bf16 v[208:211], v[216:219], v[80:83], v[208:211]
    ds_read_b128 a[160:163], v228 offset:57344
    v_cvt_pk_bf16_f32 v10, v12, v13
    v_mfma_f32_16x16x32_bf16 v[208:211], v[216:219], v[88:91], v[208:211]
    v_exp_f32 v14, v14
    v_mfma_f32_16x16x32_bf16 a[64:67], a[192:195], v[96:99], a[64:67]
    s_add_u32 s33, s33, 16384
    v_exp_f32 v15, v15
    v_mfma_f32_16x16x32_bf16 a[64:67], a[224:227], v[104:107], a[64:67]
    s_mov_b32 m0, s26
    v_exp_f32 v16, v16
    v_mfma_f32_16x16x32_bf16 a[68:71], a[196:199], v[96:99], a[68:71]
    buffer_load_dwordx4 v232, s[12:15], s32 offen offset:0  lds
    v_mfma_f32_16x16x32_bf16 a[68:71], a[228:231], v[104:107], a[68:71]
    ds_read_b128 a[164:167], v229 offset:57344
    v_add_f32 v236, v236, v14
    v_mfma_f32_16x16x32_bf16 a[72:75], a[200:203], v[96:99], a[72:75]
    v_add_f32 v236, v236, v15
    v_cvt_pk_bf16_f32 v11, v14, v15
    v_mfma_f32_16x16x32_bf16 a[72:75], a[232:235], v[104:107], a[72:75]
    v_exp_f32 v17, v17
    v_mfma_f32_16x16x32_bf16 a[76:79], a[204:207], v[96:99], a[76:79]
    ds_read_b128 a[168:171], v230 offset:57344
    v_cvt_pk_bf16_f32 v16, v16, v17
    v_mfma_f32_16x16x32_bf16 a[76:79], a[236:239], v[104:107], a[76:79]
    v_exp_f32 v18, v18
    v_mfma_f32_16x16x32_bf16 a[80:83], a[208:211], v[96:99], a[80:83]
    v_exp_f32 v19, v19
    v_mfma_f32_16x16x32_bf16 a[80:83], a[240:243], v[104:107], a[80:83]
    ds_read_b128 a[172:175], v231 offset:57344
    v_cvt_pk_bf16_f32 v17, v18, v19
    v_mfma_f32_16x16x32_bf16 a[84:87], a[212:215], v[96:99], a[84:87]
    buffer_load_dwordx4 v232, s[12:15], s32 offen offset:1024  lds
    v_mfma_f32_16x16x32_bf16 a[84:87], a[244:247], v[104:107], a[84:87]
    v_exp_f32 v20, v20
    v_mfma_f32_16x16x32_bf16 a[88:91], a[216:219], v[96:99], a[88:91]
    v_exp_f32 v21, v21
    v_mfma_f32_16x16x32_bf16 a[88:91], a[248:251], v[104:107], a[88:91]
    ds_read_b128 a[176:179], v228 offset:58368
    v_cvt_pk_bf16_f32 v18, v20, v21
    v_mfma_f32_16x16x32_bf16 a[92:95], a[220:223], v[96:99], a[92:95]
    v_exp_f32 v22, v22
    v_mfma_f32_16x16x32_bf16 a[92:95], a[252:255], v[104:107], a[92:95]
    v_exp_f32 v23, v23
    v_mfma_f32_16x16x32_bf16 a[96:99], a[192:195], v[112:115], a[96:99]
    ds_read_b128 a[180:183], v229 offset:58368
    v_cvt_pk_bf16_f32 v19, v22, v23
    v_mfma_f32_16x16x32_bf16 a[96:99], a[224:227], v[120:123], a[96:99]
    v_exp_f32 v24, v24
    v_mfma_f32_16x16x32_bf16 a[100:103], a[196:199], v[112:115], a[100:103]
    buffer_load_dwordx4 v233, s[12:15], s32 offen offset:2048  lds
    v_mfma_f32_16x16x32_bf16 a[100:103], a[228:231], v[120:123], a[100:103]
    v_exp_f32 v25, v25
    v_mfma_f32_16x16x32_bf16 a[104:107], a[200:203], v[112:115], a[104:107]
    ds_read_b128 a[184:187], v230 offset:58368
    v_cvt_pk_bf16_f32 v24, v24, v25
    v_mfma_f32_16x16x32_bf16 a[104:107], a[232:235], v[120:123], a[104:107]
    v_exp_f32 v26, v26
    v_mfma_f32_16x16x32_bf16 a[108:111], a[204:207], v[112:115], a[108:111]
    ds_read_b128 a[188:191], v231 offset:58368
    v_mfma_f32_16x16x32_bf16 a[108:111], a[236:239], v[120:123], a[108:111]
    v_exp_f32 v27, v27
    v_mfma_f32_16x16x32_bf16 a[112:115], a[208:211], v[112:115], a[112:115]
    v_exp_f32 v28, v28
    v_mfma_f32_16x16x32_bf16 a[112:115], a[240:243], v[120:123], a[112:115]
    v_exp_f32 v29, v29
    v_mfma_f32_16x16x32_bf16 a[116:119], a[212:215], v[112:115], a[116:119]
    buffer_load_dwordx4 v233, s[12:15], s32 offen offset:3072  lds
    v_mfma_f32_16x16x32_bf16 a[116:119], a[244:247], v[120:123], a[116:119]
    s_add_u32 s32, s32, 16384
    v_exp_f32 v30, v30
    v_mfma_f32_16x16x32_bf16 a[120:123], a[216:219], v[112:115], a[120:123]
    v_cvt_pk_bf16_f32 v25, v26, v27
    v_cvt_pk_bf16_f32 v26, v28, v29
    v_mfma_f32_16x16x32_bf16 a[120:123], a[248:251], v[120:123], a[120:123]
    v_exp_f32 v31, v31
    v_mfma_f32_16x16x32_bf16 a[124:127], a[220:223], v[112:115], a[124:127]
    v_exp_f32 v32, v32
    v_mfma_f32_16x16x32_bf16 a[124:127], a[252:255], v[120:123], a[124:127]
    v_exp_f32 v33, v33
    v_mfma_f32_16x16x32_bf16 v[212:215], v[216:219], v[112:115], v[212:215]
    v_exp_f32 v34, v34
    v_mfma_f32_16x16x32_bf16 v[212:215], v[216:219], v[120:123], v[212:215]
    s_waitcnt lgkmcnt(0)
    v_exp_f32 v35, v35
    v_mfma_f32_16x16x32_bf16 v[64:67], a[128:131], v[128:131], v[192:195]
    ds_read_b64_tr_b16 a[192:193], v220 offset:32768
    v_cvt_pk_bf16_f32 v27, v30, v31
    v_mfma_f32_16x16x32_bf16 v[64:67], a[132:135], v[132:135], v[64:67]
    v_exp_f32 v36, v36
    v_mfma_f32_16x16x32_bf16 v[64:67], a[136:139], v[136:139], v[64:67]
    ds_read_b64_tr_b16 a[194:195], v220 offset:33792
    v_add_f32 v238, v238, v32
    v_mfma_f32_16x16x32_bf16 v[64:67], a[140:143], v[140:143], v[64:67]
    v_exp_f32 v37, v37
    v_mfma_f32_16x16x32_bf16 v[68:71], a[144:147], v[128:131], v[192:195]
    ds_read_b64_tr_b16 a[224:225], v220 offset:40960
    v_add_f32 v238, v238, v33
    v_mfma_f32_16x16x32_bf16 v[68:71], a[148:151], v[132:135], v[68:71]
    v_exp_f32 v38, v38
    v_mfma_f32_16x16x32_bf16 v[68:71], a[152:155], v[136:139], v[68:71]
    ds_read_b64_tr_b16 a[226:227], v220 offset:41984
    v_cvt_pk_bf16_f32 v32, v32, v33
    v_mfma_f32_16x16x32_bf16 v[68:71], a[156:159], v[140:143], v[68:71]
    ds_read_b64_tr_b16 a[196:197], v221 offset:32768
    v_add_f32 v238, v238, v34
    v_mfma_f32_16x16x32_bf16 v[72:75], a[160:163], v[128:131], v[192:195]
    v_exp_f32 v39, v39
    v_mfma_f32_16x16x32_bf16 v[72:75], a[164:167], v[132:135], v[72:75]
    ds_read_b64_tr_b16 a[198:199], v221 offset:33792
    v_add_f32 v238, v238, v35
    v_mfma_f32_16x16x32_bf16 v[72:75], a[168:171], v[136:139], v[72:75]
    v_exp_f32 v40, v40
    v_mfma_f32_16x16x32_bf16 v[72:75], a[172:175], v[140:143], v[72:75]
    ds_read_b64_tr_b16 a[228:229], v221 offset:40960
    v_cvt_pk_bf16_f32 v33, v34, v35
    v_mfma_f32_16x16x32_bf16 v[76:79], a[176:179], v[128:131], v[192:195]
    v_exp_f32 v41, v41
    v_mfma_f32_16x16x32_bf16 v[76:79], a[180:183], v[132:135], v[76:79]
    ds_read_b64_tr_b16 a[230:231], v221 offset:41984
    v_add_f32 v238, v238, v36
    v_mfma_f32_16x16x32_bf16 v[76:79], a[184:187], v[136:139], v[76:79]
    ds_read_b64_tr_b16 a[200:201], v222 offset:32768
    v_add_f32 v238, v238, v37
    v_mfma_f32_16x16x32_bf16 v[76:79], a[188:191], v[140:143], v[76:79]
    v_exp_f32 v42, v42
    v_mfma_f32_16x16x32_bf16 v[80:83], a[128:131], v[144:147], v[196:199]
    ds_read_b64_tr_b16 a[202:203], v222 offset:33792
    v_cvt_pk_bf16_f32 v34, v36, v37
    v_mfma_f32_16x16x32_bf16 v[80:83], a[132:135], v[148:151], v[80:83]
    v_exp_f32 v43, v43
    v_mfma_f32_16x16x32_bf16 v[80:83], a[136:139], v[152:155], v[80:83]
    ds_read_b64_tr_b16 a[232:233], v222 offset:40960
    v_add_f32 v238, v238, v38
    v_mfma_f32_16x16x32_bf16 v[80:83], a[140:143], v[156:159], v[80:83]
    v_exp_f32 v44, v44
    v_mfma_f32_16x16x32_bf16 v[84:87], a[144:147], v[144:147], v[196:199]
    ds_read_b64_tr_b16 a[234:235], v222 offset:41984
    v_add_f32 v238, v238, v39
    v_mfma_f32_16x16x32_bf16 v[84:87], a[148:151], v[148:151], v[84:87]
    ds_read_b64_tr_b16 a[204:205], v223 offset:32768
    v_cvt_pk_bf16_f32 v35, v38, v39
    v_mfma_f32_16x16x32_bf16 v[84:87], a[152:155], v[152:155], v[84:87]
    v_exp_f32 v45, v45
    v_mfma_f32_16x16x32_bf16 v[84:87], a[156:159], v[156:159], v[84:87]
    ds_read_b64_tr_b16 a[206:207], v223 offset:33792
    v_add_f32 v238, v238, v40
    v_mfma_f32_16x16x32_bf16 v[88:91], a[160:163], v[144:147], v[196:199]
    v_exp_f32 v46, v46
    v_mfma_f32_16x16x32_bf16 v[88:91], a[164:167], v[148:151], v[88:91]
    ds_read_b64_tr_b16 a[236:237], v223 offset:40960
    v_add_f32 v238, v238, v41
    v_mfma_f32_16x16x32_bf16 v[88:91], a[168:171], v[152:155], v[88:91]
    v_exp_f32 v47, v47
    v_mfma_f32_16x16x32_bf16 v[88:91], a[172:175], v[156:159], v[88:91]
    ds_read_b64_tr_b16 a[238:239], v223 offset:41984
    v_cvt_pk_bf16_f32 v40, v40, v41
    v_mfma_f32_16x16x32_bf16 v[92:95], a[176:179], v[144:147], v[196:199]
    ds_read_b64_tr_b16 a[208:209], v224 offset:32768
    v_add_f32 v238, v238, v42
    v_mfma_f32_16x16x32_bf16 v[92:95], a[180:183], v[148:151], v[92:95]
    v_exp_f32 v48, v48
    v_mfma_f32_16x16x32_bf16 v[92:95], a[184:187], v[152:155], v[92:95]
    ds_read_b64_tr_b16 a[210:211], v224 offset:33792
    v_add_f32 v238, v238, v43
    v_mfma_f32_16x16x32_bf16 v[92:95], a[188:191], v[156:159], v[92:95]
    v_exp_f32 v49, v49
    v_mfma_f32_16x16x32_bf16 v[96:99], a[128:131], v[160:163], v[200:203]
    ds_read_b64_tr_b16 a[240:241], v224 offset:40960
    v_cvt_pk_bf16_f32 v41, v42, v43
    v_mfma_f32_16x16x32_bf16 v[96:99], a[132:135], v[164:167], v[96:99]
    v_exp_f32 v50, v50
    v_mfma_f32_16x16x32_bf16 v[96:99], a[136:139], v[168:171], v[96:99]
    ds_read_b64_tr_b16 a[242:243], v224 offset:41984
    v_add_f32 v238, v238, v44
    v_mfma_f32_16x16x32_bf16 v[96:99], a[140:143], v[172:175], v[96:99]
    ds_read_b64_tr_b16 a[212:213], v225 offset:32768
    v_add_f32 v238, v238, v45
    v_mfma_f32_16x16x32_bf16 v[100:103], a[144:147], v[160:163], v[200:203]
    v_exp_f32 v51, v51
    v_mfma_f32_16x16x32_bf16 v[100:103], a[148:151], v[164:167], v[100:103]
    ds_read_b64_tr_b16 a[214:215], v225 offset:33792
    v_cvt_pk_bf16_f32 v42, v44, v45
    v_mfma_f32_16x16x32_bf16 v[100:103], a[152:155], v[168:171], v[100:103]
    v_exp_f32 v52, v52
    v_mfma_f32_16x16x32_bf16 v[100:103], a[156:159], v[172:175], v[100:103]
    ds_read_b64_tr_b16 a[244:245], v225 offset:40960
    v_add_f32 v238, v238, v46
    v_mfma_f32_16x16x32_bf16 v[104:107], a[160:163], v[160:163], v[200:203]
    v_exp_f32 v53, v53
    v_mfma_f32_16x16x32_bf16 v[104:107], a[164:167], v[164:167], v[104:107]
    ds_read_b64_tr_b16 a[246:247], v225 offset:41984
    v_add_f32 v238, v238, v47
    v_mfma_f32_16x16x32_bf16 v[104:107], a[168:171], v[168:171], v[104:107]
    ds_read_b64_tr_b16 a[216:217], v226 offset:32768
    v_cvt_pk_bf16_f32 v43, v46, v47
    v_mfma_f32_16x16x32_bf16 v[104:107], a[172:175], v[172:175], v[104:107]
    s_branch L_io7
    .p2align 12
L_iw7:
    s_branch L_iwr7
L_io7:
    v_exp_f32 v54, v54
    v_mfma_f32_16x16x32_bf16 v[108:111], a[176:179], v[160:163], v[200:203]
    ds_read_b64_tr_b16 a[218:219], v226 offset:33792
    v_cvt_pk_bf16_f32 v48, v48, v49
    v_mfma_f32_16x16x32_bf16 v[108:111], a[180:183], v[164:167], v[108:111]
    v_exp_f32 v55, v55
    v_mfma_f32_16x16x32_bf16 v[108:111], a[184:187], v[168:171], v[108:111]
    ds_read_b64_tr_b16 a[248:249], v226 offset:40960
    v_cvt_pk_bf16_f32 v49, v50, v51
    v_mfma_f32_16x16x32_bf16 v[108:111], a[188:191], v[172:175], v[108:111]
    v_exp_f32 v56, v56
    v_mfma_f32_16x16x32_bf16 v[112:115], a[128:131], v[176:179], v[204:207]
    ds_read_b64_tr_b16 a[250:251], v226 offset:41984
    v_cvt_pk_bf16_f32 v50, v52, v53
    v_mfma_f32_16x16x32_bf16 v[112:115], a[132:135], v[180:183], v[112:115]
    ds_read_b64_tr_b16 a[220:221], v227 offset:32768
    v_cvt_pk_bf16_f32 v51, v54, v55
    v_mfma_f32_16x16x32_bf16 v[112:115], a[136:139], v[184:187], v[112:115]
    v_exp_f32 v57, v57
    v_mfma_f32_16x16x32_bf16 v[112:115], a[140:143], v[188:191], v[112:115]
    ds_read_b64_tr_b16 a[222:223], v227 offset:33792
    v_cvt_pk_bf16_f32 v56, v56, v57
    v_mfma_f32_16x16x32_bf16 v[116:119], a[144:147], v[176:179], v[204:207]
    v_exp_f32 v58, v58
    v_mfma_f32_16x16x32_bf16 v[116:119], a[148:151], v[180:183], v[116:119]
    v_exp_f32 v59, v59
    v_mfma_f32_16x16x32_bf16 v[116:119], a[152:155], v[184:187], v[116:119]
    ds_read_b64_tr_b16 a[252:253], v227 offset:40960
    v_cvt_pk_bf16_f32 v57, v58, v59
    v_mfma_f32_16x16x32_bf16 v[116:119], a[156:159], v[188:191], v[116:119]
    ds_read_b64_tr_b16 a[254:255], v227 offset:41984
    v_mfma_f32_16x16x32_bf16 v[120:123], a[160:163], v[176:179], v[204:207]
    v_exp_f32 v60, v60
    v_mfma_f32_16x16x32_bf16 v[120:123], a[164:167], v[180:183], v[120:123]
    v_exp_f32 v61, v61
    v_mfma_f32_16x16x32_bf16 v[120:123], a[168:171], v[184:187], v[120:123]
    v_exp_f32 v62, v62
    v_mfma_f32_16x16x32_bf16 v[120:123], a[172:175], v[188:191], v[120:123]
    v_exp_f32 v63, v63
    v_mfma_f32_16x16x32_bf16 v[124:127], a[176:179], v[176:179], v[204:207]
    v_cvt_pk_bf16_f32 v58, v60, v61
    v_cvt_pk_bf16_f32 v59, v62, v63
    v_mfma_f32_16x16x32_bf16 v[124:127], a[180:183], v[180:183], v[124:127]
    s_mov_b32 s76, s44
    s_mov_b32 s77, s45
    v_mfma_f32_16x16x32_bf16 v[124:127], a[184:187], v[184:187], v[124:127]
    s_mov_b32 s78, 2097152
    s_mov_b32 s79, 0x20000
    v_mfma_f32_16x16x32_bf16 v[124:127], a[188:191], v[188:191], v[124:127]
    s_waitcnt vmcnt(18) lgkmcnt(0)
    s_barrier
    v_mfma_f32_16x16x32_bf16 a[0:3], a[192:195], v[0:3], a[0:3]
    v_exp_f32 v64, v64
    v_mfma_f32_16x16x32_bf16 a[0:3], a[224:227], v[8:11], a[0:3]
    v_exp_f32 v65, v65
    v_mfma_f32_16x16x32_bf16 a[4:7], a[196:199], v[0:3], a[4:7]
    v_add_f32 v236, v236, v64
    v_add_f32 v236, v236, v65
    v_mfma_f32_16x16x32_bf16 a[4:7], a[228:231], v[8:11], a[4:7]
    s_mov_b32 s54, 16793600
    v_exp_f32 v66, v66
    v_mfma_f32_16x16x32_bf16 a[8:11], a[200:203], v[0:3], a[8:11]
    buffer_load_dwordx4 v[244:247], v252, s[20:23], s54 offen offset:0 sc1
    v_mfma_f32_16x16x32_bf16 a[8:11], a[232:235], v[8:11], a[8:11]
    ds_read_b128 a[128:131], v228 offset:0
    v_cvt_pk_bf16_f32 v64, v64, v65
    v_mfma_f32_16x16x32_bf16 a[12:15], a[204:207], v[0:3], a[12:15]
    v_exp_f32 v67, v67
    v_mfma_f32_16x16x32_bf16 a[12:15], a[236:239], v[8:11], a[12:15]
    ds_read_b128 a[132:135], v229 offset:0
    v_add_f32 v236, v236, v66
    v_mfma_f32_16x16x32_bf16 a[16:19], a[208:211], v[0:3], a[16:19]
    v_add_f32 v236, v236, v67
    v_cvt_pk_bf16_f32 v65, v66, v67
    v_mfma_f32_16x16x32_bf16 a[16:19], a[240:243], v[8:11], a[16:19]
    v_exp_f32 v68, v68
    v_mfma_f32_16x16x32_bf16 a[20:23], a[212:215], v[0:3], a[20:23]
    buffer_load_dwordx4 v[248:251], v252, s[20:23], s54 offen offset:1024 sc1
    v_mfma_f32_16x16x32_bf16 a[20:23], a[244:247], v[8:11], a[20:23]
    ds_read_b128 a[136:139], v230 offset:0
    v_add_f32 v236, v236, v68
    v_mfma_f32_16x16x32_bf16 a[24:27], a[216:219], v[0:3], a[24:27]
    v_exp_f32 v69, v69
    v_mfma_f32_16x16x32_bf16 a[24:27], a[248:251], v[8:11], a[24:27]
    v_add_f32 v236, v236, v69
    v_cvt_pk_bf16_f32 v66, v68, v69
    v_mfma_f32_16x16x32_bf16 a[28:31], a[220:223], v[0:3], a[28:31]
    v_exp_f32 v70, v70
    v_mfma_f32_16x16x32_bf16 a[28:31], a[252:255], v[8:11], a[28:31]
    s_mov_b32 m0, s30
    v_exp_f32 v71, v71
    v_mfma_f32_16x16x32_bf16 a[32:35], a[192:195], v[16:19], a[32:35]
    buffer_load_dwordx4 v234, s[16:19], s33 offen offset:0  lds
    v_mfma_f32_16x16x32_bf16 a[32:35], a[224:227], v[24:27], a[32:35]
    ds_read_b128 a[140:143], v231 offset:0
    v_add_f32 v236, v236, v70
    v_mfma_f32_16x16x32_bf16 a[36:39], a[196:199], v[16:19], a[36:39]
    ds_read_b128 a[144:147], v228 offset:1024
    v_add_f32 v236, v236, v71
    v_mfma_f32_16x16x32_bf16 a[36:39], a[228:231], v[24:27], a[36:39]
    v_exp_f32 v72, v72
    v_mfma_f32_16x16x32_bf16 a[40:43], a[200:203], v[16:19], a[40:43]
    v_cvt_pk_bf16_f32 v67, v70, v71
    v_add_f32 v236, v236, v72
    v_mfma_f32_16x16x32_bf16 a[40:43], a[232:235], v[24:27], a[40:43]
    v_exp_f32 v73, v73
    v_mfma_f32_16x16x32_bf16 a[44:47], a[204:207], v[16:19], a[44:47]
    ds_read_b128 a[148:151], v229 offset:1024
    v_add_f32 v236, v236, v73
    v_mfma_f32_16x16x32_bf16 a[44:47], a[236:239], v[24:27], a[44:47]
    buffer_load_dwordx4 v234, s[16:19], s33 offen offset:1024  lds
    v_mfma_f32_16x16x32_bf16 a[48:51], a[208:211], v[16:19], a[48:51]
    v_exp_f32 v74, v74
    v_mfma_f32_16x16x32_bf16 a[48:51], a[240:243], v[24:27], a[48:51]
    ds_read_b128 a[152:155], v230 offset:1024
    v_cvt_pk_bf16_f32 v72, v72, v73
    v_mfma_f32_16x16x32_bf16 a[52:55], a[212:215], v[16:19], a[52:55]
    v_exp_f32 v75, v75
    v_mfma_f32_16x16x32_bf16 a[52:55], a[244:247], v[24:27], a[52:55]
    v_add_f32 v236, v236, v74
    v_add_f32 v236, v236, v75
    v_mfma_f32_16x16x32_bf16 a[56:59], a[216:219], v[16:19], a[56:59]
    ds_read_b128 a[156:159], v231 offset:1024
    v_cvt_pk_bf16_f32 v73, v74, v75
    v_mfma_f32_16x16x32_bf16 a[56:59], a[248:251], v[24:27], a[56:59]
    buffer_load_dwordx4 v235, s[16:19], s33 offen offset:2048  lds
    v_mfma_f32_16x16x32_bf16 a[60:63], a[220:223], v[16:19], a[60:63]
    v_exp_f32 v76, v76
    v_mfma_f32_16x16x32_bf16 a[60:63], a[252:255], v[24:27], a[60:63]
    v_exp_f32 v77, v77
    v_mfma_f32_16x16x32_bf16 v[208:211], v[216:219], v[16:19], v[208:211]
    ds_read_b128 a[160:163], v228 offset:8192
    v_add_f32 v236, v236, v76
    v_mfma_f32_16x16x32_bf16 v[208:211], v[216:219], v[24:27], v[208:211]
    v_add_f32 v236, v236, v77
    v_cvt_pk_bf16_f32 v74, v76, v77
    v_mfma_f32_16x16x32_bf16 a[64:67], a[192:195], v[32:35], a[64:67]
    v_exp_f32 v78, v78
    v_mfma_f32_16x16x32_bf16 a[64:67], a[224:227], v[40:43], a[64:67]
    buffer_load_dwordx4 v235, s[16:19], s33 offen offset:3072  lds
    v_mfma_f32_16x16x32_bf16 a[68:71], a[196:199], v[32:35], a[68:71]
    ds_read_b128 a[164:167], v229 offset:8192
    v_add_f32 v236, v236, v78
    v_mfma_f32_16x16x32_bf16 a[68:71], a[228:231], v[40:43], a[68:71]
    v_exp_f32 v79, v79
    v_mfma_f32_16x16x32_bf16 a[72:75], a[200:203], v[32:35], a[72:75]
    v_add_f32 v236, v236, v79
    v_cvt_pk_bf16_f32 v75, v78, v79
    v_mfma_f32_16x16x32_bf16 a[72:75], a[232:235], v[40:43], a[72:75]
    s_add_u32 s33, s33, 16384
    v_exp_f32 v80, v80
    v_mfma_f32_16x16x32_bf16 a[76:79], a[204:207], v[32:35], a[76:79]
    s_mov_b32 m0, s27
    v_exp_f32 v81, v81
    v_mfma_f32_16x16x32_bf16 a[76:79], a[236:239], v[40:43], a[76:79]
    buffer_load_dwordx4 v232, s[12:15], s32 offen offset:0  lds
    v_mfma_f32_16x16x32_bf16 a[80:83], a[208:211], v[32:35], a[80:83]
    ds_read_b128 a[168:171], v230 offset:8192
    v_cvt_pk_bf16_f32 v80, v80, v81
    v_mfma_f32_16x16x32_bf16 a[80:83], a[240:243], v[40:43], a[80:83]
    v_exp_f32 v82, v82
    v_mfma_f32_16x16x32_bf16 a[84:87], a[212:215], v[32:35], a[84:87]
    v_exp_f32 v83, v83
    v_mfma_f32_16x16x32_bf16 a[84:87], a[244:247], v[40:43], a[84:87]
    ds_read_b128 a[172:175], v231 offset:8192
    v_cvt_pk_bf16_f32 v81, v82, v83
    v_mfma_f32_16x16x32_bf16 a[88:91], a[216:219], v[32:35], a[88:91]
    v_exp_f32 v84, v84
    v_mfma_f32_16x16x32_bf16 a[88:91], a[248:251], v[40:43], a[88:91]
    v_exp_f32 v85, v85
    v_mfma_f32_16x16x32_bf16 a[92:95], a[220:223], v[32:35], a[92:95]
    buffer_load_dwordx4 v232, s[12:15], s32 offen offset:1024  lds
    v_mfma_f32_16x16x32_bf16 a[92:95], a[252:255], v[40:43], a[92:95]
    ds_read_b128 a[176:179], v228 offset:9216
    v_cvt_pk_bf16_f32 v82, v84, v85
    v_mfma_f32_16x16x32_bf16 a[96:99], a[192:195], v[48:51], a[96:99]
    v_exp_f32 v86, v86
    v_mfma_f32_16x16x32_bf16 a[96:99], a[224:227], v[56:59], a[96:99]
    v_exp_f32 v87, v87
    v_mfma_f32_16x16x32_bf16 a[100:103], a[196:199], v[48:51], a[100:103]
    ds_read_b128 a[180:183], v229 offset:9216
    v_cvt_pk_bf16_f32 v83, v86, v87
    v_mfma_f32_16x16x32_bf16 a[100:103], a[228:231], v[56:59], a[100:103]
    v_exp_f32 v88, v88
    v_mfma_f32_16x16x32_bf16 a[104:107], a[200:203], v[48:51], a[104:107]
    buffer_load_dwordx4 v233, s[12:15], s32 offen offset:2048  lds
    v_mfma_f32_16x16x32_bf16 a[104:107], a[232:235], v[56:59], a[104:107]
    v_exp_f32 v89, v89
    v_mfma_f32_16x16x32_bf16 a[108:111], a[204:207], v[48:51], a[108:111]
    ds_read_b128 a[184:187], v230 offset:9216
    v_cvt_pk_bf16_f32 v88, v88, v89
    v_mfma_f32_16x16x32_bf16 a[108:111], a[236:239], v[56:59], a[108:111]
    ds_read_b128 a[188:191], v231 offset:9216
    v_mfma_f32_16x16x32_bf16 a[112:115], a[208:211], v[48:51], a[112:115]
    v_exp_f32 v90, v90
    v_mfma_f32_16x16x32_bf16 a[112:115], a[240:243], v[56:59], a[112:115]
    v_exp_f32 v91, v91
    v_mfma_f32_16x16x32_bf16 a[116:119], a[212:215], v[48:51], a[116:119]
    buffer_load_dwordx4 v233, s[12:15], s32 offen offset:3072  lds
    v_mfma_f32_16x16x32_bf16 a[116:119], a[244:247], v[56:59], a[116:119]
    s_add_u32 s32, s32, 16384
    v_exp_f32 v92, v92
    v_mfma_f32_16x16x32_bf16 a[120:123], a[216:219], v[48:51], a[120:123]
    v_exp_f32 v93, v93
    v_mfma_f32_16x16x32_bf16 a[120:123], a[248:251], v[56:59], a[120:123]
    v_cvt_pk_bf16_f32 v89, v90, v91
    v_cvt_pk_bf16_f32 v90, v92, v93
    v_mfma_f32_16x16x32_bf16 a[124:127], a[220:223], v[48:51], a[124:127]
    v_exp_f32 v94, v94
    v_mfma_f32_16x16x32_bf16 a[124:127], a[252:255], v[56:59], a[124:127]
    v_exp_f32 v95, v95
    v_mfma_f32_16x16x32_bf16 v[212:215], v[216:219], v[48:51], v[212:215]
    v_exp_f32 v96, v96
    v_mfma_f32_16x16x32_bf16 v[212:215], v[216:219], v[56:59], v[212:215]
    s_waitcnt lgkmcnt(0)
    v_exp_f32 v97, v97
    v_exp_f32 v98, v98
    v_exp_f32 v99, v99
    v_mfma_f32_16x16x32_bf16 v[0:3], a[128:131], v[128:131], v[192:195]
    ds_read_b64_tr_b16 a[192:193], v220 offset:49152
    v_cvt_pk_bf16_f32 v91, v94, v95
    v_mfma_f32_16x16x32_bf16 v[0:3], a[132:135], v[132:135], v[0:3]
    v_exp_f32 v100, v100
    v_mfma_f32_16x16x32_bf16 v[0:3], a[136:139], v[136:139], v[0:3]
    ds_read_b64_tr_b16 a[194:195], v220 offset:50176
    v_add_f32 v238, v238, v96
    v_mfma_f32_16x16x32_bf16 v[0:3], a[140:143], v[140:143], v[0:3]
    v_exp_f32 v101, v101
    v_mfma_f32_16x16x32_bf16 v[4:7], a[144:147], v[128:131], v[192:195]
    ds_read_b64_tr_b16 a[224:225], v220 offset:57344
    v_add_f32 v238, v238, v97
    v_mfma_f32_16x16x32_bf16 v[4:7], a[148:151], v[132:135], v[4:7]
    v_exp_f32 v102, v102
    v_mfma_f32_16x16x32_bf16 v[4:7], a[152:155], v[136:139], v[4:7]
    ds_read_b64_tr_b16 a[226:227], v220 offset:58368
    v_cvt_pk_bf16_f32 v96, v96, v97
    v_mfma_f32_16x16x32_bf16 v[4:7], a[156:159], v[140:143], v[4:7]
    ds_read_b64_tr_b16 a[196:197], v221 offset:49152
    v_add_f32 v238, v238, v98
    v_mfma_f32_16x16x32_bf16 v[8:11], a[160:163], v[128:131], v[192:195]
    v_exp_f32 v103, v103
    v_mfma_f32_16x16x32_bf16 v[8:11], a[164:167], v[132:135], v[8:11]
    ds_read_b64_tr_b16 a[198:199], v221 offset:50176
    v_add_f32 v238, v238, v99
    v_mfma_f32_16x16x32_bf16 v[8:11], a[168:171], v[136:139], v[8:11]
    v_exp_f32 v104, v104
    v_mfma_f32_16x16x32_bf16 v[8:11], a[172:175], v[140:143], v[8:11]
    ds_read_b64_tr_b16 a[228:229], v221 offset:57344
    v_cvt_pk_bf16_f32 v97, v98, v99
    v_mfma_f32_16x16x32_bf16 v[12:15], a[176:179], v[128:131], v[192:195]
    v_exp_f32 v105, v105
    v_mfma_f32_16x16x32_bf16 v[12:15], a[180:183], v[132:135], v[12:15]
    ds_read_b64_tr_b16 a[230:231], v221 offset:58368
    v_add_f32 v238, v238, v100
    v_mfma_f32_16x16x32_bf16 v[12:15], a[184:187], v[136:139], v[12:15]
    ds_read_b64_tr_b16 a[200:201], v222 offset:49152
    v_add_f32 v238, v238, v101
    v_mfma_f32_16x16x32_bf16 v[12:15], a[188:191], v[140:143], v[12:15]
    v_exp_f32 v106, v106
    v_mfma_f32_16x16x32_bf16 v[16:19], a[128:131], v[144:147], v[196:199]
    ds_read_b64_tr_b16 a[202:203], v222 offset:50176
    v_cvt_pk_bf16_f32 v98, v100, v101
    v_mfma_f32_16x16x32_bf16 v[16:19], a[132:135], v[148:151], v[16:19]
    v_exp_f32 v107, v107
    v_mfma_f32_16x16x32_bf16 v[16:19], a[136:139], v[152:155], v[16:19]
    ds_read_b64_tr_b16 a[232:233], v222 offset:57344
    v_add_f32 v238, v238, v102
    v_mfma_f32_16x16x32_bf16 v[16:19], a[140:143], v[156:159], v[16:19]
    v_exp_f32 v108, v108
    v_mfma_f32_16x16x32_bf16 v[20:23], a[144:147], v[144:147], v[196:199]
    ds_read_b64_tr_b16 a[234:235], v222 offset:58368
    v_add_f32 v238, v238, v103
    v_mfma_f32_16x16x32_bf16 v[20:23], a[148:151], v[148:151], v[20:23]
    ds_read_b64_tr_b16 a[204:205], v223 offset:49152
    v_cvt_pk_bf16_f32 v99, v102, v103
    v_mfma_f32_16x16x32_bf16 v[20:23], a[152:155], v[152:155], v[20:23]
    v_exp_f32 v109, v109
    v_mfma_f32_16x16x32_bf16 v[20:23], a[156:159], v[156:159], v[20:23]
    ds_read_b64_tr_b16 a[206:207], v223 offset:50176
    v_add_f32 v238, v238, v104
    v_mfma_f32_16x16x32_bf16 v[24:27], a[160:163], v[144:147], v[196:199]
    v_exp_f32 v110, v110
    v_mfma_f32_16x16x32_bf16 v[24:27], a[164:167], v[148:151], v[24:27]
    ds_read_b64_tr_b16 a[236:237], v223 offset:57344
    v_add_f32 v238, v238, v105
    v_mfma_f32_16x16x32_bf16 v[24:27], a[168:171], v[152:155], v[24:27]
    v_exp_f32 v111, v111
    v_mfma_f32_16x16x32_bf16 v[24:27], a[172:175], v[156:159], v[24:27]
    ds_read_b64_tr_b16 a[238:239], v223 offset:58368
    v_cvt_pk_bf16_f32 v104, v104, v105
    v_mfma_f32_16x16x32_bf16 v[28:31], a[176:179], v[144:147], v[196:199]
    ds_read_b64_tr_b16 a[208:209], v224 offset:49152
    v_add_f32 v238, v238, v106
    v_mfma_f32_16x16x32_bf16 v[28:31], a[180:183], v[148:151], v[28:31]
    v_exp_f32 v112, v112
    v_mfma_f32_16x16x32_bf16 v[28:31], a[184:187], v[152:155], v[28:31]
    ds_read_b64_tr_b16 a[210:211], v224 offset:50176
    v_add_f32 v238, v238, v107
    v_mfma_f32_16x16x32_bf16 v[28:31], a[188:191], v[156:159], v[28:31]
    v_exp_f32 v113, v113
    v_mfma_f32_16x16x32_bf16 v[32:35], a[128:131], v[160:163], v[200:203]
    ds_read_b64_tr_b16 a[240:241], v224 offset:57344
    v_cvt_pk_bf16_f32 v105, v106, v107
    v_mfma_f32_16x16x32_bf16 v[32:35], a[132:135], v[164:167], v[32:35]
    v_exp_f32 v114, v114
    v_mfma_f32_16x16x32_bf16 v[32:35], a[136:139], v[168:171], v[32:35]
    ds_read_b64_tr_b16 a[242:243], v224 offset:58368
    v_add_f32 v238, v238, v108
    v_mfma_f32_16x16x32_bf16 v[32:35], a[140:143], v[172:175], v[32:35]
    ds_read_b64_tr_b16 a[212:213], v225 offset:49152
    v_add_f32 v238, v238, v109
    v_mfma_f32_16x16x32_bf16 v[36:39], a[144:147], v[160:163], v[200:203]
    v_exp_f32 v115, v115
    v_mfma_f32_16x16x32_bf16 v[36:39], a[148:151], v[164:167], v[36:39]
    ds_read_b64_tr_b16 a[214:215], v225 offset:50176
    v_cvt_pk_bf16_f32 v106, v108, v109
    v_mfma_f32_16x16x32_bf16 v[36:39], a[152:155], v[168:171], v[36:39]
    v_exp_f32 v116, v116
    v_mfma_f32_16x16x32_bf16 v[36:39], a[156:159], v[172:175], v[36:39]
    ds_read_b64_tr_b16 a[244:245], v225 offset:57344
    v_add_f32 v238, v238, v110
    v_mfma_f32_16x16x32_bf16 v[40:43], a[160:163], v[160:163], v[200:203]
    v_exp_f32 v117, v117
    v_mfma_f32_16x16x32_bf16 v[40:43], a[164:167], v[164:167], v[40:43]
    ds_read_b64_tr_b16 a[246:247], v225 offset:58368
    v_add_f32 v238, v238, v111
    v_mfma_f32_16x16x32_bf16 v[40:43], a[168:171], v[168:171], v[40:43]
    ds_read_b64_tr_b16 a[216:217], v226 offset:49152
    v_cvt_pk_bf16_f32 v107, v110, v111
    v_mfma_f32_16x16x32_bf16 v[40:43], a[172:175], v[172:175], v[40:43]
    v_exp_f32 v118, v118
    v_mfma_f32_16x16x32_bf16 v[44:47], a[176:179], v[160:163], v[200:203]
    ds_read_b64_tr_b16 a[218:219], v226 offset:50176
    v_cvt_pk_bf16_f32 v112, v112, v113
    v_mfma_f32_16x16x32_bf16 v[44:47], a[180:183], v[164:167], v[44:47]
    v_exp_f32 v119, v119
    v_mfma_f32_16x16x32_bf16 v[44:47], a[184:187], v[168:171], v[44:47]
    ds_read_b64_tr_b16 a[248:249], v226 offset:57344
    v_cvt_pk_bf16_f32 v113, v114, v115
    v_mfma_f32_16x16x32_bf16 v[44:47], a[188:191], v[172:175], v[44:47]
    v_exp_f32 v120, v120
    v_mfma_f32_16x16x32_bf16 v[48:51], a[128:131], v[176:179], v[204:207]
    ds_read_b64_tr_b16 a[250:251], v226 offset:58368
    v_cvt_pk_bf16_f32 v114, v116, v117
    v_mfma_f32_16x16x32_bf16 v[48:51], a[132:135], v[180:183], v[48:51]
    ds_read_b64_tr_b16 a[220:221], v227 offset:49152
    v_cvt_pk_bf16_f32 v115, v118, v119
    v_mfma_f32_16x16x32_bf16 v[48:51], a[136:139], v[184:187], v[48:51]
    v_exp_f32 v121, v121
    v_mfma_f32_16x16x32_bf16 v[48:51], a[140:143], v[188:191], v[48:51]
    ds_read_b64_tr_b16 a[222:223], v227 offset:50176
    v_cvt_pk_bf16_f32 v120, v120, v121
    v_mfma_f32_16x16x32_bf16 v[52:55], a[144:147], v[176:179], v[204:207]
    v_exp_f32 v122, v122
    v_mfma_f32_16x16x32_bf16 v[52:55], a[148:151], v[180:183], v[52:55]
    v_exp_f32 v123, v123
    v_mfma_f32_16x16x32_bf16 v[52:55], a[152:155], v[184:187], v[52:55]
    ds_read_b64_tr_b16 a[252:253], v227 offset:57344
    v_cvt_pk_bf16_f32 v121, v122, v123
    v_mfma_f32_16x16x32_bf16 v[52:55], a[156:159], v[188:191], v[52:55]
    ds_read_b64_tr_b16 a[254:255], v227 offset:58368
    v_mfma_f32_16x16x32_bf16 v[56:59], a[160:163], v[176:179], v[204:207]
    v_exp_f32 v124, v124
    v_mfma_f32_16x16x32_bf16 v[56:59], a[164:167], v[180:183], v[56:59]
    v_exp_f32 v125, v125
    v_mfma_f32_16x16x32_bf16 v[56:59], a[168:171], v[184:187], v[56:59]
    v_exp_f32 v126, v126
    v_mfma_f32_16x16x32_bf16 v[56:59], a[172:175], v[188:191], v[56:59]
    v_exp_f32 v127, v127
    v_mfma_f32_16x16x32_bf16 v[60:63], a[176:179], v[176:179], v[204:207]
    v_cvt_pk_bf16_f32 v122, v124, v125
    v_cvt_pk_bf16_f32 v123, v126, v127
    v_mfma_f32_16x16x32_bf16 v[60:63], a[180:183], v[180:183], v[60:63]
    v_mfma_f32_16x16x32_bf16 v[60:63], a[184:187], v[184:187], v[60:63]
    v_mfma_f32_16x16x32_bf16 v[60:63], a[188:191], v[188:191], v[60:63]
    s_waitcnt vmcnt(8) lgkmcnt(0)
    s_barrier
    v_cmp_ne_u32 vcc, s70, v245
    v_cmp_ne_u32 s[42:43], s70, v247
    s_nop 0
    s_or_b64 vcc, vcc, s[42:43]
    v_cmp_ne_u32 s[42:43], s70, v249
    s_nop 0
    s_or_b64 vcc, vcc, s[42:43]
    v_cmp_ne_u32 s[42:43], s70, v251
    s_nop 0
    s_or_b64 vcc, vcc, s[42:43]
    s_cbranch_vccnz L_key_slow
L_key_ok:
    v_mfma_f32_16x16x32_bf16 a[0:3], a[192:195], v[64:67], a[0:3]
    v_exp_f32 v0, v0
    v_mfma_f32_16x16x32_bf16 a[0:3], a[224:227], v[72:75], a[0:3]
    v_exp_f32 v1, v1
    v_xor_b32 v232, 128, v240
    v_mfma_f32_16x16x32_bf16 a[4:7], a[196:199], v[64:67], a[4:7]
    v_add_f32 v236, v236, v0
    v_add_f32 v236, v236, v1
    v_max3_u32 v244, v244, v246, v248
    v_mfma_f32_16x16x32_bf16 a[4:7], a[228:231], v[72:75], a[4:7]
    s_mov_b32 m0, s31
    v_exp_f32 v2, v2
    s_branch L_io8
    .p2align 12
L_iw8:
    s_branch L_iwr8
L_io8:
    v_mfma_f32_16x16x32_bf16 a[8:11], a[200:203], v[64:67], a[8:11]
    buffer_load_dwordx4 v234, s[16:19], s33 offen offset:0  lds
    v_max_u32 v244, v244, v250
    v_mfma_f32_16x16x32_bf16 a[8:11], a[232:235], v[72:75], a[8:11]
    ds_read_b128 a[128:131], v228 offset:16384
    v_cvt_pk_bf16_f32 v0, v0, v1
    v_mfma_f32_16x16x32_bf16 a[12:15], a[204:207], v[64:67], a[12:15]
    v_exp_f32 v3, v3
    v_max_u32_dpp v244, v244, v244 row_ror:8 row_mask:0xf bank_mask:0xf
    v_mfma_f32_16x16x32_bf16 a[12:15], a[236:239], v[72:75], a[12:15]
    ds_read_b128 a[132:135], v229 offset:16384
    v_add_f32 v236, v236, v2
    v_mfma_f32_16x16x32_bf16 a[16:19], a[208:211], v[64:67], a[16:19]
    v_add_f32 v236, v236, v3
    v_cvt_pk_bf16_f32 v1, v2, v3
    v_mfma_f32_16x16x32_bf16 a[16:19], a[240:243], v[72:75], a[16:19]
    v_exp_f32 v4, v4
    v_max_u32_dpp v244, v244, v244 row_ror:4 row_mask:0xf bank_mask:0xf
    v_mfma_f32_16x16x32_bf16 a[20:23], a[212:215], v[64:67], a[20:23]
    v_exp_f32 v5, v5
    v_mfma_f32_16x16x32_bf16 a[20:23], a[244:247], v[72:75], a[20:23]
    ds_read_b128 a[136:139], v230 offset:16384
    v_add_f32 v236, v236, v4
    v_max_u32_dpp v244, v244, v244 row_ror:2 row_mask:0xf bank_mask:0xf
    v_mfma_f32_16x16x32_bf16 a[24:27], a[216:219], v[64:67], a[24:27]
    buffer_load_dwordx4 v234, s[16:19], s33 offen offset:1024  lds
    v_mfma_f32_16x16x32_bf16 a[24:27], a[248:251], v[72:75], a[24:27]
    v_add_f32 v236, v236, v5
    v_cvt_pk_bf16_f32 v2, v4, v5
    v_max_u32_dpp v244, v244, v244 row_ror:1 row_mask:0xf bank_mask:0xf
    v_mfma_f32_16x16x32_bf16 a[28:31], a[220:223], v[64:67], a[28:31]
    v_exp_f32 v6, v6
    v_mfma_f32_16x16x32_bf16 a[28:31], a[252:255], v[72:75], a[28:31]
    ds_read_b128 a[140:143], v231 offset:16384
    v_add_f32 v236, v236, v6
    v_mfma_f32_16x16x32_bf16 a[32:35], a[192:195], v[80:83], a[32:35]
    v_exp_f32 v7, v7
    v_mov_b32 v245, v244
    v_mfma_f32_16x16x32_bf16 a[32:35], a[224:227], v[88:91], a[32:35]
    v_add_f32 v236, v236, v7
    v_cvt_pk_bf16_f32 v3, v6, v7
    v_mfma_f32_16x16x32_bf16 a[36:39], a[196:199], v[80:83], a[36:39]
    v_exp_f32 v8, v8
    v_permlane16_swap_b32 v245, v244
    v_mfma_f32_16x16x32_bf16 a[36:39], a[228:231], v[88:91], a[36:39]
    ds_read_b128 a[144:147], v228 offset:17408
    v_add_f32 v236, v236, v8
    v_mfma_f32_16x16x32_bf16 a[40:43], a[200:203], v[80:83], a[40:43]
    buffer_load_dwordx4 v235, s[16:19], s33 offen offset:2048  lds
    v_max_u32 v244, v244, v245
    v_mfma_f32_16x16x32_bf16 a[40:43], a[232:235], v[88:91], a[40:43]
    v_exp_f32 v9, v9
    v_mfma_f32_16x16x32_bf16 a[44:47], a[204:207], v[80:83], a[44:47]
    ds_read_b128 a[148:151], v229 offset:17408
    v_add_f32 v236, v236, v9
    v_mfma_f32_16x16x32_bf16 a[44:47], a[236:239], v[88:91], a[44:47]
    v_exp_f32 v10, v10
    v_mov_b32 v245, v244
    v_mfma_f32_16x16x32_bf16 a[48:51], a[208:211], v[80:83], a[48:51]
    v_cvt_pk_bf16_f32 v8, v8, v9
    v_add_f32 v236, v236, v10
    v_mfma_f32_16x16x32_bf16 a[48:51], a[240:243], v[88:91], a[48:51]
    v_exp_f32 v11, v11
    v_permlane32_swap_b32 v245, v244
    v_mfma_f32_16x16x32_bf16 a[52:55], a[212:215], v[80:83], a[52:55]
    ds_read_b128 a[152:155], v230 offset:17408
    v_add_f32 v236, v236, v11
    v_mfma_f32_16x16x32_bf16 a[52:55], a[244:247], v[88:91], a[52:55]
    v_exp_f32 v12, v12
    v_mfma_f32_16x16x32_bf16 a[56:59], a[216:219], v[80:83], a[56:59]
    buffer_load_dwordx4 v235, s[16:19], s33 offen offset:3072  lds
    v_max_u32 v244, v244, v245
    v_mfma_f32_16x16x32_bf16 a[56:59], a[248:251], v[88:91], a[56:59]
    ds_read_b128 a[156:159], v231 offset:17408
    v_cvt_pk_bf16_f32 v9, v10, v11
    v_mfma_f32_16x16x32_bf16 a[60:63], a[220:223], v[80:83], a[60:63]
    v_exp_f32 v13, v13
    v_readfirstlane_b32 s54, v244
    v_mfma_f32_16x16x32_bf16 a[60:63], a[252:255], v[88:91], a[60:63]
    v_add_f32 v236, v236, v12
    v_add_f32 v236, v236, v13
    v_mfma_f32_16x16x32_bf16 v[208:211], v[216:219], v[80:83], v[208:211]
    ds_read_b128 a[160:163], v228 offset:24576
    v_cvt_pk_bf16_f32 v10, v12, v13
    s_andn2_b32 s55, 2047, s54
    v_mfma_f32_16x16x32_bf16 v[208:211], v[216:219], v[88:91], v[208:211]
    s_add_u32 s33, s33, 16384
    v_exp_f32 v14, v14
    v_mfma_f32_16x16x32_bf16 a[64:67], a[192:195], v[96:99], a[64:67]
    s_mov_b32 s33, 0
    v_exp_f32 v15, v15
    v_mfma_f32_16x16x32_bf16 a[64:67], a[224:227], v[104:107], a[64:67]
    s_mov_b32 m0, s24
    v_exp_f32 v16, v16
    s_lshl_b32 s42, s55, 10
    v_mfma_f32_16x16x32_bf16 a[68:71], a[196:199], v[96:99], a[68:71]
    buffer_load_dwordx4 v240, s[8:11], s33 offen offset:0  lds
    v_mfma_f32_16x16x32_bf16 a[68:71], a[228:231], v[104:107], a[68:71]
    ds_read_b128 a[164:167], v229 offset:24576
    v_add_f32 v236, v236, v14
    s_lshl_b32 s43, s55, 3
    v_mfma_f32_16x16x32_bf16 a[72:75], a[200:203], v[96:99], a[72:75]
    v_add_f32 v236, v236, v15
    v_cvt_pk_bf16_f32 v11, v14, v15
    v_mfma_f32_16x16x32_bf16 a[72:75], a[232:235], v[104:107], a[72:75]
    v_exp_f32 v17, v17
    s_add_u32 s43, s43, 16777216
    v_mfma_f32_16x16x32_bf16 a[76:79], a[204:207], v[96:99], a[76:79]
    ds_read_b128 a[168:171], v230 offset:24576
    v_cvt_pk_bf16_f32 v16, v16, v17
    v_mfma_f32_16x16x32_bf16 a[76:79], a[236:239], v[104:107], a[76:79]
    v_exp_f32 v18, v18
    v_mfma_f32_16x16x32_bf16 a[80:83], a[208:211], v[96:99], a[80:83]
    v_exp_f32 v19, v19
    v_mov_b32 v250, 0
    v_mfma_f32_16x16x32_bf16 a[80:83], a[240:243], v[104:107], a[80:83]
    ds_read_b128 a[172:175], v231 offset:24576
    v_cvt_pk_bf16_f32 v17, v18, v19
    v_mfma_f32_16x16x32_bf16 a[84:87], a[212:215], v[96:99], a[84:87]
    buffer_load_dwordx4 v240, s[8:11], s33 offen offset:1024  lds
    v_bfe_u32 v251, v252, 4, 3
    v_mfma_f32_16x16x32_bf16 a[84:87], a[244:247], v[104:107], a[84:87]
    v_exp_f32 v20, v20
    v_mfma_f32_16x16x32_bf16 a[88:91], a[216:219], v[96:99], a[88:91]
    v_exp_f32 v21, v21
    v_mfma_f32_16x16x32_bf16 a[88:91], a[248:251], v[104:107], a[88:91]
    ds_read_b128 a[176:179], v228 offset:25600
    v_cvt_pk_bf16_f32 v18, v20, v21
    v_lshlrev_b32 v251, 3, v251
    v_mfma_f32_16x16x32_bf16 a[92:95], a[220:223], v[96:99], a[92:95]
    v_exp_f32 v22, v22
    v_mfma_f32_16x16x32_bf16 a[92:95], a[252:255], v[104:107], a[92:95]
    v_exp_f32 v23, v23
    buffer_load_dwordx4 v[244:247], v252, s[76:79], s42 offen
    v_mfma_f32_16x16x32_bf16 a[96:99], a[192:195], v[112:115], a[96:99]
    ds_read_b128 a[180:183], v229 offset:25600
    v_cvt_pk_bf16_f32 v19, v22, v23
    v_mfma_f32_16x16x32_bf16 a[96:99], a[224:227], v[120:123], a[96:99]
    v_exp_f32 v24, v24
    buffer_load_dwordx2 v[248:249], v250, s[20:23], s43 offen sc1
    v_mfma_f32_16x16x32_bf16 a[100:103], a[196:199], v[112:115], a[100:103]
    buffer_load_dwordx4 v232, s[8:11], s33 offen offset:2048  lds
    v_mfma_f32_16x16x32_bf16 a[100:103], a[228:231], v[120:123], a[100:103]
    v_exp_f32 v25, v25
    v_mfma_f32_16x16x32_bf16 a[104:107], a[200:203], v[112:115], a[104:107]
    ds_read_b128 a[184:187], v230 offset:25600
    v_cvt_pk_bf16_f32 v24, v24, v25
    s_lshl_b32 s43, s73, 8
    v_mfma_f32_16x16x32_bf16 a[104:107], a[232:235], v[120:123], a[104:107]
    v_exp_f32 v26, v26
    v_mfma_f32_16x16x32_bf16 a[108:111], a[204:207], v[112:115], a[108:111]
    ds_read_b128 a[188:191], v231 offset:25600
    s_add_u32 s42, s42, s43
    v_mfma_f32_16x16x32_bf16 a[108:111], a[236:239], v[120:123], a[108:111]
    v_exp_f32 v27, v27
    v_mfma_f32_16x16x32_bf16 a[112:115], a[208:211], v[112:115], a[112:115]
    v_exp_f32 v28, v28
    s_lshl_b32 s43, s3, 6
    v_mfma_f32_16x16x32_bf16 a[112:115], a[240:243], v[120:123], a[112:115]
    v_exp_f32 v29, v29
    v_mfma_f32_16x16x32_bf16 a[116:119], a[212:215], v[112:115], a[116:119]
    buffer_load_dwordx4 v232, s[8:11], s33 offen offset:3072  lds
    v_mfma_f32_16x16x32_bf16 a[116:119], a[244:247], v[120:123], a[116:119]
    s_add_u32 s33, s33, 65536
    v_exp_f32 v30, v30
    s_add_u32 s42, s42, s43
    v_mfma_f32_16x16x32_bf16 a[120:123], a[216:219], v[112:115], a[120:123]
    v_cvt_pk_bf16_f32 v25, v26, v27
    v_cvt_pk_bf16_f32 v26, v28, v29
    v_mfma_f32_16x16x32_bf16 a[120:123], a[248:251], v[120:123], a[120:123]
    v_exp_f32 v31, v31
    buffer_load_dwordx2 v[250:251], v251, s[76:79], s42 offen
    v_mfma_f32_16x16x32_bf16 a[124:127], a[220:223], v[112:115], a[124:127]
    v_exp_f32 v32, v32
    v_mfma_f32_16x16x32_bf16 a[124:127], a[252:255], v[120:123], a[124:127]
    v_exp_f32 v33, v33
    v_mfma_f32_16x16x32_bf16 v[212:215], v[216:219], v[112:115], v[212:215]
    v_exp_f32 v34, v34
    v_mfma_f32_16x16x32_bf16 v[212:215], v[216:219], v[120:123], v[212:215]
    s_waitcnt lgkmcnt(0)
    v_exp_f32 v35, v35
    v_mfma_f32_16x16x32_bf16 v[64:67], a[128:131], v[128:131], v[192:195]
    ds_read_b64_tr_b16 a[192:193], v220 offset:0
    v_cvt_pk_bf16_f32 v27, v30, v31
    v_mfma_f32_16x16x32_bf16 v[64:67], a[132:135], v[132:135], v[64:67]
    v_exp_f32 v36, v36
    v_mfma_f32_16x16x32_bf16 v[64:67], a[136:139], v[136:139], v[64:67]
    ds_read_b64_tr_b16 a[194:195], v220 offset:1024
    v_add_f32 v238, v238, v32
    v_mfma_f32_16x16x32_bf16 v[64:67], a[140:143], v[140:143], v[64:67]
    v_exp_f32 v37, v37
    v_mfma_f32_16x16x32_bf16 v[68:71], a[144:147], v[128:131], v[192:195]
    ds_read_b64_tr_b16 a[224:225], v220 offset:8192
    v_add_f32 v238, v238, v33
    v_mfma_f32_16x16x32_bf16 v[68:71], a[148:151], v[132:135], v[68:71]
    v_exp_f32 v38, v38
    v_mfma_f32_16x16x32_bf16 v[68:71], a[152:155], v[136:139], v[68:71]
    ds_read_b64_tr_b16 a[226:227], v220 offset:9216
    v_cvt_pk_bf16_f32 v32, v32, v33
    v_mfma_f32_16x16x32_bf16 v[68:71], a[156:159], v[140:143], v[68:71]
    ds_read_b64_tr_b16 a[196:197], v221 offset:0
    v_add_f32 v238, v238, v34
    v_mfma_f32_16x16x32_bf16 v[72:75], a[160:163], v[128:131], v[192:195]
    v_exp_f32 v39, v39
    v_mfma_f32_16x16x32_bf16 v[72:75], a[164:167], v[132:135], v[72:75]
    ds_read_b64_tr_b16 a[198:199], v221 offset:1024
    v_add_f32 v238, v238, v35
    v_mfma_f32_16x16x32_bf16 v[72:75], a[168:171], v[136:139], v[72:75]
    v_exp_f32 v40, v40
    v_mfma_f32_16x16x32_bf16 v[72:75], a[172:175], v[140:143], v[72:75]
    ds_read_b64_tr_b16 a[228:229], v221 offset:8192
    v_cvt_pk_bf16_f32 v33, v34, v35
    v_mfma_f32_16x16x32_bf16 v[76:79], a[176:179], v[128:131], v[192:195]
    v_exp_f32 v41, v41
    v_mfma_f32_16x16x32_bf16 v[76:79], a[180:183], v[132:135], v[76:79]
    ds_read_b64_tr_b16 a[230:231], v221 offset:9216
    v_add_f32 v238, v238, v36
    v_mfma_f32_16x16x32_bf16 v[76:79], a[184:187], v[136:139], v[76:79]
    ds_read_b64_tr_b16 a[200:201], v222 offset:0
    v_add_f32 v238, v238, v37
    v_mfma_f32_16x16x32_bf16 v[76:79], a[188:191], v[140:143], v[76:79]
    v_exp_f32 v42, v42
    v_mfma_f32_16x16x32_bf16 v[80:83], a[128:131], v[144:147], v[196:199]
    ds_read_b64_tr_b16 a[202:203], v222 offset:1024
    v_cvt_pk_bf16_f32 v34, v36, v37
    v_mfma_f32_16x16x32_bf16 v[80:83], a[132:135], v[148:151], v[80:83]
    v_exp_f32 v43, v43
    v_mfma_f32_16x16x32_bf16 v[80:83], a[136:139], v[152:155], v[80:83]
    ds_read_b64_tr_b16 a[232:233], v222 offset:8192
    v_add_f32 v238, v238, v38
    v_mfma_f32_16x16x32_bf16 v[80:83], a[140:143], v[156:159], v[80:83]
    v_exp_f32 v44, v44
    v_mfma_f32_16x16x32_bf16 v[84:87], a[144:147], v[144:147], v[196:199]
    ds_read_b64_tr_b16 a[234:235], v222 offset:9216
    v_add_f32 v238, v238, v39
    v_mfma_f32_16x16x32_bf16 v[84:87], a[148:151], v[148:151], v[84:87]
    ds_read_b64_tr_b16 a[204:205], v223 offset:0
    v_cvt_pk_bf16_f32 v35, v38, v39
    v_mfma_f32_16x16x32_bf16 v[84:87], a[152:155], v[152:155], v[84:87]
    v_exp_f32 v45, v45
    v_mfma_f32_16x16x32_bf16 v[84:87], a[156:159], v[156:159], v[84:87]
    ds_read_b64_tr_b16 a[206:207], v223 offset:1024
    v_add_f32 v238, v238, v40
    v_mfma_f32_16x16x32_bf16 v[88:91], a[160:163], v[144:147], v[196:199]
    v_exp_f32 v46, v46
    v_mfma_f32_16x16x32_bf16 v[88:91], a[164:167], v[148:151], v[88:91]
    ds_read_b64_tr_b16 a[236:237], v223 offset:8192
    v_add_f32 v238, v238, v41
    v_mfma_f32_16x16x32_bf16 v[88:91], a[168:171], v[152:155], v[88:91]
    v_exp_f32 v47, v47
    v_mfma_f32_16x16x32_bf16 v[88:91], a[172:175], v[156:159], v[88:91]
    ds_read_b64_tr_b16 a[238:239], v223 offset:9216
    v_cvt_pk_bf16_f32 v40, v40, v41
    v_mfma_f32_16x16x32_bf16 v[92:95], a[176:179], v[144:147], v[196:199]
    ds_read_b64_tr_b16 a[208:209], v224 offset:0
    v_add_f32 v238, v238, v42
    v_mfma_f32_16x16x32_bf16 v[92:95], a[180:183], v[148:151], v[92:95]
    v_exp_f32 v48, v48
    v_mfma_f32_16x16x32_bf16 v[92:95], a[184:187], v[152:155], v[92:95]
    ds_read_b64_tr_b16 a[210:211], v224 offset:1024
    v_add_f32 v238, v238, v43
    v_mfma_f32_16x16x32_bf16 v[92:95], a[188:191], v[156:159], v[92:95]
    v_exp_f32 v49, v49
    v_mfma_f32_16x16x32_bf16 v[96:99], a[128:131], v[160:163], v[200:203]
    ds_read_b64_tr_b16 a[240:241], v224 offset:8192
    v_cvt_pk_bf16_f32 v41, v42, v43
    v_mfma_f32_16x16x32_bf16 v[96:99], a[132:135], v[164:167], v[96:99]
    v_exp_f32 v50, v50
    v_mfma_f32_16x16x32_bf16 v[96:99], a[136:139], v[168:171], v[96:99]
    ds_read_b64_tr_b16 a[242:243], v224 offset:9216
    v_add_f32 v238, v238, v44
    v_mfma_f32_16x16x32_bf16 v[96:99], a[140:143], v[172:175], v[96:99]
    ds_read_b64_tr_b16 a[212:213], v225 offset:0
    v_add_f32 v238, v238, v45
    v_mfma_f32_16x16x32_bf16 v[100:103], a[144:147], v[160:163], v[200:203]
    v_exp_f32 v51, v51
    v_mfma_f32_16x16x32_bf16 v[100:103], a[148:151], v[164:167], v[100:103]
    ds_read_b64_tr_b16 a[214:215], v225 offset:1024
    v_cvt_pk_bf16_f32 v42, v44, v45
    v_mfma_f32_16x16x32_bf16 v[100:103], a[152:155], v[168:171], v[100:103]
    v_exp_f32 v52, v52
    v_mfma_f32_16x16x32_bf16 v[100:103], a[156:159], v[172:175], v[100:103]
    ds_read_b64_tr_b16 a[244:245], v225 offset:8192
    v_add_f32 v238, v238, v46
    v_mfma_f32_16x16x32_bf16 v[104:107], a[160:163], v[160:163], v[200:203]
    v_exp_f32 v53, v53
    v_mfma_f32_16x16x32_bf16 v[104:107], a[164:167], v[164:167], v[104:107]
    ds_read_b64_tr_b16 a[246:247], v225 offset:9216
    v_add_f32 v238, v238, v47
    v_mfma_f32_16x16x32_bf16 v[104:107], a[168:171], v[168:171], v[104:107]
    ds_read_b64_tr_b16 a[216:217], v226 offset:0
    v_cvt_pk_bf16_f32 v43, v46, v47
    v_mfma_f32_16x16x32_bf16 v[104:107], a[172:175], v[172:175], v[104:107]
    v_exp_f32 v54, v54
    v_mfma_f32_16x16x32_bf16 v[108:111], a[176:179], v[160:163], v[200:203]
    ds_read_b64_tr_b16 a[218:219], v226 offset:1024
    v_cvt_pk_bf16_f32 v48, v48, v49
    v_mfma_f32_16x16x32_bf16 v[108:111], a[180:183], v[164:167], v[108:111]
    v_exp_f32 v55, v55
    v_mfma_f32_16x16x32_bf16 v[108:111], a[184:187], v[168:171], v[108:111]
    ds_read_b64_tr_b16 a[248:249], v226 offset:8192
    v_cvt_pk_bf16_f32 v49, v50, v51
    v_mfma_f32_16x16x32_bf16 v[108:111], a[188:191], v[172:175], v[108:111]
    v_exp_f32 v56, v56
    v_mfma_f32_16x16x32_bf16 v[112:115], a[128:131], v[176:179], v[204:207]
    ds_read_b64_tr_b16 a[250:251], v226 offset:9216
    v_cvt_pk_bf16_f32 v50, v52, v53
    v_mfma_f32_16x16x32_bf16 v[112:115], a[132:135], v[180:183], v[112:115]
    ds_read_b64_tr_b16 a[220:221], v227 offset:0
    v_cvt_pk_bf16_f32 v51, v54, v55
    v_mfma_f32_16x16x32_bf16 v[112:115], a[136:139], v[184:187], v[112:115]
    v_exp_f32 v57, v57
    v_mfma_f32_16x16x32_bf16 v[112:115], a[140:143], v[188:191], v[112:115]
    ds_read_b64_tr_b16 a[222:223], v227 offset:1024
    v_cvt_pk_bf16_f32 v56, v56, v57
    v_mfma_f32_16x16x32_bf16 v[116:119], a[144:147], v[176:179], v[204:207]
    v_exp_f32 v58, v58
    v_mfma_f32_16x16x32_bf16 v[116:119], a[148:151], v[180:183], v[116:119]
    v_exp_f32 v59, v59
    v_mfma_f32_16x16x32_bf16 v[116:119], a[152:155], v[184:187], v[116:119]
    ds_read_b64_tr_b16 a[252:253], v227 offset:8192
    v_cvt_pk_bf16_f32 v57, v58, v59
    v_mfma_f32_16x16x32_bf16 v[116:119], a[156:159], v[188:191], v[116:119]
    ds_read_b64_tr_b16 a[254:255], v227 offset:9216
    v_mfma_f32_16x16x32_bf16 v[120:123], a[160:163], v[176:179], v[204:207]
    v_exp_f32 v60, v60
    v_mfma_f32_16x16x32_bf16 v[120:123], a[164:167], v[180:183], v[120:123]
    v_exp_f32 v61, v61
    v_mfma_f32_16x16x32_bf16 v[120:123], a[168:171], v[184:187], v[120:123]
    v_exp_f32 v62, v62
    v_mfma_f32_16x16x32_bf16 v[120:123], a[172:175], v[188:191], v[120:123]
    v_exp_f32 v63, v63
    v_mfma_f32_16x16x32_bf16 v[124:127], a[176:179], v[176:179], v[204:207]
    v_cvt_pk_bf16_f32 v58, v60, v61
    v_cvt_pk_bf16_f32 v59, v62, v63
    v_mfma_f32_16x16x32_bf16 v[124:127], a[180:183], v[180:183], v[124:127]
    s_lshl_b32 s37, s72, 2
    s_add_u32 s37, s37, s59
    v_mfma_f32_16x16x32_bf16 v[124:127], a[184:187], v[184:187], v[124:127]
    s_lshl_b32 s37, s37, 5
    s_lshl_b32 s38, s37, 10
    v_mfma_f32_16x16x32_bf16 v[124:127], a[188:191], v[188:191], v[124:127]
    s_waitcnt vmcnt(21) lgkmcnt(0)
    s_barrier
    v_mfma_f32_16x16x32_bf16 a[0:3], a[192:195], v[0:3], a[0:3]
    v_exp_f32 v64, v64
    v_mfma_f32_16x16x32_bf16 a[0:3], a[224:227], v[8:11], a[0:3]
    v_exp_f32 v65, v65
    v_mfma_f32_16x16x32_bf16 a[4:7], a[196:199], v[0:3], a[4:7]
    v_add_f32 v236, v236, v64
    v_add_f32 v236, v236, v65
    v_mfma_f32_16x16x32_bf16 a[4:7], a[228:231], v[8:11], a[4:7]
    s_mov_b32 m0, s25
    v_exp_f32 v66, v66
    v_mfma_f32_16x16x32_bf16 a[8:11], a[200:203], v[0:3], a[8:11]
    buffer_load_dwordx4 v240, s[8:11], s33 offen offset:0  lds
    v_mfma_f32_16x16x32_bf16 a[8:11], a[232:235], v[8:11], a[8:11]
    ds_read_b128 a[128:131], v228 offset:32768
    v_cvt_pk_bf16_f32 v64, v64, v65
    v_mfma_f32_16x16x32_bf16 a[12:15], a[204:207], v[0:3], a[12:15]
    v_exp_f32 v67, v67
    v_mfma_f32_16x16x32_bf16 a[12:15], a[236:239], v[8:11], a[12:15]
    ds_read_b128 a[132:135], v229 offset:32768
    v_add_f32 v236, v236, v66
    v_mfma_f32_16x16x32_bf16 a[16:19], a[208:211], v[0:3], a[16:19]
    v_add_f32 v236, v236, v67
    v_cvt_pk_bf16_f32 v65, v66, v67
    v_mfma_f32_16x16x32_bf16 a[16:19], a[240:243], v[8:11], a[16:19]
    v_exp_f32 v68, v68
    v_mfma_f32_16x16x32_bf16 a[20:23], a[212:215], v[0:3], a[20:23]
    v_exp_f32 v69, v69
    v_mfma_f32_16x16x32_bf16 a[20:23], a[244:247], v[8:11], a[20:23]
    ds_read_b128 a[136:139], v230 offset:32768
    v_add_f32 v236, v236, v68
    v_mfma_f32_16x16x32_bf16 a[24:27], a[216:219], v[0:3], a[24:27]
    buffer_load_dwordx4 v240, s[8:11], s33 offen offset:1024  lds
    v_mfma_f32_16x16x32_bf16 a[24:27], a[248:251], v[8:11], a[24:27]
    v_add_f32 v236, v236, v69
    v_cvt_pk_bf16_f32 v66, v68, v69
    v_mfma_f32_16x16x32_bf16 a[28:31], a[220:223], v[0:3], a[28:31]
    v_exp_f32 v70, v70
    v_mfma_f32_16x16x32_bf16 a[28:31], a[252:255], v[8:11], a[28:31]
    ds_read_b128 a[140:143], v231 offset:32768
    v_add_f32 v236, v236, v70
    v_mfma_f32_16x16x32_bf16 a[32:35], a[192:195], v[16:19], a[32:35]
    v_exp_f32 v71, v71
    v_mfma_f32_16x16x32_bf16 a[32:35], a[224:227], v[24:27], a[32:35]
    v_add_f32 v236, v236, v71
    v_cvt_pk_bf16_f32 v67, v70, v71
    v_mfma_f32_16x16x32_bf16 a[36:39], a[196:199], v[16:19], a[36:39]
    v_exp_f32 v72, v72
    v_mfma_f32_16x16x32_bf16 a[36:39], a[228:231], v[24:27], a[36:39]
    ds_read_b128 a[144:147], v228 offset:33792
    v_add_f32 v236, v236, v72
    v_mfma_f32_16x16x32_bf16 a[40:43], a[200:203], v[16:19], a[40:43]
    buffer_load_dwordx4 v232, s[8:11], s33 offen offset:2048  lds
    v_mfma_f32_16x16x32_bf16 a[40:43], a[232:235], v[24:27], a[40:43]
    v_exp_f32 v73, v73
    v_mfma_f32_16x16x32_bf16 a[44:47], a[204:207], v[16:19], a[44:47]
    ds_read_b128 a[148:151], v229 offset:33792
    v_add_f32 v236, v236, v73
    v_mfma_f32_16x16x32_bf16 a[44:47], a[236:239], v[24:27], a[44:47]
    v_exp_f32 v74, v74
    v_mfma_f32_16x16x32_bf16 a[48:51], a[208:211], v[16:19], a[48:51]
    v_cvt_pk_bf16_f32 v72, v72, v73
    s_branch L_io9
    .p2align 12
L_iw9:
    s_branch L_iwr8
L_io9:
    v_add_f32 v236, v236, v74
    v_mfma_f32_16x16x32_bf16 a[48:51], a[240:243], v[24:27], a[48:51]
    v_exp_f32 v75, v75
    v_mfma_f32_16x16x32_bf16 a[52:55], a[212:215], v[16:19], a[52:55]
    ds_read_b128 a[152:155], v230 offset:33792
    v_add_f32 v236, v236, v75
    v_mfma_f32_16x16x32_bf16 a[52:55], a[244:247], v[24:27], a[52:55]
    v_exp_f32 v76, v76
    v_mfma_f32_16x16x32_bf16 a[56:59], a[216:219], v[16:19], a[56:59]
    buffer_load_dwordx4 v232, s[8:11], s33 offen offset:3072  lds
    v_mfma_f32_16x16x32_bf16 a[56:59], a[248:251], v[24:27], a[56:59]
    ds_read_b128 a[156:159], v231 offset:33792
    v_cvt_pk_bf16_f32 v73, v74, v75
    v_mfma_f32_16x16x32_bf16 a[60:63], a[220:223], v[16:19], a[60:63]
    v_exp_f32 v77, v77
    v_mfma_f32_16x16x32_bf16 a[60:63], a[252:255], v[24:27], a[60:63]
    v_add_f32 v236, v236, v76
    v_add_f32 v236, v236, v77
    v_mfma_f32_16x16x32_bf16 v[208:211], v[216:219], v[16:19], v[208:211]
    ds_read_b128 a[160:163], v228 offset:40960
    v_cvt_pk_bf16_f32 v74, v76, v77
    v_mfma_f32_16x16x32_bf16 v[208:211], v[216:219], v[24:27], v[208:211]
    v_exp_f32 v78, v78
    v_mfma_f32_16x16x32_bf16 a[64:67], a[192:195], v[32:35], a[64:67]
    s_add_u32 s33, s33, 65536
    v_exp_f32 v79, v79
    v_mfma_f32_16x16x32_bf16 a[64:67], a[224:227], v[40:43], a[64:67]
    s_mov_b32 m0, s28
    v_exp_f32 v80, v80
    v_mfma_f32_16x16x32_bf16 a[68:71], a[196:199], v[32:35], a[68:71]
    buffer_load_dwordx4 v240, s[8:11], s33 offen offset:0  lds
    v_mfma_f32_16x16x32_bf16 a[68:71], a[228:231], v[40:43], a[68:71]
    ds_read_b128 a[164:167], v229 offset:40960
    v_add_f32 v236, v236, v78
    v_mfma_f32_16x16x32_bf16 a[72:75], a[200:203], v[32:35], a[72:75]
    v_add_f32 v236, v236, v79
    v_cvt_pk_bf16_f32 v75, v78, v79
    v_mfma_f32_16x16x32_bf16 a[72:75], a[232:235], v[40:43], a[72:75]
    v_exp_f32 v81, v81
    v_mfma_f32_16x16x32_bf16 a[76:79], a[204:207], v[32:35], a[76:79]
    ds_read_b128 a[168:171], v230 offset:40960
    v_cvt_pk_bf16_f32 v80, v80, v81
    v_mfma_f32_16x16x32_bf16 a[76:79], a[236:239], v[40:43], a[76:79]
    v_exp_f32 v82, v82
    v_mfma_f32_16x16x32_bf16 a[80:83], a[208:211], v[32:35], a[80:83]
    v_exp_f32 v83, v83
    v_mfma_f32_16x16x32_bf16 a[80:83], a[240:243], v[40:43], a[80:83]
    ds_read_b128 a[172:175], v231 offset:40960
    v_cvt_pk_bf16_f32 v81, v82, v83
    v_mfma_f32_16x16x32_bf16 a[84:87], a[212:215], v[32:35], a[84:87]
    buffer_load_dwordx4 v240, s[8:11], s33 offen offset:1024  lds
    v_mfma_f32_16x16x32_bf16 a[84:87], a[244:247], v[40:43], a[84:87]
    v_exp_f32 v84, v84
    v_mfma_f32_16x16x32_bf16 a[88:91], a[216:219], v[32:35], a[88:91]
    v_exp_f32 v85, v85
    v_mfma_f32_16x16x32_bf16 a[88:91], a[248:251], v[40:43], a[88:91]
    ds_read_b128 a[176:179], v228 offset:41984
    v_cvt_pk_bf16_f32 v82, v84, v85
    v_mfma_f32_16x16x32_bf16 a[92:95], a[220:223], v[32:35], a[92:95]
    v_exp_f32 v86, v86
    v_mfma_f32_16x16x32_bf16 a[92:95], a[252:255], v[40:43], a[92:95]
    v_exp_f32 v87, v87
    v_mfma_f32_16x16x32_bf16 a[96:99], a[192:195], v[48:51], a[96:99]
    ds_read_b128 a[180:183], v229 offset:41984
    v_cvt_pk_bf16_f32 v83, v86, v87
    v_mfma_f32_16x16x32_bf16 a[96:99], a[224:227], v[56:59], a[96:99]
    v_exp_f32 v88, v88
    v_mfma_f32_16x16x32_bf16 a[100:103], a[196:199], v[48:51], a[100:103]
    buffer_load_dwordx4 v232, s[8:11], s33 offen offset:2048  lds
    v_mfma_f32_16x16x32_bf16 a[100:103], a[228:231], v[56:59], a[100:103]
    v_exp_f32 v89, v89
    v_mfma_f32_16x16x32_bf16 a[104:107], a[200:203], v[48:51], a[104:107]
    ds_read_b128 a[184:187], v230 offset:41984
    v_cvt_pk_bf16_f32 v88, v88, v89
    v_mfma_f32_16x16x32_bf16 a[104:107], a[232:235], v[56:59], a[104:107]
    v_exp_f32 v90, v90
    v_mfma_f32_16x16x32_bf16 a[108:111], a[204:207], v[48:51], a[108:111]
    ds_read_b128 a[188:191], v231 offset:41984
    v_mfma_f32_16x16x32_bf16 a[108:111], a[236:239], v[56:59], a[108:111]
    v_exp_f32 v91, v91
    v_mfma_f32_16x16x32_bf16 a[112:115], a[208:211], v[48:51], a[112:115]
    v_exp_f32 v92, v92
    v_mfma_f32_16x16x32_bf16 a[112:115], a[240:243], v[56:59], a[112:115]
    v_exp_f32 v93, v93
    v_mfma_f32_16x16x32_bf16 a[116:119], a[212:215], v[48:51], a[116:119]
    buffer_load_dwordx4 v232, s[8:11], s33 offen offset:3072  lds
    v_mfma_f32_16x16x32_bf16 a[116:119], a[244:247], v[56:59], a[116:119]
    s_add_u32 s33, s33, 65536
    v_exp_f32 v94, v94
    v_mfma_f32_16x16x32_bf16 a[120:123], a[216:219], v[48:51], a[120:123]
    v_cvt_pk_bf16_f32 v89, v90, v91
    v_cvt_pk_bf16_f32 v90, v92, v93
    v_mfma_f32_16x16x32_bf16 a[120:123], a[248:251], v[56:59], a[120:123]
    v_exp_f32 v95, v95
    v_mfma_f32_16x16x32_bf16 a[124:127], a[220:223], v[48:51], a[124:127]
    v_exp_f32 v96, v96
    v_mfma_f32_16x16x32_bf16 a[124:127], a[252:255], v[56:59], a[124:127]
    v_exp_f32 v97, v97
    v_mfma_f32_16x16x32_bf16 v[212:215], v[216:219], v[48:51], v[212:215]
    v_exp_f32 v98, v98
    v_mfma_f32_16x16x32_bf16 v[212:215], v[216:219], v[56:59], v[212:215]
    s_waitcnt lgkmcnt(0)
    v_exp_f32 v99, v99
    v_mfma_f32_16x16x32_bf16 v[0:3], a[128:131], v[128:131], v[192:195]
    ds_read_b64_tr_b16 a[192:193], v220 offset:16384
    v_cvt_pk_bf16_f32 v91, v94, v95
    v_mfma_f32_16x16x32_bf16 v[0:3], a[132:135], v[132:135], v[0:3]
    v_exp_f32 v100, v100
    v_mfma_f32_16x16x32_bf16 v[0:3], a[136:139], v[136:139], v[0:3]
    ds_read_b64_tr_b16 a[194:195], v220 offset:17408
    v_add_f32 v238, v238, v96
    v_mfma_f32_16x16x32_bf16 v[0:3], a[140:143], v[140:143], v[0:3]
    v_exp_f32 v101, v101
    v_mfma_f32_16x16x32_bf16 v[4:7], a[144:147], v[128:131], v[192:195]
    ds_read_b64_tr_b16 a[224:225], v220 offset:24576
    v_add_f32 v238, v238, v97
    v_mfma_f32_16x16x32_bf16 v[4:7], a[148:151], v[132:135], v[4:7]
    v_exp_f32 v102, v102
    v_mfma_f32_16x16x32_bf16 v[4:7], a[152:155], v[136:139], v[4:7]
    ds_read_b64_tr_b16 a[226:227], v220 offset:25600
    v_cvt_pk_bf16_f32 v96, v96, v97
    v_mfma_f32_16x16x32_bf16 v[4:7], a[156:159], v[140:143], v[4:7]
    ds_read_b64_tr_b16 a[196:197], v221 offset:16384
    v_add_f32 v238, v238, v98
    v_mfma_f32_16x16x32_bf16 v[8:11], a[160:163], v[128:131], v[192:195]
    v_exp_f32 v103, v103
    v_mfma_f32_16x16x32_bf16 v[8:11], a[164:167], v[132:135], v[8:11]
    ds_read_b64_tr_b16 a[198:199], v221 offset:17408
    v_add_f32 v238, v238, v99
    v_mfma_f32_16x16x32_bf16 v[8:11], a[168:171], v[136:139], v[8:11]
    v_exp_f32 v104, v104
    v_mfma_f32_16x16x32_bf16 v[8:11], a[172:175], v[140:143], v[8:11]
    ds_read_b64_tr_b16 a[228:229], v221 offset:24576
    v_cvt_pk_bf16_f32 v97, v98, v99
    v_mfma_f32_16x16x32_bf16 v[12:15], a[176:179], v[128:131], v[192:195]
    v_exp_f32 v105, v105
    v_mfma_f32_16x16x32_bf16 v[12:15], a[180:183], v[132:135], v[12:15]
    ds_read_b64_tr_b16 a[230:231], v221 offset:25600
    v_add_f32 v238, v238, v100
    v_mfma_f32_16x16x32_bf16 v[12:15], a[184:187], v[136:139], v[12:15]
    ds_read_b64_tr_b16 a[200:201], v222 offset:16384
    v_add_f32 v238, v238, v101
    v_mfma_f32_16x16x32_bf16 v[12:15], a[188:191], v[140:143], v[12:15]
    v_exp_f32 v106, v106
    v_mfma_f32_16x16x32_bf16 v[16:19], a[128:131], v[144:147], v[196:199]
    ds_read_b64_tr_b16 a[202:203], v222 offset:17408
    v_cvt_pk_bf16_f32 v98, v100, v101
    v_mfma_f32_16x16x32_bf16 v[16:19], a[132:135], v[148:151], v[16:19]
    v_exp_f32 v107, v107
    v_mfma_f32_16x16x32_bf16 v[16:19], a[136:139], v[152:155], v[16:19]
    ds_read_b64_tr_b16 a[232:233], v222 offset:24576
    v_add_f32 v238, v238, v102
    v_mfma_f32_16x16x32_bf16 v[16:19], a[140:143], v[156:159], v[16:19]
    v_exp_f32 v108, v108
    v_mfma_f32_16x16x32_bf16 v[20:23], a[144:147], v[144:147], v[196:199]
    ds_read_b64_tr_b16 a[234:235], v222 offset:25600
    v_add_f32 v238, v238, v103
    v_mfma_f32_16x16x32_bf16 v[20:23], a[148:151], v[148:151], v[20:23]
    ds_read_b64_tr_b16 a[204:205], v223 offset:16384
    v_cvt_pk_bf16_f32 v99, v102, v103
    v_mfma_f32_16x16x32_bf16 v[20:23], a[152:155], v[152:155], v[20:23]
    v_exp_f32 v109, v109
    v_mfma_f32_16x16x32_bf16 v[20:23], a[156:159], v[156:159], v[20:23]
    ds_read_b64_tr_b16 a[206:207], v223 offset:17408
    v_add_f32 v238, v238, v104
    v_mfma_f32_16x16x32_bf16 v[24:27], a[160:163], v[144:147], v[196:199]
    v_exp_f32 v110, v110
    v_mfma_f32_16x16x32_bf16 v[24:27], a[164:167], v[148:151], v[24:27]
    ds_read_b64_tr_b16 a[236:237], v223 offset:24576
    v_add_f32 v238, v238, v105
    v_mfma_f32_16x16x32_bf16 v[24:27], a[168:171], v[152:155], v[24:27]
    v_exp_f32 v111, v111
    v_mfma_f32_16x16x32_bf16 v[24:27], a[172:175], v[156:159], v[24:27]
    ds_read_b64_tr_b16 a[238:239], v223 offset:25600
    v_cvt_pk_bf16_f32 v104, v104, v105
    v_mfma_f32_16x16x32_bf16 v[28:31], a[176:179], v[144:147], v[196:199]
    ds_read_b64_tr_b16 a[208:209], v224 offset:16384
    v_add_f32 v238, v238, v106
    v_mfma_f32_16x16x32_bf16 v[28:31], a[180:183], v[148:151], v[28:31]
    v_exp_f32 v112, v112
    v_mfma_f32_16x16x32_bf16 v[28:31], a[184:187], v[152:155], v[28:31]
    ds_read_b64_tr_b16 a[210:211], v224 offset:17408
    v_add_f32 v238, v238, v107
    v_mfma_f32_16x16x32_bf16 v[28:31], a[188:191], v[156:159], v[28:31]
    v_exp_f32 v113, v113
    v_mfma_f32_16x16x32_bf16 v[32:35], a[128:131], v[160:163], v[200:203]
    ds_read_b64_tr_b16 a[240:241], v224 offset:24576
    v_cvt_pk_bf16_f32 v105, v106, v107
    v_mfma_f32_16x16x32_bf16 v[32:35], a[132:135], v[164:167], v[32:35]
    v_exp_f32 v114, v114
    v_mfma_f32_16x16x32_bf16 v[32:35], a[136:139], v[168:171], v[32:35]
    ds_read_b64_tr_b16 a[242:243], v224 offset:25600
    v_add_f32 v238, v238, v108
    v_mfma_f32_16x16x32_bf16 v[32:35], a[140:143], v[172:175], v[32:35]
    ds_read_b64_tr_b16 a[212:213], v225 offset:16384
    v_add_f32 v238, v238, v109
    v_mfma_f32_16x16x32_bf16 v[36:39], a[144:147], v[160:163], v[200:203]
    v_exp_f32 v115, v115
    v_mfma_f32_16x16x32_bf16 v[36:39], a[148:151], v[164:167], v[36:39]
    ds_read_b64_tr_b16 a[214:215], v225 offset:17408
    v_cvt_pk_bf16_f32 v106, v108, v109
    v_mfma_f32_16x16x32_bf16 v[36:39], a[152:155], v[168:171], v[36:39]
    v_exp_f32 v116, v116
    v_mfma_f32_16x16x32_bf16 v[36:39], a[156:159], v[172:175], v[36:39]
    ds_read_b64_tr_b16 a[244:245], v225 offset:24576
    v_add_f32 v238, v238, v110
    v_mfma_f32_16x16x32_bf16 v[40:43], a[160:163], v[160:163], v[200:203]
    v_exp_f32 v117, v117
    v_mfma_f32_16x16x32_bf16 v[40:43], a[164:167], v[164:167], v[40:43]
    ds_read_b64_tr_b16 a[246:247], v225 offset:25600
    v_add_f32 v238, v238, v111
    v_mfma_f32_16x16x32_bf16 v[40:43], a[168:171], v[168:171], v[40:43]
    ds_read_b64_tr_b16 a[216:217], v226 offset:16384
    v_cvt_pk_bf16_f32 v107, v110, v111
    v_mfma_f32_16x16x32_bf16 v[40:43], a[172:175], v[172:175], v[40:43]
    v_exp_f32 v118, v118
    v_mfma_f32_16x16x32_bf16 v[44:47], a[176:179], v[160:163], v[200:203]
    ds_read_b64_tr_b16 a[218:219], v226 offset:17408
    v_cvt_pk_bf16_f32 v112, v112, v113
    v_mfma_f32_16x16x32_bf16 v[44:47], a[180:183], v[164:167], v[44:47]
    v_exp_f32 v119, v119
    v_mfma_f32_16x16x32_bf16 v[44:47], a[184:187], v[168:171], v[44:47]
    ds_read_b64_tr_b16 a[248:249], v226 offset:24576
    v_cvt_pk_bf16_f32 v113, v114, v115
    v_mfma_f32_16x16x32_bf16 v[44:47], a[188:191], v[172:175], v[44:47]
    v_exp_f32 v120, v120
    v_mfma_f32_16x16x32_bf16 v[48:51], a[128:131], v[176:179], v[204:207]
    ds_read_b64_tr_b16 a[250:251], v226 offset:25600
    v_cvt_pk_bf16_f32 v114, v116, v117
    v_mfma_f32_16x16x32_bf16 v[48:51], a[132:135], v[180:183], v[48:51]
    ds_read_b64_tr_b16 a[220:221], v227 offset:16384
    v_cvt_pk_bf16_f32 v115, v118, v119
    v_mfma_f32_16x16x32_bf16 v[48:51], a[136:139], v[184:187], v[48:51]
    v_exp_f32 v121, v121
    v_mfma_f32_16x16x32_bf16 v[48:51], a[140:143], v[188:191], v[48:51]
    ds_read_b64_tr_b16 a[222:223], v227 offset:17408
    v_cvt_pk_bf16_f32 v120, v120, v121
    v_mfma_f32_16x16x32_bf16 v[52:55], a[144:147], v[176:179], v[204:207]
    v_exp_f32 v122, v122
    v_mfma_f32_16x16x32_bf16 v[52:55], a[148:151], v[180:183], v[52:55]
    v_exp_f32 v123, v123
    v_mfma_f32_16x16x32_bf16 v[52:55], a[152:155], v[184:187], v[52:55]
    ds_read_b64_tr_b16 a[252:253], v227 offset:24576
    v_cvt_pk_bf16_f32 v121, v122, v123
    v_mfma_f32_16x16x32_bf16 v[52:55], a[156:159], v[188:191], v[52:55]
    ds_read_b64_tr_b16 a[254:255], v227 offset:25600
    v_mfma_f32_16x16x32_bf16 v[56:59], a[160:163], v[176:179], v[204:207]
    v_exp_f32 v124, v124
    v_mfma_f32_16x16x32_bf16 v[56:59], a[164:167], v[180:183], v[56:59]
    v_exp_f32 v125, v125
    v_mfma_f32_16x16x32_bf16 v[56:59], a[168:171], v[184:187], v[56:59]
    v_exp_f32 v126, v126
    v_mfma_f32_16x16x32_bf16 v[56:59], a[172:175], v[188:191], v[56:59]
    v_exp_f32 v127, v127
    v_mfma_f32_16x16x32_bf16 v[60:63], a[176:179], v[176:179], v[204:207]
    v_cvt_pk_bf16_f32 v122, v124, v125
    v_cvt_pk_bf16_f32 v123, v126, v127
    s_lshl_b32 s58, s37, 3
    s_add_u32 s58, s58, 16777216
    v_mfma_f32_16x16x32_bf16 v[60:63], a[180:183], v[180:183], v[60:63]
    s_lshl_b32 s42, s73, 8
    s_add_u32 s38, s38, s42
    v_mfma_f32_16x16x32_bf16 v[60:63], a[184:187], v[184:187], v[60:63]
    s_lshl_b32 s42, s3, 6
    s_add_u32 s38, s38, s42
    v_mfma_f32_16x16x32_bf16 v[60:63], a[188:191], v[188:191], v[60:63]
    s_waitcnt vmcnt(19) lgkmcnt(0)
    s_barrier
    v_mfma_f32_16x16x32_bf16 a[0:3], a[192:195], v[64:67], a[0:3]
    v_exp_f32 v0, v0
    v_mfma_f32_16x16x32_bf16 a[0:3], a[224:227], v[72:75], a[0:3]
    v_exp_f32 v1, v1
    v_mfma_f32_16x16x32_bf16 a[4:7], a[196:199], v[64:67], a[4:7]
    v_add_f32 v236, v236, v0
    v_add_f32 v236, v236, v1
    v_mfma_f32_16x16x32_bf16 a[4:7], a[228:231], v[72:75], a[4:7]
    s_mov_b32 m0, s26
    v_exp_f32 v2, v2
    v_mfma_f32_16x16x32_bf16 a[8:11], a[200:203], v[64:67], a[8:11]
    buffer_load_dwordx4 v240, s[8:11], s33 offen offset:0  lds
    v_mfma_f32_16x16x32_bf16 a[8:11], a[232:235], v[72:75], a[8:11]
    ds_read_b128 a[128:131], v228 offset:49152
    v_cvt_pk_bf16_f32 v0, v0, v1
    v_mfma_f32_16x16x32_bf16 a[12:15], a[204:207], v[64:67], a[12:15]
    v_exp_f32 v3, v3
    v_mfma_f32_16x16x32_bf16 a[12:15], a[236:239], v[72:75], a[12:15]
    ds_read_b128 a[132:135], v229 offset:49152
    v_add_f32 v236, v236, v2
    v_mfma_f32_16x16x32_bf16 a[16:19], a[208:211], v[64:67], a[16:19]
    v_add_f32 v236, v236, v3
    v_cvt_pk_bf16_f32 v1, v2, v3
    v_mfma_f32_16x16x32_bf16 a[16:19], a[240:243], v[72:75], a[16:19]
    v_exp_f32 v4, v4
    v_mfma_f32_16x16x32_bf16 a[20:23], a[212:215], v[64:67], a[20:23]
    v_exp_f32 v5, v5
    v_mfma_f32_16x16x32_bf16 a[20:23], a[244:247], v[72:75], a[20:23]
    ds_read_b128 a[136:139], v230 offset:49152
    v_add_f32 v236, v236, v4
    v_mfma_f32_16x16x32_bf16 a[24:27], a[216:219], v[64:67], a[24:27]
    buffer_load_dwordx4 v240, s[8:11], s33 offen offset:1024  lds
    v_mfma_f32_16x16x32_bf16 a[24:27], a[248:251], v[72:75], a[24:27]
    v_add_f32 v236, v236, v5
    v_cvt_pk_bf16_f32 v2, v4, v5
    v_mfma_f32_16x16x32_bf16 a[28:31], a[220:223], v[64:67], a[28:31]
    v_exp_f32 v6, v6
    v_mfma_f32_16x16x32_bf16 a[28:31], a[252:255], v[72:75], a[28:31]
    ds_read_b128 a[140:143], v231 offset:49152
    v_add_f32 v236, v236, v6
    v_mfma_f32_16x16x32_bf16 a[32:35], a[192:195], v[80:83], a[32:35]
    v_exp_f32 v7, v7
    v_mfma_f32_16x16x32_bf16 a[32:35], a[224:227], v[88:91], a[32:35]
    v_add_f32 v236, v236, v7
    v_cvt_pk_bf16_f32 v3, v6, v7
    v_mfma_f32_16x16x32_bf16 a[36:39], a[196:199], v[80:83], a[36:39]
    v_exp_f32 v8, v8
    v_mfma_f32_16x16x32_bf16 a[36:39], a[228:231], v[88:91], a[36:39]
    ds_read_b128 a[144:147], v228 offset:50176
    v_add_f32 v236, v236, v8
    v_mfma_f32_16x16x32_bf16 a[40:43], a[200:203], v[80:83], a[40:43]
    buffer_load_dwordx4 v232, s[8:11], s33 offen offset:2048  lds
    v_mfma_f32_16x16x32_bf16 a[40:43], a[232:235], v[88:91], a[40:43]
    v_exp_f32 v9, v9
    v_mfma_f32_16x16x32_bf16 a[44:47], a[204:207], v[80:83], a[44:47]
    ds_read_b128 a[148:151], v229 offset:50176
    v_add_f32 v236, v236, v9
    v_mfma_f32_16x16x32_bf16 a[44:47], a[236:239], v[88:91], a[44:47]
    v_exp_f32 v10, v10
    v_mfma_f32_16x16x32_bf16 a[48:51], a[208:211], v[80:83], a[48:51]
    v_cvt_pk_bf16_f32 v8, v8, v9
    v_add_f32 v236, v236, v10
    v_mfma_f32_16x16x32_bf16 a[48:51], a[240:243], v[88:91], a[48:51]
    v_exp_f32 v11, v11
    v_mfma_f32_16x16x32_bf16 a[52:55], a[212:215], v[80:83], a[52:55]
    ds_read_b128 a[152:155], v230 offset:50176
    v_add_f32 v236, v236, v11
    v_mfma_f32_16x16x32_bf16 a[52:55], a[244:247], v[88:91], a[52:55]
    v_exp_f32 v12, v12
    v_mfma_f32_16x16x32_bf16 a[56:59], a[216:219], v[80:83], a[56:59]
    buffer_load_dwordx4 v232, s[8:11], s33 offen offset:3072  lds
    v_mfma_f32_16x16x32_bf16 a[56:59], a[248:251], v[88:91], a[56:59]
    ds_read_b128 a[156:159], v231 offset:50176
    v_cvt_pk_bf16_f32 v9, v10, v11
    v_mfma_f32_16x16x32_bf16 a[60:63], a[220:223], v[80:83], a[60:63]
    v_exp_f32 v13, v13
    v_mfma_f32_16x16x32_bf16 a[60:63], a[252:255], v[88:91], a[60:63]
    v_add_f32 v236, v236, v12
    v_add_f32 v236, v236, v13
    v_mfma_f32_16x16x32_bf16 v[208:211], v[216:219], v[80:83], v[208:211]
    ds_read_b128 a[160:163], v228 offset:57344
    v_cvt_pk_bf16_f32 v10, v12, v13
    v_mfma_f32_16x16x32_bf16 v[208:211], v[216:219], v[88:91], v[208:211]
    v_exp_f32 v14, v14
    v_mfma_f32_16x16x32_bf16 a[64:67], a[192:195], v[96:99], a[64:67]
    s_add_u32 s33, s33, 65536
    v_exp_f32 v15, v15
    v_mfma_f32_16x16x32_bf16 a[64:67], a[224:227], v[104:107], a[64:67]
    s_mov_b32 m0, s29
    v_exp_f32 v16, v16
    v_mfma_f32_16x16x32_bf16 a[68:71], a[196:199], v[96:99], a[68:71]
    buffer_load_dwordx4 v240, s[8:11], s33 offen offset:0  lds
    v_mfma_f32_16x16x32_bf16 a[68:71], a[228:231], v[104:107], a[68:71]
    ds_read_b128 a[164:167], v229 offset:57344
    v_add_f32 v236, v236, v14
    v_mfma_f32_16x16x32_bf16 a[72:75], a[200:203], v[96:99], a[72:75]
    v_add_f32 v236, v236, v15
    v_cvt_pk_bf16_f32 v11, v14, v15
    v_mfma_f32_16x16x32_bf16 a[72:75], a[232:235], v[104:107], a[72:75]
    v_exp_f32 v17, v17
    v_mfma_f32_16x16x32_bf16 a[76:79], a[204:207], v[96:99], a[76:79]
    ds_read_b128 a[168:171], v230 offset:57344
    v_cvt_pk_bf16_f32 v16, v16, v17
    v_mfma_f32_16x16x32_bf16 a[76:79], a[236:239], v[104:107], a[76:79]
    v_exp_f32 v18, v18
    v_mfma_f32_16x16x32_bf16 a[80:83], a[208:211], v[96:99], a[80:83]
    v_exp_f32 v19, v19
    v_mfma_f32_16x16x32_bf16 a[80:83], a[240:243], v[104:107], a[80:83]
    ds_read_b128 a[172:175], v231 offset:57344
    v_cvt_pk_bf16_f32 v17, v18, v19
    v_mfma_f32_16x16x32_bf16 a[84:87], a[212:215], v[96:99], a[84:87]
    buffer_load_dwordx4 v240, s[8:11], s33 offen offset:1024  lds
    v_mfma_f32_16x16x32_bf16 a[84:87], a[244:247], v[104:107], a[84:87]
    v_exp_f32 v20, v20
    v_mfma_f32_16x16x32_bf16 a[88:91], a[216:219], v[96:99], a[88:91]
    v_exp_f32 v21, v21
    v_mfma_f32_16x16x32_bf16 a[88:91], a[248:251], v[104:107], a[88:91]
    ds_read_b128 a[176:179], v228 offset:58368
    v_cvt_pk_bf16_f32 v18, v20, v21
    v_mfma_f32_16x16x32_bf16 a[92:95], a[220:223], v[96:99], a[92:95]
    v_exp_f32 v22, v22
    v_mfma_f32_16x16x32_bf16 a[92:95], a[252:255], v[104:107], a[92:95]
    v_exp_f32 v23, v23
    v_mfma_f32_16x16x32_bf16 a[96:99], a[192:195], v[112:115], a[96:99]
    ds_read_b128 a[180:183], v229 offset:58368
    v_cvt_pk_bf16_f32 v19, v22, v23
    v_mfma_f32_16x16x32_bf16 a[96:99], a[224:227], v[120:123], a[96:99]
    v_exp_f32 v24, v24
    v_mfma_f32_16x16x32_bf16 a[100:103], a[196:199], v[112:115], a[100:103]
    buffer_load_dwordx4 v232, s[8:11], s33 offen offset:2048  lds
    v_mfma_f32_16x16x32_bf16 a[100:103], a[228:231], v[120:123], a[100:103]
    s_branch L_io10
    .p2align 12
L_iw10:
    s_branch L_iwr8
L_io10:
    v_exp_f32 v25, v25
    v_mfma_f32_16x16x32_bf16 a[104:107], a[200:203], v[112:115], a[104:107]
    ds_read_b128 a[184:187], v230 offset:58368
    v_cvt_pk_bf16_f32 v24, v24, v25
    v_mfma_f32_16x16x32_bf16 a[104:107], a[232:235], v[120:123], a[104:107]
    v_exp_f32 v26, v26
    v_mfma_f32_16x16x32_bf16 a[108:111], a[204:207], v[112:115], a[108:111]
    ds_read_b128 a[188:191], v231 offset:58368
    v_mfma_f32_16x16x32_bf16 a[108:111], a[236:239], v[120:123], a[108:111]
    v_exp_f32 v27, v27
    v_mfma_f32_16x16x32_bf16 a[112:115], a[208:211], v[112:115], a[112:115]
    v_exp_f32 v28, v28
    v_mfma_f32_16x16x32_bf16 a[112:115], a[240:243], v[120:123], a[112:115]
    v_exp_f32 v29, v29
    v_mfma_f32_16x16x32_bf16 a[116:119], a[212:215], v[112:115], a[116:119]
    buffer_load_dwordx4 v232, s[8:11], s33 offen offset:3072  lds
    v_mfma_f32_16x16x32_bf16 a[116:119], a[244:247], v[120:123], a[116:119]
    s_add_u32 s33, s33, 65536
    v_exp_f32 v30, v30
    v_mfma_f32_16x16x32_bf16 a[120:123], a[216:219], v[112:115], a[120:123]
    v_cvt_pk_bf16_f32 v25, v26, v27
    v_cvt_pk_bf16_f32 v26, v28, v29
    v_mfma_f32_16x16x32_bf16 a[120:123], a[248:251], v[120:123], a[120:123]
    v_exp_f32 v31, v31
    v_mfma_f32_16x16x32_bf16 a[124:127], a[220:223], v[112:115], a[124:127]
    v_exp_f32 v32, v32
    v_mfma_f32_16x16x32_bf16 a[124:127], a[252:255], v[120:123], a[124:127]
    v_exp_f32 v33, v33
    v_mfma_f32_16x16x32_bf16 v[212:215], v[216:219], v[112:115], v[212:215]
    v_exp_f32 v34, v34
    v_mfma_f32_16x16x32_bf16 v[212:215], v[216:219], v[120:123], v[212:215]
    s_waitcnt lgkmcnt(0)
    v_exp_f32 v35, v35
    v_mfma_f32_16x16x32_bf16 v[64:67], a[128:131], v[128:131], v[192:195]
    ds_read_b64_tr_b16 a[192:193], v220 offset:32768
    v_cvt_pk_bf16_f32 v27, v30, v31
    v_mfma_f32_16x16x32_bf16 v[64:67], a[132:135], v[132:135], v[64:67]
    v_exp_f32 v36, v36
    v_mfma_f32_16x16x32_bf16 v[64:67], a[136:139], v[136:139], v[64:67]
    ds_read_b64_tr_b16 a[194:195], v220 offset:33792
    v_add_f32 v238, v238, v32
    v_mfma_f32_16x16x32_bf16 v[64:67], a[140:143], v[140:143], v[64:67]
    v_exp_f32 v37, v37
    v_mfma_f32_16x16x32_bf16 v[68:71], a[144:147], v[128:131], v[192:195]
    ds_read_b64_tr_b16 a[224:225], v220 offset:40960
    v_add_f32 v238, v238, v33
    v_mfma_f32_16x16x32_bf16 v[68:71], a[148:151], v[132:135], v[68:71]
    v_exp_f32 v38, v38
    v_mfma_f32_16x16x32_bf16 v[68:71], a[152:155], v[136:139], v[68:71]
    ds_read_b64_tr_b16 a[226:227], v220 offset:41984
    v_cvt_pk_bf16_f32 v32, v32, v33
    v_mfma_f32_16x16x32_bf16 v[68:71], a[156:159], v[140:143], v[68:71]
    ds_read_b64_tr_b16 a[196:197], v221 offset:32768
    v_add_f32 v238, v238, v34
    v_mfma_f32_16x16x32_bf16 v[72:75], a[160:163], v[128:131], v[192:195]
    v_exp_f32 v39, v39
    v_mfma_f32_16x16x32_bf16 v[72:75], a[164:167], v[132:135], v[72:75]
    ds_read_b64_tr_b16 a[198:199], v221 offset:33792
    v_add_f32 v238, v238, v35
    v_mfma_f32_16x16x32_bf16 v[72:75], a[168:171], v[136:139], v[72:75]
    v_exp_f32 v40, v40
    v_mfma_f32_16x16x32_bf16 v[72:75], a[172:175], v[140:143], v[72:75]
    ds_read_b64_tr_b16 a[228:229], v221 offset:40960
    v_cvt_pk_bf16_f32 v33, v34, v35
    v_mfma_f32_16x16x32_bf16 v[76:79], a[176:179], v[128:131], v[192:195]
    v_exp_f32 v41, v41
    v_mfma_f32_16x16x32_bf16 v[76:79], a[180:183], v[132:135], v[76:79]
    ds_read_b64_tr_b16 a[230:231], v221 offset:41984
    v_add_f32 v238, v238, v36
    v_mfma_f32_16x16x32_bf16 v[76:79], a[184:187], v[136:139], v[76:79]
    ds_read_b64_tr_b16 a[200:201], v222 offset:32768
    v_add_f32 v238, v238, v37
    v_mfma_f32_16x16x32_bf16 v[76:79], a[188:191], v[140:143], v[76:79]
    v_exp_f32 v42, v42
    v_mfma_f32_16x16x32_bf16 v[80:83], a[128:131], v[144:147], v[196:199]
    ds_read_b64_tr_b16 a[202:203], v222 offset:33792
    v_cvt_pk_bf16_f32 v34, v36, v37
    v_mfma_f32_16x16x32_bf16 v[80:83], a[132:135], v[148:151], v[80:83]
    v_exp_f32 v43, v43
    v_mfma_f32_16x16x32_bf16 v[80:83], a[136:139], v[152:155], v[80:83]
    ds_read_b64_tr_b16 a[232:233], v222 offset:40960
    v_add_f32 v238, v238, v38
    v_mfma_f32_16x16x32_bf16 v[80:83], a[140:143], v[156:159], v[80:83]
    v_exp_f32 v44, v44
    v_mfma_f32_16x16x32_bf16 v[84:87], a[144:147], v[144:147], v[196:199]
    ds_read_b64_tr_b16 a[234:235], v222 offset:41984
    v_add_f32 v238, v238, v39
    v_mfma_f32_16x16x32_bf16 v[84:87], a[148:151], v[148:151], v[84:87]
    ds_read_b64_tr_b16 a[204:205], v223 offset:32768
    v_cvt_pk_bf16_f32 v35, v38, v39
    v_mfma_f32_16x16x32_bf16 v[84:87], a[152:155], v[152:155], v[84:87]
    v_exp_f32 v45, v45
    v_mfma_f32_16x16x32_bf16 v[84:87], a[156:159], v[156:159], v[84:87]
    ds_read_b64_tr_b16 a[206:207], v223 offset:33792
    v_add_f32 v238, v238, v40
    v_mfma_f32_16x16x32_bf16 v[88:91], a[160:163], v[144:147], v[196:199]
    v_exp_f32 v46, v46
    v_mfma_f32_16x16x32_bf16 v[88:91], a[164:167], v[148:151], v[88:91]
    ds_read_b64_tr_b16 a[236:237], v223 offset:40960
    v_add_f32 v238, v238, v41
    v_mfma_f32_16x16x32_bf16 v[88:91], a[168:171], v[152:155], v[88:91]
    v_exp_f32 v47, v47
    v_mfma_f32_16x16x32_bf16 v[88:91], a[172:175], v[156:159], v[88:91]
    ds_read_b64_tr_b16 a[238:239], v223 offset:41984
    v_cvt_pk_bf16_f32 v40, v40, v41
    v_mfma_f32_16x16x32_bf16 v[92:95], a[176:179], v[144:147], v[196:199]
    ds_read_b64_tr_b16 a[208:209], v224 offset:32768
    v_add_f32 v238, v238, v42
    v_mfma_f32_16x16x32_bf16 v[92:95], a[180:183], v[148:151], v[92:95]
    v_exp_f32 v48, v48
    v_mfma_f32_16x16x32_bf16 v[92:95], a[184:187], v[152:155], v[92:95]
    ds_read_b64_tr_b16 a[210:211], v224 offset:33792
    v_add_f32 v238, v238, v43
    v_mfma_f32_16x16x32_bf16 v[92:95], a[188:191], v[156:159], v[92:95]
    v_exp_f32 v49, v49
    v_mfma_f32_16x16x32_bf16 v[96:99], a[128:131], v[160:163], v[200:203]
    ds_read_b64_tr_b16 a[240:241], v224 offset:40960
    v_cvt_pk_bf16_f32 v41, v42, v43
    v_mfma_f32_16x16x32_bf16 v[96:99], a[132:135], v[164:167], v[96:99]
    v_exp_f32 v50, v50
    v_mfma_f32_16x16x32_bf16 v[96:99], a[136:139], v[168:171], v[96:99]
    ds_read_b64_tr_b16 a[242:243], v224 offset:41984
    v_add_f32 v238, v238, v44
    v_mfma_f32_16x16x32_bf16 v[96:99], a[140:143], v[172:175], v[96:99]
    ds_read_b64_tr_b16 a[212:213], v225 offset:32768
    v_add_f32 v238, v238, v45
    v_mfma_f32_16x16x32_bf16 v[100:103], a[144:147], v[160:163], v[200:203]
    v_exp_f32 v51, v51
    v_mfma_f32_16x16x32_bf16 v[100:103], a[148:151], v[164:167], v[100:103]
    ds_read_b64_tr_b16 a[214:215], v225 offset:33792
    v_cvt_pk_bf16_f32 v42, v44, v45
    v_mfma_f32_16x16x32_bf16 v[100:103], a[152:155], v[168:171], v[100:103]
    v_exp_f32 v52, v52
    v_mfma_f32_16x16x32_bf16 v[100:103], a[156:159], v[172:175], v[100:103]
    ds_read_b64_tr_b16 a[244:245], v225 offset:40960
    v_add_f32 v238, v238, v46
    v_mfma_f32_16x16x32_bf16 v[104:107], a[160:163], v[160:163], v[200:203]
    v_exp_f32 v53, v53
    v_mfma_f32_16x16x32_bf16 v[104:107], a[164:167], v[164:167], v[104:107]
    ds_read_b64_tr_b16 a[246:247], v225 offset:41984
    v_add_f32 v238, v238, v47
    v_mfma_f32_16x16x32_bf16 v[104:107], a[168:171], v[168:171], v[104:107]
    ds_read_b64_tr_b16 a[216:217], v226 offset:32768
    v_cvt_pk_bf16_f32 v43, v46, v47
    v_mfma_f32_16x16x32_bf16 v[104:107], a[172:175], v[172:175], v[104:107]
    v_exp_f32 v54, v54
    v_mfma_f32_16x16x32_bf16 v[108:111], a[176:179], v[160:163], v[200:203]
    ds_read_b64_tr_b16 a[218:219], v226 offset:33792
    v_cvt_pk_bf16_f32 v48, v48, v49
    v_mfma_f32_16x16x32_bf16 v[108:111], a[180:183], v[164:167], v[108:111]
    v_exp_f32 v55, v55
    v_mfma_f32_16x16x32_bf16 v[108:111], a[184:187], v[168:171], v[108:111]
    ds_read_b64_tr_b16 a[248:249], v226 offset:40960
    v_cvt_pk_bf16_f32 v49, v50, v51
    v_mfma_f32_16x16x32_bf16 v[108:111], a[188:191], v[172:175], v[108:111]
    v_exp_f32 v56, v56
    v_mfma_f32_16x16x32_bf16 v[112:115], a[128:131], v[176:179], v[204:207]
    ds_read_b64_tr_b16 a[250:251], v226 offset:41984
    v_cvt_pk_bf16_f32 v50, v52, v53
    v_mfma_f32_16x16x32_bf16 v[112:115], a[132:135], v[180:183], v[112:115]
    ds_read_b64_tr_b16 a[220:221], v227 offset:32768
    v_cvt_pk_bf16_f32 v51, v54, v55
    v_mfma_f32_16x16x32_bf16 v[112:115], a[136:139], v[184:187], v[112:115]
    v_exp_f32 v57, v57
    v_mfma_f32_16x16x32_bf16 v[112:115], a[140:143], v[188:191], v[112:115]
    ds_read_b64_tr_b16 a[222:223], v227 offset:33792
    v_cvt_pk_bf16_f32 v56, v56, v57
    v_mfma_f32_16x16x32_bf16 v[116:119], a[144:147], v[176:179], v[204:207]
    v_exp_f32 v58, v58
    v_mfma_f32_16x16x32_bf16 v[116:119], a[148:151], v[180:183], v[116:119]
    v_exp_f32 v59, v59
    v_mfma_f32_16x16x32_bf16 v[116:119], a[152:155], v[184:187], v[116:119]
    ds_read_b64_tr_b16 a[252:253], v227 offset:40960
    v_cvt_pk_bf16_f32 v57, v58, v59
    v_mfma_f32_16x16x32_bf16 v[116:119], a[156:159], v[188:191], v[116:119]
    ds_read_b64_tr_b16 a[254:255], v227 offset:41984
    v_mfma_f32_16x16x32_bf16 v[120:123], a[160:163], v[176:179], v[204:207]
    v_exp_f32 v60, v60
    v_mfma_f32_16x16x32_bf16 v[120:123], a[164:167], v[180:183], v[120:123]
    v_exp_f32 v61, v61
    v_mfma_f32_16x16x32_bf16 v[120:123], a[168:171], v[184:187], v[120:123]
    v_exp_f32 v62, v62
    v_mfma_f32_16x16x32_bf16 v[120:123], a[172:175], v[188:191], v[120:123]
    v_exp_f32 v63, v63
    v_mfma_f32_16x16x32_bf16 v[124:127], a[176:179], v[176:179], v[204:207]
    v_cvt_pk_bf16_f32 v58, v60, v61
    v_cvt_pk_bf16_f32 v59, v62, v63
    v_mfma_f32_16x16x32_bf16 v[124:127], a[180:183], v[180:183], v[124:127]
    v_mfma_f32_16x16x32_bf16 v[124:127], a[184:187], v[184:187], v[124:127]
    v_mfma_f32_16x16x32_bf16 v[124:127], a[188:191], v[188:191], v[124:127]
    s_waitcnt vmcnt(4) lgkmcnt(0)
    s_barrier
    v_mfma_f32_16x16x32_bf16 a[0:3], a[192:195], v[0:3], a[0:3]
    v_add_u32 v229, 65536, v243
    s_mov_b32 m0, s27
    v_exp_f32 v64, v64
    v_mfma_f32_16x16x32_bf16 a[0:3], a[224:227], v[8:11], a[0:3]
    buffer_load_dwordx4 v240, s[8:11], s33 offen offset:0  lds
    ds_read_b64_tr_b16 v[128:129], v243 offset:0
    ds_read_b64_tr_b16 v[130:131], v243 offset:4096
    v_mfma_f32_16x16x32_bf16 a[4:7], a[196:199], v[0:3], a[4:7]
    ds_read_b64_tr_b16 v[132:133], v243 offset:8
    v_exp_f32 v65, v65
    v_mfma_f32_16x16x32_bf16 a[4:7], a[228:231], v[8:11], a[4:7]
    ds_read_b64_tr_b16 v[134:135], v243 offset:4104
    buffer_load_dwordx4 v240, s[8:11], s33 offen offset:1024  lds
    v_add_f32 v236, v236, v64
    v_mfma_f32_16x16x32_bf16 a[8:11], a[200:203], v[0:3], a[8:11]
    ds_read_b64_tr_b16 v[136:137], v243 offset:8192
    v_exp_f32 v66, v66
    v_mfma_f32_16x16x32_bf16 a[8:11], a[232:235], v[8:11], a[8:11]
    ds_read_b64_tr_b16 v[138:139], v243 offset:12288
    v_add_f32 v236, v236, v65
    v_cvt_pk_bf16_f32 v64, v64, v65
    v_mfma_f32_16x16x32_bf16 a[12:15], a[204:207], v[0:3], a[12:15]
    ds_read_b64_tr_b16 v[140:141], v243 offset:8200
    ds_read_b64_tr_b16 v[142:143], v243 offset:12296
    v_exp_f32 v67, v67
    v_mfma_f32_16x16x32_bf16 a[12:15], a[236:239], v[8:11], a[12:15]
    buffer_load_dwordx4 v232, s[8:11], s33 offen offset:2048  lds
    v_add_f32 v236, v236, v66
    v_mfma_f32_16x16x32_bf16 a[16:19], a[208:211], v[0:3], a[16:19]
    ds_read_b64_tr_b16 v[144:145], v243 offset:16384
    ds_read_b64_tr_b16 v[146:147], v243 offset:20480
    ds_read_b64_tr_b16 v[148:149], v243 offset:16392
    ds_read_b64_tr_b16 v[150:151], v243 offset:20488
    v_mfma_f32_16x16x32_bf16 a[16:19], a[240:243], v[8:11], a[16:19]
    buffer_load_dwordx4 v232, s[8:11], s33 offen offset:3072  lds
    v_exp_f32 v68, v68
    v_mfma_f32_16x16x32_bf16 a[20:23], a[212:215], v[0:3], a[20:23]
    ds_read_b64_tr_b16 v[152:153], v243 offset:24576
    v_add_f32 v236, v236, v67
    v_cvt_pk_bf16_f32 v65, v66, v67
    v_mfma_f32_16x16x32_bf16 a[20:23], a[244:247], v[8:11], a[20:23]
    ds_read_b64_tr_b16 v[154:155], v243 offset:28672
    v_exp_f32 v69, v69
    v_mfma_f32_16x16x32_bf16 a[24:27], a[216:219], v[0:3], a[24:27]
    ds_read_b64_tr_b16 v[156:157], v243 offset:24584
    ds_read_b64_tr_b16 v[158:159], v243 offset:28680
    s_add_u32 s33, s33, 65536
    s_mov_b32 m0, s30
    v_add_f32 v236, v236, v68
    v_mfma_f32_16x16x32_bf16 a[24:27], a[248:251], v[8:11], a[24:27]
    buffer_load_dwordx4 v240, s[8:11], s33 offen offset:0  lds
    v_exp_f32 v70, v70
    v_mfma_f32_16x16x32_bf16 a[28:31], a[220:223], v[0:3], a[28:31]
    ds_read_b64_tr_b16 v[160:161], v229 offset:0
    ds_read_b64_tr_b16 v[162:163], v229 offset:4096
    v_add_f32 v236, v236, v69
    v_mfma_f32_16x16x32_bf16 a[28:31], a[252:255], v[8:11], a[28:31]
    ds_read_b64_tr_b16 v[164:165], v229 offset:8
    ds_read_b64_tr_b16 v[166:167], v229 offset:4104
    v_cvt_pk_bf16_f32 v66, v68, v69
    v_mfma_f32_16x16x32_bf16 a[32:35], a[192:195], v[16:19], a[32:35]
    buffer_load_dwordx4 v240, s[8:11], s33 offen offset:1024  lds
    v_exp_f32 v71, v71
    v_mfma_f32_16x16x32_bf16 a[32:35], a[224:227], v[24:27], a[32:35]
    ds_read_b64_tr_b16 v[168:169], v229 offset:8192
    ds_read_b64_tr_b16 v[170:171], v229 offset:12288
    v_add_f32 v236, v236, v70
    v_mfma_f32_16x16x32_bf16 a[36:39], a[196:199], v[16:19], a[36:39]
    ds_read_b64_tr_b16 v[172:173], v229 offset:8200
    ds_read_b64_tr_b16 v[174:175], v229 offset:12296
    v_exp_f32 v72, v72
    v_mfma_f32_16x16x32_bf16 a[36:39], a[228:231], v[24:27], a[36:39]
    buffer_load_dwordx4 v232, s[8:11], s33 offen offset:2048  lds
    v_add_f32 v236, v236, v71
    v_mfma_f32_16x16x32_bf16 a[40:43], a[200:203], v[16:19], a[40:43]
    ds_read_b64_tr_b16 v[176:177], v243 offset:32768
    ds_read_b64_tr_b16 v[178:179], v243 offset:36864
    v_cvt_pk_bf16_f32 v67, v70, v71
    v_mfma_f32_16x16x32_bf16 a[40:43], a[232:235], v[24:27], a[40:43]
    ds_read_b64_tr_b16 v[180:181], v243 offset:32776
    ds_read_b64_tr_b16 v[182:183], v243 offset:36872
    v_exp_f32 v73, v73
    v_mfma_f32_16x16x32_bf16 a[44:47], a[204:207], v[16:19], a[44:47]
    buffer_load_dwordx4 v232, s[8:11], s33 offen offset:3072  lds
    v_add_f32 v236, v236, v72
    v_mfma_f32_16x16x32_bf16 a[44:47], a[236:239], v[24:27], a[44:47]
    ds_read_b64_tr_b16 v[184:185], v243 offset:40960
    ds_read_b64_tr_b16 v[186:187], v243 offset:45056
    v_exp_f32 v74, v74
    v_mfma_f32_16x16x32_bf16 a[48:51], a[208:211], v[16:19], a[48:51]
    ds_read_b64_tr_b16 v[188:189], v243 offset:40968
    ds_read_b64_tr_b16 v[190:191], v243 offset:45064
    s_add_u32 s33, s33, 65536
    v_add_f32 v236, v236, v73
    s_waitcnt lgkmcnt(0)
    s_barrier
    v_mfma_f32_16x16x32_bf16 a[48:51], a[240:243], v[24:27], a[48:51]
    s_mov_b32 m0, s24
    s_nop 0
    buffer_load_dwordx4 v240, s[8:11], s33 offen offset:0  lds
    v_cvt_pk_bf16_f32 v72, v72, v73
    v_mfma_f32_16x16x32_bf16 a[52:55], a[212:215], v[16:19], a[52:55]
    ds_read_b64_tr_b16 a[128:129], v220 offset:49152
    v_exp_f32 v75, v75
    v_mfma_f32_16x16x32_bf16 a[52:55], a[244:247], v[24:27], a[52:55]
    ds_read_b64_tr_b16 a[130:131], v220 offset:50176
    v_add_f32 v236, v236, v74
    v_mfma_f32_16x16x32_bf16 a[56:59], a[216:219], v[16:19], a[56:59]
    buffer_load_dwordx4 v240, s[8:11], s33 offen offset:1024  lds
    v_exp_f32 v76, v76
    v_mfma_f32_16x16x32_bf16 a[56:59], a[248:251], v[24:27], a[56:59]
    ds_read_b64_tr_b16 a[160:161], v220 offset:57344
    v_add_f32 v236, v236, v75
    v_mfma_f32_16x16x32_bf16 a[60:63], a[220:223], v[16:19], a[60:63]
    ds_read_b64_tr_b16 a[162:163], v220 offset:58368
    buffer_load_dwordx4 v232, s[8:11], s33 offen offset:2048  lds
    v_cvt_pk_bf16_f32 v73, v74, v75
    v_mfma_f32_16x16x32_bf16 a[60:63], a[252:255], v[24:27], a[60:63]
    v_exp_f32 v77, v77
    v_mfma_f32_16x16x32_bf16 v[208:211], v[216:219], v[16:19], v[208:211]
    ds_read_b64_tr_b16 a[132:133], v221 offset:49152
    ds_read_b64_tr_b16 a[134:135], v221 offset:50176
    v_add_f32 v236, v236, v76
    v_mfma_f32_16x16x32_bf16 v[208:211], v[216:219], v[24:27], v[208:211]
    buffer_load_dwordx4 v232, s[8:11], s33 offen offset:3072  lds
    v_exp_f32 v78, v78
    v_mfma_f32_16x16x32_bf16 a[64:67], a[192:195], v[32:35], a[64:67]
    ds_read_b64_tr_b16 a[164:165], v221 offset:57344
    v_add_f32 v236, v236, v77
    v_mfma_f32_16x16x32_bf16 a[64:67], a[224:227], v[40:43], a[64:67]
    ds_read_b64_tr_b16 a[166:167], v221 offset:58368
    s_add_u32 s33, s33, 65536
    s_mov_b32 m0, s25
    v_cvt_pk_bf16_f32 v74, v76, v77
    v_mfma_f32_16x16x32_bf16 a[68:71], a[196:199], v[32:35], a[68:71]
    buffer_load_dwordx4 v240, s[8:11], s33 offen offset:0  lds
    v_exp_f32 v79, v79
    v_mfma_f32_16x16x32_bf16 a[68:71], a[228:231], v[40:43], a[68:71]
    ds_read_b64_tr_b16 a[136:137], v222 offset:49152
    v_add_f32 v236, v236, v78
    v_mfma_f32_16x16x32_bf16 a[72:75], a[200:203], v[32:35], a[72:75]
    ds_read_b64_tr_b16 a[138:139], v222 offset:50176
    v_exp_f32 v80, v80
    v_mfma_f32_16x16x32_bf16 a[72:75], a[232:235], v[40:43], a[72:75]
    buffer_load_dwordx4 v240, s[8:11], s33 offen offset:1024  lds
    v_add_f32 v236, v236, v79
    v_mfma_f32_16x16x32_bf16 a[76:79], a[204:207], v[32:35], a[76:79]
    ds_read_b64_tr_b16 a[168:169], v222 offset:57344
    ds_read_b64_tr_b16 a[170:171], v222 offset:58368
    v_cvt_pk_bf16_f32 v75, v78, v79
    v_mfma_f32_16x16x32_bf16 a[76:79], a[236:239], v[40:43], a[76:79]
    buffer_load_dwordx4 v232, s[8:11], s33 offen offset:2048  lds
    v_exp_f32 v81, v81
    v_mfma_f32_16x16x32_bf16 a[80:83], a[208:211], v[32:35], a[80:83]
    v_exp_f32 v82, v82
    v_mfma_f32_16x16x32_bf16 a[80:83], a[240:243], v[40:43], a[80:83]
    ds_read_b64_tr_b16 a[140:141], v223 offset:49152
    ds_read_b64_tr_b16 a[142:143], v223 offset:50176
    v_cvt_pk_bf16_f32 v80, v80, v81
    v_mfma_f32_16x16x32_bf16 a[84:87], a[212:215], v[32:35], a[84:87]
    v_exp_f32 v83, v83
    v_mfma_f32_16x16x32_bf16 a[84:87], a[244:247], v[40:43], a[84:87]
    buffer_load_dwordx4 v232, s[8:11], s33 offen offset:3072  lds
    v_exp_f32 v84, v84
    v_mfma_f32_16x16x32_bf16 a[88:91], a[216:219], v[32:35], a[88:91]
    ds_read_b64_tr_b16 a[172:173], v223 offset:57344
    ds_read_b64_tr_b16 a[174:175], v223 offset:58368
    s_add_u32 s33, s33, 65536
    s_mov_b32 m0, s28
    v_mfma_f32_16x16x32_bf16 a[88:91], a[248:251], v[40:43], a[88:91]
    buffer_load_dwordx4 v240, s[8:11], s33 offen offset:0  lds
    v_cvt_pk_bf16_f32 v81, v82, v83
    v_mfma_f32_16x16x32_bf16 a[92:95], a[220:223], v[32:35], a[92:95]
    ds_read_b64_tr_b16 a[144:145], v224 offset:49152
    v_exp_f32 v85, v85
    v_mfma_f32_16x16x32_bf16 a[92:95], a[252:255], v[40:43], a[92:95]
    ds_read_b64_tr_b16 a[146:147], v224 offset:50176
    v_exp_f32 v86, v86
    v_mfma_f32_16x16x32_bf16 a[96:99], a[192:195], v[48:51], a[96:99]
    buffer_load_dwordx4 v240, s[8:11], s33 offen offset:1024  lds
    v_cvt_pk_bf16_f32 v82, v84, v85
    v_mfma_f32_16x16x32_bf16 a[96:99], a[224:227], v[56:59], a[96:99]
    ds_read_b64_tr_b16 a[176:177], v224 offset:57344
    v_exp_f32 v87, v87
    v_mfma_f32_16x16x32_bf16 a[100:103], a[196:199], v[48:51], a[100:103]
    ds_read_b64_tr_b16 a[178:179], v224 offset:58368
    v_exp_f32 v88, v88
    v_mfma_f32_16x16x32_bf16 a[100:103], a[228:231], v[56:59], a[100:103]
    buffer_load_dwordx4 v232, s[8:11], s33 offen offset:2048  lds
    ds_read_b64_tr_b16 a[148:149], v225 offset:49152
    v_mfma_f32_16x16x32_bf16 a[104:107], a[200:203], v[48:51], a[104:107]
    ds_read_b64_tr_b16 a[150:151], v225 offset:50176
    v_cvt_pk_bf16_f32 v83, v86, v87
    v_mfma_f32_16x16x32_bf16 a[104:107], a[232:235], v[56:59], a[104:107]
    buffer_load_dwordx4 v232, s[8:11], s33 offen offset:3072  lds
    v_exp_f32 v89, v89
    v_mfma_f32_16x16x32_bf16 a[108:111], a[204:207], v[48:51], a[108:111]
    s_branch L_io11
    .p2align 12
L_iw11:
    s_branch L_iwr8
L_io11:
    ds_read_b64_tr_b16 a[180:181], v225 offset:57344
    v_exp_f32 v90, v90
    v_mfma_f32_16x16x32_bf16 a[108:111], a[236:239], v[56:59], a[108:111]
    ds_read_b64_tr_b16 a[182:183], v225 offset:58368
    s_add_u32 s33, s33, 65536
    s_mov_b32 m0, s26
    v_cvt_pk_bf16_f32 v88, v88, v89
    v_mfma_f32_16x16x32_bf16 a[112:115], a[208:211], v[48:51], a[112:115]
    v_exp_f32 v91, v91
    v_mfma_f32_16x16x32_bf16 a[112:115], a[240:243], v[56:59], a[112:115]
    buffer_load_dwordx4 v240, s[8:11], s33 offen offset:0  lds
    v_exp_f32 v92, v92
    v_mfma_f32_16x16x32_bf16 a[116:119], a[212:215], v[48:51], a[116:119]
    ds_read_b64_tr_b16 a[152:153], v226 offset:49152
    ds_read_b64_tr_b16 a[154:155], v226 offset:50176
    v_mfma_f32_16x16x32_bf16 a[116:119], a[244:247], v[56:59], a[116:119]
    buffer_load_dwordx4 v240, s[8:11], s33 offen offset:1024  lds
    ds_read_b64_tr_b16 a[184:185], v226 offset:57344
    v_cvt_pk_bf16_f32 v89, v90, v91
    v_mfma_f32_16x16x32_bf16 a[120:123], a[216:219], v[48:51], a[120:123]
    ds_read_b64_tr_b16 a[186:187], v226 offset:58368
    v_exp_f32 v93, v93
    v_mfma_f32_16x16x32_bf16 a[120:123], a[248:251], v[56:59], a[120:123]
    v_exp_f32 v94, v94
    v_mfma_f32_16x16x32_bf16 a[124:127], a[220:223], v[48:51], a[124:127]
    buffer_load_dwordx4 v232, s[8:11], s33 offen offset:2048  lds
    v_cvt_pk_bf16_f32 v90, v92, v93
    v_mfma_f32_16x16x32_bf16 a[124:127], a[252:255], v[56:59], a[124:127]
    ds_read_b64_tr_b16 a[156:157], v227 offset:49152
    v_exp_f32 v95, v95
    v_mfma_f32_16x16x32_bf16 v[212:215], v[216:219], v[48:51], v[212:215]
    ds_read_b64_tr_b16 a[158:159], v227 offset:50176
    buffer_load_dwordx4 v232, s[8:11], s33 offen offset:3072  lds
    v_cvt_pk_bf16_f32 v91, v94, v95
    v_mfma_f32_16x16x32_bf16 v[212:215], v[216:219], v[56:59], v[212:215]
    ds_read_b64_tr_b16 a[188:189], v227 offset:57344
    ds_read_b64_tr_b16 a[190:191], v227 offset:58368
    s_add_u32 s33, s33, 65536
    s_waitcnt vmcnt(12) lgkmcnt(0)
    s_barrier
    v_mfma_f32_16x16x32_bf16 a[0:3], a[128:131], v[64:67], a[0:3]
    s_mov_b32 m0, s31
    v_exp_f32 v96, v96
    s_lshl_b32 s42, s36, 2
    s_add_u32 s42, s42, s3
    s_lshl_b32 s42, s42, 19
    s_lshl_b32 s43, s35, 12
    s_add_u32 s32, s42, s43
    s_add_u32 s39, s32, 131072
    s_add_u32 s40, s32, 262144
    s_add_u32 s41, s32, 393216
    v_mov_b32 v204, v236
    s_nop 1
    v_permlane16_swap_b32 v204, v236
    v_add_f32 v236, v236, v204
    v_mfma_f32_16x16x32_bf16 a[0:3], a[160:163], v[72:75], a[0:3]
    v_exp_f32 v97, v97
    v_mov_b32 v204, v236
    s_nop 1
    v_permlane32_swap_b32 v204, v236
    v_add_f32 v236, v236, v204
    v_rcp_f32 v200, v236
    v_mfma_f32_16x16x32_bf16 a[4:7], a[132:135], v[64:67], a[4:7]
    buffer_load_dwordx4 v240, s[8:11], s33 offen offset:0  lds
    v_add_f32 v238, v238, v96
    v_mfma_f32_16x16x32_bf16 a[4:7], a[164:167], v[72:75], a[4:7]
    v_exp_f32 v98, v98
    v_mfma_f32_16x16x32_bf16 a[8:11], a[136:139], v[64:67], a[8:11]
    ds_read_b64_tr_b16 a[192:193], v229 offset:16384
    v_add_f32 v238, v238, v97
    v_cvt_pk_bf16_f32 v96, v96, v97
    v_accvgpr_read_b32 v32, a0
    v_accvgpr_read_b32 v33, a1
    v_accvgpr_read_b32 v34, a2
    v_accvgpr_read_b32 v35, a3
    v_mfma_f32_16x16x32_bf16 a[8:11], a[168:171], v[72:75], a[8:11]
    v_exp_f32 v99, v99
    v_mfma_f32_16x16x32_bf16 a[12:15], a[140:143], v[64:67], a[12:15]
    ds_read_b64_tr_b16 a[194:195], v229 offset:20480
    v_add_f32 v238, v238, v98
    v_accvgpr_read_b32 v36, a4
    v_accvgpr_read_b32 v37, a5
    v_accvgpr_read_b32 v38, a6
    v_accvgpr_read_b32 v39, a7
    v_mul_f32 v32, v32, v200
    v_mul_f32 v33, v33, v200
    v_mfma_f32_16x16x32_bf16 a[12:15], a[172:175], v[72:75], a[12:15]
    ds_read_b64_tr_b16 a[196:197], v229 offset:16392
    v_exp_f32 v100, v100
    v_mul_f32 v34, v34, v200
    v_mul_f32 v35, v35, v200
    v_mul_f32 v36, v36, v200
    v_mul_f32 v37, v37, v200
    v_mul_f32 v38, v38, v200
    v_mfma_f32_16x16x32_bf16 a[16:19], a[144:147], v[64:67], a[16:19]
    ds_read_b64_tr_b16 a[198:199], v229 offset:20488
    v_add_f32 v238, v238, v99
    v_mul_f32 v39, v39, v200
    v_cvt_pk_bf16_f32 v0, v32, v33
    v_cvt_pk_bf16_f32 v1, v34, v35
    v_cvt_pk_bf16_f32 v2, v36, v37
    v_cvt_pk_bf16_f32 v3, v38, v39
    v_mfma_f32_16x16x32_bf16 a[16:19], a[176:179], v[72:75], a[16:19]
    v_cvt_pk_bf16_f32 v97, v98, v99
    v_exp_f32 v101, v101
    buffer_store_dwordx4 v[0:3], v252, s[20:23], s32 offen offset:0 sc1
    v_accvgpr_read_b32 v40, a8
    v_accvgpr_read_b32 v41, a9
    v_accvgpr_read_b32 v42, a10
    v_mfma_f32_16x16x32_bf16 a[20:23], a[148:151], v[64:67], a[20:23]
    v_add_f32 v238, v238, v100
    v_accvgpr_read_b32 v43, a11
    v_accvgpr_read_b32 v44, a12
    v_accvgpr_read_b32 v45, a13
    v_accvgpr_read_b32 v46, a14
    v_accvgpr_read_b32 v47, a15
    v_mul_f32 v40, v40, v200
    v_mul_f32 v41, v41, v200
    v_mfma_f32_16x16x32_bf16 a[20:23], a[180:183], v[72:75], a[20:23]
    buffer_load_dwordx4 v240, s[8:11], s33 offen offset:1024  lds
    v_exp_f32 v102, v102
    v_mul_f32 v42, v42, v200
    v_mul_f32 v43, v43, v200
    v_mul_f32 v44, v44, v200
    v_mul_f32 v45, v45, v200
    v_mfma_f32_16x16x32_bf16 a[24:27], a[152:155], v[64:67], a[24:27]
    ds_read_b64_tr_b16 a[200:201], v229 offset:24576
    v_add_f32 v238, v238, v101
    v_mul_f32 v46, v46, v200
    v_mul_f32 v47, v47, v200
    v_cvt_pk_bf16_f32 v4, v40, v41
    v_cvt_pk_bf16_f32 v5, v42, v43
    v_cvt_pk_bf16_f32 v6, v44, v45
    v_cvt_pk_bf16_f32 v7, v46, v47
    v_mfma_f32_16x16x32_bf16 a[24:27], a[184:187], v[72:75], a[24:27]
    v_cvt_pk_bf16_f32 v98, v100, v101
    v_exp_f32 v103, v103
    buffer_store_dwordx4 v[4:7], v252, s[20:23], s32 offen offset:1024 sc1
    v_accvgpr_read_b32 v48, a16
    v_accvgpr_read_b32 v49, a17
    v_accvgpr_read_b32 v50, a18
    v_mfma_f32_16x16x32_bf16 a[28:31], a[156:159], v[64:67], a[28:31]
    v_add_f32 v238, v238, v102
    v_accvgpr_read_b32 v51, a19
    v_accvgpr_read_b32 v52, a20
    v_accvgpr_read_b32 v53, a21
    v_accvgpr_read_b32 v54, a22
    v_accvgpr_read_b32 v55, a23
    v_mul_f32 v48, v48, v200
    v_mul_f32 v49, v49, v200
    v_mfma_f32_16x16x32_bf16 a[28:31], a[188:191], v[72:75], a[28:31]
    ds_read_b64_tr_b16 a[202:203], v229 offset:28672
    v_exp_f32 v104, v104
    v_mul_f32 v50, v50, v200
    v_mul_f32 v51, v51, v200
    v_mul_f32 v52, v52, v200
    v_mul_f32 v53, v53, v200
    v_mul_f32 v54, v54, v200
    v_mfma_f32_16x16x32_bf16 a[32:35], a[128:131], v[80:83], a[32:35]
    ds_read_b64_tr_b16 a[204:205], v229 offset:24584
    v_add_f32 v238, v238, v103
    v_mul_f32 v55, v55, v200
    v_cvt_pk_bf16_f32 v8, v48, v49
    v_cvt_pk_bf16_f32 v9, v50, v51
    v_cvt_pk_bf16_f32 v10, v52, v53
    v_cvt_pk_bf16_f32 v11, v54, v55
    v_mfma_f32_16x16x32_bf16 a[32:35], a[160:163], v[88:91], a[32:35]
    ds_read_b64_tr_b16 a[206:207], v229 offset:28680
    v_cvt_pk_bf16_f32 v99, v102, v103
    buffer_store_dwordx4 v[8:11], v252, s[20:23], s32 offen offset:2048 sc1
    v_accvgpr_read_b32 v56, a24
    v_accvgpr_read_b32 v57, a25
    v_accvgpr_read_b32 v58, a26
    v_accvgpr_read_b32 v59, a27
    v_mfma_f32_16x16x32_bf16 a[36:39], a[132:135], v[80:83], a[36:39]
    v_exp_f32 v105, v105
    v_add_f32 v238, v238, v104
    v_accvgpr_read_b32 v60, a28
    v_accvgpr_read_b32 v61, a29
    v_accvgpr_read_b32 v62, a30
    v_accvgpr_read_b32 v63, a31
    v_mul_f32 v56, v56, v200
    v_mfma_f32_16x16x32_bf16 a[36:39], a[164:167], v[88:91], a[36:39]
    v_exp_f32 v106, v106
    v_mul_f32 v57, v57, v200
    v_mul_f32 v58, v58, v200
    v_mul_f32 v59, v59, v200
    v_mul_f32 v60, v60, v200
    v_mul_f32 v61, v61, v200
    v_mul_f32 v62, v62, v200
    v_mfma_f32_16x16x32_bf16 a[40:43], a[136:139], v[80:83], a[40:43]
    buffer_load_dwordx4 v232, s[8:11], s33 offen offset:2048  lds
    v_add_f32 v238, v238, v105
    v_mul_f32 v63, v63, v200
    v_cvt_pk_bf16_f32 v12, v56, v57
    v_cvt_pk_bf16_f32 v13, v58, v59
    v_cvt_pk_bf16_f32 v14, v60, v61
    v_cvt_pk_bf16_f32 v15, v62, v63
    v_mfma_f32_16x16x32_bf16 a[40:43], a[168:171], v[88:91], a[40:43]
    ds_read_b64_tr_b16 a[208:209], v243 offset:49152
    v_cvt_pk_bf16_f32 v104, v104, v105
    buffer_store_dwordx4 v[12:15], v252, s[20:23], s32 offen offset:3072 sc1
    v_mfma_f32_16x16x32_bf16 a[44:47], a[140:143], v[80:83], a[44:47]
    v_exp_f32 v107, v107
    v_mfma_f32_16x16x32_bf16 a[44:47], a[172:175], v[88:91], a[44:47]
    v_add_f32 v238, v238, v106
    v_exp_f32 v108, v108
    v_mfma_f32_16x16x32_bf16 a[48:51], a[144:147], v[80:83], a[48:51]
    ds_read_b64_tr_b16 a[210:211], v243 offset:53248
    v_add_f32 v238, v238, v107
    v_mfma_f32_16x16x32_bf16 a[48:51], a[176:179], v[88:91], a[48:51]
    ds_read_b64_tr_b16 a[212:213], v243 offset:49160
    v_cvt_pk_bf16_f32 v105, v106, v107
    v_mfma_f32_16x16x32_bf16 a[52:55], a[148:151], v[80:83], a[52:55]
    ds_read_b64_tr_b16 a[214:215], v243 offset:53256
    v_exp_f32 v109, v109
    v_mfma_f32_16x16x32_bf16 a[52:55], a[180:183], v[88:91], a[52:55]
    v_add_f32 v238, v238, v108
    v_exp_f32 v110, v110
    v_mfma_f32_16x16x32_bf16 a[56:59], a[152:155], v[80:83], a[56:59]
    v_add_f32 v238, v238, v109
    v_mfma_f32_16x16x32_bf16 a[56:59], a[184:187], v[88:91], a[56:59]
    buffer_load_dwordx4 v232, s[8:11], s33 offen offset:3072  lds
    v_cvt_pk_bf16_f32 v106, v108, v109
    v_mfma_f32_16x16x32_bf16 a[60:63], a[156:159], v[80:83], a[60:63]
    v_exp_f32 v111, v111
    v_mfma_f32_16x16x32_bf16 a[60:63], a[188:191], v[88:91], a[60:63]
    ds_read_b64_tr_b16 a[216:217], v243 offset:57344
    ds_read_b64_tr_b16 a[218:219], v243 offset:61440
    v_add_f32 v238, v238, v110
    v_mfma_f32_16x16x32_bf16 v[208:211], v[216:219], v[80:83], v[208:211]
    v_exp_f32 v112, v112
    v_add_f32 v238, v238, v111
    v_mfma_f32_16x16x32_bf16 v[208:211], v[216:219], v[88:91], v[208:211]
    v_cvt_pk_bf16_f32 v107, v110, v111
    v_mfma_f32_16x16x32_bf16 a[64:67], a[128:131], v[96:99], a[64:67]
    ds_read_b64_tr_b16 a[220:221], v243 offset:57352
    v_exp_f32 v113, v113
    v_mfma_f32_16x16x32_bf16 a[64:67], a[160:163], v[104:107], a[64:67]
    v_exp_f32 v114, v114
    v_mfma_f32_16x16x32_bf16 a[68:71], a[132:135], v[96:99], a[68:71]
    ds_read_b64_tr_b16 a[222:223], v243 offset:61448
    s_add_u32 s33, s33, 65536
    s_add_u32 s12, s38, 16384
    v_cvt_pk_bf16_f32 v112, v112, v113
    v_rcp_f32 v201, v208
    v_accvgpr_read_b32 v32, a32
    v_accvgpr_read_b32 v33, a33
    v_accvgpr_read_b32 v34, a34
    v_mfma_f32_16x16x32_bf16 a[68:71], a[164:167], v[104:107], a[68:71]
    v_exp_f32 v115, v115
    v_accvgpr_read_b32 v35, a35
    v_accvgpr_read_b32 v36, a36
    v_accvgpr_read_b32 v37, a37
    v_accvgpr_read_b32 v38, a38
    v_accvgpr_read_b32 v39, a39
    v_mul_f32 v32, v32, v201
    v_mfma_f32_16x16x32_bf16 a[72:75], a[136:139], v[96:99], a[72:75]
    v_exp_f32 v116, v116
    v_mul_f32 v33, v33, v201
    v_mul_f32 v34, v34, v201
    v_mul_f32 v35, v35, v201
    v_mul_f32 v36, v36, v201
    v_mul_f32 v37, v37, v201
    v_mul_f32 v38, v38, v201
    v_mfma_f32_16x16x32_bf16 a[72:75], a[168:171], v[104:107], a[72:75]
    buffer_load_dwordx4 v[220:223], v241, s[76:79], s38 offen
    v_cvt_pk_bf16_f32 v113, v114, v115
    v_mul_f32 v39, v39, v201
    v_cvt_pk_bf16_f32 v16, v32, v33
    v_cvt_pk_bf16_f32 v17, v34, v35
    v_cvt_pk_bf16_f32 v18, v36, v37
    v_cvt_pk_bf16_f32 v19, v38, v39
    v_mfma_f32_16x16x32_bf16 a[76:79], a[140:143], v[96:99], a[76:79]
    ds_read_b64_tr_b16 a[224:225], v229 offset:32768
    v_exp_f32 v117, v117
    buffer_store_dwordx4 v[16:19], v252, s[20:23], s39 offen offset:0 sc1
    v_accvgpr_read_b32 v40, a40
    v_accvgpr_read_b32 v41, a41
    v_accvgpr_read_b32 v42, a42
    v_mfma_f32_16x16x32_bf16 a[76:79], a[172:175], v[104:107], a[76:79]
    v_exp_f32 v118, v118
    v_accvgpr_read_b32 v43, a43
    v_accvgpr_read_b32 v44, a44
    v_accvgpr_read_b32 v45, a45
    v_accvgpr_read_b32 v46, a46
    v_accvgpr_read_b32 v47, a47
    v_mul_f32 v40, v40, v201
    v_mfma_f32_16x16x32_bf16 a[80:83], a[144:147], v[96:99], a[80:83]
    ds_read_b64_tr_b16 a[226:227], v229 offset:36864
    v_cvt_pk_bf16_f32 v114, v116, v117
    v_mul_f32 v41, v41, v201
    v_mul_f32 v42, v42, v201
    v_mul_f32 v43, v43, v201
    v_mul_f32 v44, v44, v201
    v_mul_f32 v45, v45, v201
    v_mul_f32 v46, v46, v201
    v_mfma_f32_16x16x32_bf16 a[80:83], a[176:179], v[104:107], a[80:83]
    ds_read_b64_tr_b16 a[228:229], v229 offset:32776
    v_exp_f32 v119, v119
    v_mul_f32 v47, v47, v201
    v_cvt_pk_bf16_f32 v20, v40, v41
    v_cvt_pk_bf16_f32 v21, v42, v43
    v_cvt_pk_bf16_f32 v22, v44, v45
    v_cvt_pk_bf16_f32 v23, v46, v47
    v_mfma_f32_16x16x32_bf16 a[84:87], a[148:151], v[96:99], a[84:87]
    v_exp_f32 v120, v120
    buffer_store_dwordx4 v[20:23], v252, s[20:23], s39 offen offset:1024 sc1
    v_accvgpr_read_b32 v48, a48
    v_accvgpr_read_b32 v49, a49
    v_accvgpr_read_b32 v50, a50
    v_accvgpr_read_b32 v51, a51
    v_mfma_f32_16x16x32_bf16 a[84:87], a[180:183], v[104:107], a[84:87]
    ds_read_b64_tr_b16 a[230:231], v229 offset:36872
    v_cvt_pk_bf16_f32 v115, v118, v119
    v_accvgpr_read_b32 v52, a52
    v_accvgpr_read_b32 v53, a53
    v_accvgpr_read_b32 v54, a54
    v_accvgpr_read_b32 v55, a55
    v_mul_f32 v48, v48, v201
    v_mul_f32 v49, v49, v201
    v_mfma_f32_16x16x32_bf16 a[88:91], a[152:155], v[96:99], a[88:91]
    v_exp_f32 v121, v121
    v_mul_f32 v50, v50, v201
    v_mul_f32 v51, v51, v201
    v_mul_f32 v52, v52, v201
    v_mul_f32 v53, v53, v201
    v_mul_f32 v54, v54, v201
    v_mul_f32 v55, v55, v201
    v_mfma_f32_16x16x32_bf16 a[88:91], a[184:187], v[104:107], a[88:91]
    buffer_load_dwordx4 v[224:227], v241, s[76:79], s12 offen
    v_exp_f32 v122, v122
    v_cvt_pk_bf16_f32 v24, v48, v49
    v_cvt_pk_bf16_f32 v25, v50, v51
    v_cvt_pk_bf16_f32 v26, v52, v53
    v_cvt_pk_bf16_f32 v27, v54, v55
    v_mfma_f32_16x16x32_bf16 a[92:95], a[156:159], v[96:99], a[92:95]
    v_cvt_pk_bf16_f32 v120, v120, v121
    v_exp_f32 v123, v123
    buffer_store_dwordx4 v[24:27], v252, s[20:23], s39 offen offset:2048 sc1
    v_accvgpr_read_b32 v56, a56
    v_accvgpr_read_b32 v57, a57
    v_accvgpr_read_b32 v58, a58
    v_mfma_f32_16x16x32_bf16 a[92:95], a[188:191], v[104:107], a[92:95]
    ds_read_b64_tr_b16 a[232:233], v229 offset:40960
    v_accvgpr_read_b32 v59, a59
    v_accvgpr_read_b32 v60, a60
    v_accvgpr_read_b32 v61, a61
    v_accvgpr_read_b32 v62, a62
    v_accvgpr_read_b32 v63, a63
    v_mul_f32 v56, v56, v201
    v_mul_f32 v57, v57, v201
    v_mfma_f32_16x16x32_bf16 a[96:99], a[128:131], v[112:115], a[96:99]
    v_exp_f32 v124, v124
    v_mul_f32 v58, v58, v201
    v_mul_f32 v59, v59, v201
    v_mul_f32 v60, v60, v201
    v_mul_f32 v61, v61, v201
    v_mul_f32 v62, v62, v201
    v_mul_f32 v63, v63, v201
    v_mfma_f32_16x16x32_bf16 a[100:103], a[132:135], v[112:115], a[100:103]
    v_cvt_pk_bf16_f32 v121, v122, v123
    v_exp_f32 v125, v125
    v_cvt_pk_bf16_f32 v28, v56, v57
    v_cvt_pk_bf16_f32 v29, v58, v59
    v_cvt_pk_bf16_f32 v30, v60, v61
    v_cvt_pk_bf16_f32 v31, v62, v63
    v_mfma_f32_16x16x32_bf16 a[104:107], a[136:139], v[112:115], a[104:107]
    ds_read_b64_tr_b16 a[234:235], v229 offset:45056
    ds_read_b64_tr_b16 a[236:237], v229 offset:40968
    buffer_store_dwordx4 v[28:31], v252, s[20:23], s39 offen offset:3072 sc1
    v_mfma_f32_16x16x32_bf16 a[108:111], a[140:143], v[112:115], a[108:111]
    v_exp_f32 v126, v126
    v_cvt_pk_bf16_f32 v122, v124, v125
    v_mfma_f32_16x16x32_bf16 a[112:115], a[144:147], v[112:115], a[112:115]
    v_exp_f32 v127, v127
    v_mfma_f32_16x16x32_bf16 a[116:119], a[148:151], v[112:115], a[116:119]
    ds_read_b64_tr_b16 a[238:239], v229 offset:45064
    v_cvt_pk_bf16_f32 v123, v126, v127
    v_mfma_f32_16x16x32_bf16 a[120:123], a[152:155], v[112:115], a[120:123]
    buffer_load_dwordx2 v[234:235], v242, s[20:23], s58 offen sc1
    ds_read_b64_tr_b16 a[240:241], v243 offset:0
    v_mfma_f32_16x16x32_bf16 a[124:127], a[156:159], v[112:115], a[124:127]
    ds_read_b64_tr_b16 a[242:243], v243 offset:4096
    ds_read_b64_tr_b16 a[244:245], v243 offset:8
    v_mfma_f32_16x16x32_bf16 a[96:99], a[160:163], v[120:123], a[96:99]
    ds_read_b64_tr_b16 a[246:247], v243 offset:4104
    buffer_load_dwordx2 v[230:231], v242, s[20:23], s58 offen offset:128 sc1
    v_mfma_f32_16x16x32_bf16 a[100:103], a[164:167], v[120:123], a[100:103]
    ds_read_b64_tr_b16 a[248:249], v243 offset:8192
    ds_read_b64_tr_b16 a[250:251], v243 offset:12288
    v_mfma_f32_16x16x32_bf16 a[104:107], a[168:171], v[120:123], a[104:107]
    ds_read_b64_tr_b16 a[252:253], v243 offset:8200
    ds_read_b64_tr_b16 a[254:255], v243 offset:12296
    s_waitcnt vmcnt(8)
    s_waitcnt lgkmcnt(0)
    s_barrier
    v_mfma_f32_16x16x32_bf16 a[108:111], a[172:175], v[120:123], a[108:111]
    v_mfma_f32_16x16x32_bf16 a[112:115], a[176:179], v[120:123], a[112:115]
    v_mfma_f32_16x16x32_bf16 a[116:119], a[180:183], v[120:123], a[116:119]
    v_mfma_f32_16x16x32_bf16 a[120:123], a[184:187], v[120:123], a[120:123]
    v_mfma_f32_16x16x32_bf16 a[124:127], a[188:191], v[120:123], a[124:127]
    v_mfma_f32_16x16x32_bf16 v[212:215], v[216:219], v[112:115], v[212:215]
    v_mfma_f32_16x16x32_bf16 v[212:215], v[216:219], v[120:123], v[212:215]
    v_mov_b32 v206, v238
    s_nop 1
    v_permlane16_swap_b32 v206, v238
    s_branch L_io12
    .p2align 12
L_iw12:
    s_branch L_iwr1
L_io12:
    v_add_f32 v238, v238, v206
    v_mov_b32 v206, v238
    s_nop 1
    v_permlane32_swap_b32 v206, v238
    v_add_f32 v238, v238, v206
    s_mov_b32 s43, 0x5d800000
    v_rcp_f32 v202, v238
    v_rcp_f32 v203, v212
    v_cmp_nlt_f32 s[80:81], v236, s43
    v_cmp_nlt_f32 s[82:83], v208, s43
    v_cmp_nlt_f32 s[84:85], v238, s43
    v_cmp_nlt_f32 s[86:87], v212, s43
    v_mov_b32 v196, 0
    v_mov_b32 v197, 0
    v_mov_b32 v198, 0
    v_mov_b32 v199, 0
    s_or_b64 s[80:81], s[80:81], s[82:83]
    s_or_b64 s[84:85], s[84:85], s[86:87]
    s_or_b64 s[80:81], s[80:81], s[84:85]
    v_accvgpr_read_b32 v64, a64
    v_accvgpr_read_b32 v65, a65
    v_accvgpr_read_b32 v66, a66
    v_accvgpr_read_b32 v67, a67
    v_accvgpr_read_b32 v68, a68
    v_accvgpr_read_b32 v69, a69
    v_accvgpr_read_b32 v70, a70
    v_accvgpr_read_b32 v71, a71
    v_mfma_f32_16x16x32_bf16 v[204:207], v[196:199], v[0:3], 0
    ds_read_b64_tr_b16 a[128:129], v243 offset:16384
    ds_read_b64_tr_b16 a[130:131], v243 offset:20480
    v_pk_mul_f32 v[64:65], v[64:65], v[202:203] op_sel:[0,0] op_sel_hi:[1,0]
    v_pk_mul_f32 v[66:67], v[66:67], v[202:203] op_sel:[0,0] op_sel_hi:[1,0]
    v_pk_mul_f32 v[68:69], v[68:69], v[202:203] op_sel:[0,0] op_sel_hi:[1,0]
    v_pk_mul_f32 v[70:71], v[70:71], v[202:203] op_sel:[0,0] op_sel_hi:[1,0]
    ds_read_b64_tr_b16 a[132:133], v243 offset:16392
    ds_read_b64_tr_b16 a[134:135], v243 offset:20488
    v_cvt_pk_bf16_f32 v32, v64, v65
    v_cvt_pk_bf16_f32 v33, v66, v67
    v_cvt_pk_bf16_f32 v34, v68, v69
    v_cvt_pk_bf16_f32 v35, v70, v71
    v_mfma_f32_16x16x32_bf16 v[204:207], v[196:199], v[4:7], v[204:207]
    buffer_store_dwordx4 v[32:35], v252, s[20:23], s40 offen offset:0 sc1
    ds_read_b64_tr_b16 a[136:137], v243 offset:24576
    v_accvgpr_read_b32 v72, a72
    v_accvgpr_read_b32 v73, a73
    v_accvgpr_read_b32 v74, a74
    v_accvgpr_read_b32 v75, a75
    v_accvgpr_read_b32 v76, a76
    v_accvgpr_read_b32 v77, a77
    v_accvgpr_read_b32 v78, a78
    v_accvgpr_read_b32 v79, a79
    v_mfma_f32_16x16x32_bf16 v[204:207], v[196:199], v[8:11], v[204:207]
    ds_read_b64_tr_b16 a[138:139], v243 offset:28672
    ds_read_b64_tr_b16 a[140:141], v243 offset:24584
    v_pk_mul_f32 v[72:73], v[72:73], v[202:203] op_sel:[0,0] op_sel_hi:[1,0]
    v_pk_mul_f32 v[74:75], v[74:75], v[202:203] op_sel:[0,0] op_sel_hi:[1,0]
    v_pk_mul_f32 v[76:77], v[76:77], v[202:203] op_sel:[0,0] op_sel_hi:[1,0]
    v_pk_mul_f32 v[78:79], v[78:79], v[202:203] op_sel:[0,0] op_sel_hi:[1,0]
    ds_read_b64_tr_b16 a[142:143], v243 offset:28680
    ds_read_b64_tr_b16 a[144:145], v229 offset:0
    v_cvt_pk_bf16_f32 v36, v72, v73
    v_cvt_pk_bf16_f32 v37, v74, v75
    v_cvt_pk_bf16_f32 v38, v76, v77
    v_cvt_pk_bf16_f32 v39, v78, v79
    v_mfma_f32_16x16x32_bf16 v[204:207], v[196:199], v[12:15], v[204:207]
    buffer_store_dwordx4 v[36:39], v252, s[20:23], s40 offen offset:1024 sc1
    ds_read_b64_tr_b16 a[146:147], v229 offset:4096
    v_accvgpr_read_b32 v80, a80
    v_accvgpr_read_b32 v81, a81
    v_accvgpr_read_b32 v82, a82
    v_accvgpr_read_b32 v83, a83
    v_accvgpr_read_b32 v84, a84
    v_accvgpr_read_b32 v85, a85
    v_accvgpr_read_b32 v86, a86
    v_accvgpr_read_b32 v87, a87
    v_mfma_f32_16x16x32_bf16 v[204:207], v[196:199], v[16:19], v[204:207]
    ds_read_b64_tr_b16 a[148:149], v229 offset:8
    ds_read_b64_tr_b16 a[150:151], v229 offset:4104
    v_pk_mul_f32 v[80:81], v[80:81], v[202:203] op_sel:[0,0] op_sel_hi:[1,0]
    v_pk_mul_f32 v[82:83], v[82:83], v[202:203] op_sel:[0,0] op_sel_hi:[1,0]
    v_pk_mul_f32 v[84:85], v[84:85], v[202:203] op_sel:[0,0] op_sel_hi:[1,0]
    v_pk_mul_f32 v[86:87], v[86:87], v[202:203] op_sel:[0,0] op_sel_hi:[1,0]
    ds_read_b64_tr_b16 a[152:153], v229 offset:8192
    ds_read_b64_tr_b16 a[154:155], v229 offset:12288
    v_cvt_pk_bf16_f32 v40, v80, v81
    v_cvt_pk_bf16_f32 v41, v82, v83
    v_cvt_pk_bf16_f32 v42, v84, v85
    v_cvt_pk_bf16_f32 v43, v86, v87
    v_mfma_f32_16x16x32_bf16 v[204:207], v[196:199], v[20:23], v[204:207]
    buffer_store_dwordx4 v[40:43], v252, s[20:23], s40 offen offset:2048 sc1
    ds_read_b64_tr_b16 a[156:157], v229 offset:8200
    v_accvgpr_read_b32 v88, a88
    v_accvgpr_read_b32 v89, a89
    v_accvgpr_read_b32 v90, a90
    v_accvgpr_read_b32 v91, a91
    v_accvgpr_read_b32 v92, a92
    v_accvgpr_read_b32 v93, a93
    v_accvgpr_read_b32 v94, a94
    v_accvgpr_read_b32 v95, a95
    v_mfma_f32_16x16x32_bf16 v[204:207], v[196:199], v[24:27], v[204:207]
    ds_read_b64_tr_b16 a[158:159], v229 offset:12296
    ds_read_b64_tr_b16 a[160:161], v243 offset:32768
    v_pk_mul_f32 v[88:89], v[88:89], v[202:203] op_sel:[0,0] op_sel_hi:[1,0]
    v_pk_mul_f32 v[90:91], v[90:91], v[202:203] op_sel:[0,0] op_sel_hi:[1,0]
    v_pk_mul_f32 v[92:93], v[92:93], v[202:203] op_sel:[0,0] op_sel_hi:[1,0]
    v_pk_mul_f32 v[94:95], v[94:95], v[202:203] op_sel:[0,0] op_sel_hi:[1,0]
    ds_read_b64_tr_b16 a[162:163], v243 offset:36864
    ds_read_b64_tr_b16 a[164:165], v243 offset:32776
    v_cvt_pk_bf16_f32 v44, v88, v89
    v_cvt_pk_bf16_f32 v45, v90, v91
    v_cvt_pk_bf16_f32 v46, v92, v93
    v_cvt_pk_bf16_f32 v47, v94, v95
    v_mfma_f32_16x16x32_bf16 v[204:207], v[196:199], v[28:31], v[204:207]
    buffer_store_dwordx4 v[44:47], v252, s[20:23], s40 offen offset:3072 sc1
    ds_read_b64_tr_b16 a[166:167], v243 offset:36872
    v_accvgpr_read_b32 v96, a96
    v_accvgpr_read_b32 v97, a97
    v_accvgpr_read_b32 v98, a98
    v_accvgpr_read_b32 v99, a99
    v_accvgpr_read_b32 v100, a100
    v_accvgpr_read_b32 v101, a101
    v_accvgpr_read_b32 v102, a102
    v_accvgpr_read_b32 v103, a103
    v_mfma_f32_16x16x32_bf16 v[204:207], v[196:199], v[32:35], v[204:207]
    ds_read_b64_tr_b16 a[168:169], v243 offset:40960
    ds_read_b64_tr_b16 a[170:171], v243 offset:45056
    v_pk_mul_f32 v[96:97], v[96:97], v[202:203] op_sel:[0,1] op_sel_hi:[1,1]
    v_pk_mul_f32 v[98:99], v[98:99], v[202:203] op_sel:[0,1] op_sel_hi:[1,1]
    v_pk_mul_f32 v[100:101], v[100:101], v[202:203] op_sel:[0,1] op_sel_hi:[1,1]
    v_pk_mul_f32 v[102:103], v[102:103], v[202:203] op_sel:[0,1] op_sel_hi:[1,1]
    ds_read_b64_tr_b16 a[172:173], v243 offset:40968
    ds_read_b64_tr_b16 a[174:175], v243 offset:45064
    v_cvt_pk_bf16_f32 v48, v96, v97
    v_cvt_pk_bf16_f32 v49, v98, v99
    v_cvt_pk_bf16_f32 v50, v100, v101
    v_cvt_pk_bf16_f32 v51, v102, v103
    v_mfma_f32_16x16x32_bf16 v[204:207], v[196:199], v[36:39], v[204:207]
    buffer_store_dwordx4 v[48:51], v252, s[20:23], s41 offen offset:0 sc1
    ds_read_b64_tr_b16 a[176:177], v229 offset:49152
    v_accvgpr_read_b32 v104, a104
    v_accvgpr_read_b32 v105, a105
    v_accvgpr_read_b32 v106, a106
    v_accvgpr_read_b32 v107, a107
    v_accvgpr_read_b32 v108, a108
    v_accvgpr_read_b32 v109, a109
    v_accvgpr_read_b32 v110, a110
    v_accvgpr_read_b32 v111, a111
    v_mfma_f32_16x16x32_bf16 v[204:207], v[196:199], v[40:43], v[204:207]
    ds_read_b64_tr_b16 a[178:179], v229 offset:53248
    ds_read_b64_tr_b16 a[180:181], v229 offset:49160
    v_pk_mul_f32 v[104:105], v[104:105], v[202:203] op_sel:[0,1] op_sel_hi:[1,1]
    v_pk_mul_f32 v[106:107], v[106:107], v[202:203] op_sel:[0,1] op_sel_hi:[1,1]
    v_pk_mul_f32 v[108:109], v[108:109], v[202:203] op_sel:[0,1] op_sel_hi:[1,1]
    v_pk_mul_f32 v[110:111], v[110:111], v[202:203] op_sel:[0,1] op_sel_hi:[1,1]
    ds_read_b64_tr_b16 a[182:183], v229 offset:53256
    ds_read_b64_tr_b16 a[184:185], v229 offset:57344
    v_cvt_pk_bf16_f32 v52, v104, v105
    v_cvt_pk_bf16_f32 v53, v106, v107
    v_cvt_pk_bf16_f32 v54, v108, v109
    v_cvt_pk_bf16_f32 v55, v110, v111
    v_mfma_f32_16x16x32_bf16 v[204:207], v[196:199], v[44:47], v[204:207]
    buffer_store_dwordx4 v[52:55], v252, s[20:23], s41 offen offset:1024 sc1
    ds_read_b64_tr_b16 a[186:187], v229 offset:61440
    v_accvgpr_read_b32 v112, a112
    v_accvgpr_read_b32 v113, a113
    v_accvgpr_read_b32 v114, a114
    v_accvgpr_read_b32 v115, a115
    v_accvgpr_read_b32 v116, a116
    v_accvgpr_read_b32 v117, a117
    v_accvgpr_read_b32 v118, a118
    v_accvgpr_read_b32 v119, a119
    v_mfma_f32_16x16x32_bf16 v[204:207], v[196:199], v[48:51], v[204:207]
    ds_read_b64_tr_b16 a[188:189], v229 offset:57352
    ds_read_b64_tr_b16 a[190:191], v229 offset:61448
    v_pk_mul_f32 v[112:113], v[112:113], v[202:203] op_sel:[0,1] op_sel_hi:[1,1]
    v_pk_mul_f32 v[114:115], v[114:115], v[202:203] op_sel:[0,1] op_sel_hi:[1,1]
    v_pk_mul_f32 v[116:117], v[116:117], v[202:203] op_sel:[0,1] op_sel_hi:[1,1]
    v_pk_mul_f32 v[118:119], v[118:119], v[202:203] op_sel:[0,1] op_sel_hi:[1,1]
    v_cvt_pk_bf16_f32 v56, v112, v113
    v_cvt_pk_bf16_f32 v57, v114, v115
    v_cvt_pk_bf16_f32 v58, v116, v117
    v_cvt_pk_bf16_f32 v59, v118, v119
    v_mfma_f32_16x16x32_bf16 v[204:207], v[196:199], v[52:55], v[204:207]
    buffer_store_dwordx4 v[56:59], v252, s[20:23], s41 offen offset:2048 sc1
    v_accvgpr_read_b32 v120, a120
    v_accvgpr_read_b32 v121, a121
    v_accvgpr_read_b32 v122, a122
    v_accvgpr_read_b32 v123, a123
    v_accvgpr_read_b32 v124, a124
    v_accvgpr_read_b32 v125, a125
    v_accvgpr_read_b32 v126, a126
    v_accvgpr_read_b32 v127, a127
    v_mfma_f32_16x16x32_bf16 v[204:207], v[196:199], v[56:59], v[204:207]
    v_pk_mul_f32 v[120:121], v[120:121], v[202:203] op_sel:[0,1] op_sel_hi:[1,1]
    v_pk_mul_f32 v[122:123], v[122:123], v[202:203] op_sel:[0,1] op_sel_hi:[1,1]
    v_pk_mul_f32 v[124:125], v[124:125], v[202:203] op_sel:[0,1] op_sel_hi:[1,1]
    v_pk_mul_f32 v[126:127], v[126:127], v[202:203] op_sel:[0,1] op_sel_hi:[1,1]
    v_cvt_pk_bf16_f32 v60, v120, v121
    v_cvt_pk_bf16_f32 v61, v122, v123
    v_cvt_pk_bf16_f32 v62, v124, v125
    v_cvt_pk_bf16_f32 v63, v126, v127
    buffer_store_dwordx4 v[60:63], v252, s[20:23], s41 offen offset:3072 sc1
    s_nop 0
    v_mfma_f32_16x16x32_bf16 v[204:207], v[196:199], v[60:63], v[204:207]
    s_waitcnt vmcnt(8)
    v_lshlrev_b32 v235, 16, v234
    v_and_b32 v234, 0xffff0000, v234
    v_rcp_f32 v235, v235
    v_lshlrev_b32 v231, 16, v230
    v_and_b32 v230, 0xffff0000, v230
    v_rcp_f32 v231, v231
    s_lshl_b32 s43, s3, 2
    s_add_u32 s43, s43, 131584
    v_mov_b32 v65, s43
    v_cmp_u_f32 vcc, v204, v204
    s_nop 0
    s_or_b64 vcc, vcc, s[80:81]
    s_cmp_lg_u64 vcc, 0
    s_cselect_b32 s42, 1, 0
    s_andn2_b32 s42, s42, s74
    v_mov_b32 v64, s42
    ds_write_b32 v65, v64
    v_lshlrev_b32 v80, 16, v220
    v_and_b32 v81, 0xffff0000, v220
    v_lshlrev_b32 v82, 16, v221
    v_and_b32 v83, 0xffff0000, v221
    v_lshlrev_b32 v84, 16, v222
    v_and_b32 v85, 0xffff0000, v222
    v_lshlrev_b32 v86, 16, v223
    v_and_b32 v87, 0xffff0000, v223
    v_lshlrev_b32 v88, 16, v224
    v_and_b32 v89, 0xffff0000, v224
    v_lshlrev_b32 v90, 16, v225
    v_and_b32 v91, 0xffff0000, v225
    v_lshlrev_b32 v92, 16, v226
    v_and_b32 v93, 0xffff0000, v226
    v_lshlrev_b32 v94, 16, v227
    v_and_b32 v95, 0xffff0000, v227
    v_sub_f32 v80, v80, v234
    v_sub_f32 v81, v81, v234
    v_sub_f32 v82, v82, v234
    v_sub_f32 v83, v83, v234
    v_sub_f32 v84, v84, v234
    v_sub_f32 v85, v85, v234
    v_sub_f32 v86, v86, v234
    v_sub_f32 v87, v87, v234
    v_sub_f32 v88, v88, v230
    v_sub_f32 v89, v89, v230
    v_sub_f32 v90, v90, v230
    v_sub_f32 v91, v91, v230
    v_sub_f32 v92, v92, v230
    v_sub_f32 v93, v93, v230
    v_sub_f32 v94, v94, v230
    v_sub_f32 v95, v95, v230
    v_cvt_pk_bf16_f32 v80, v80, v81
    v_cvt_pk_bf16_f32 v82, v82, v83
    v_cvt_pk_bf16_f32 v84, v84, v85
    v_cvt_pk_bf16_f32 v86, v86, v87
    v_cvt_pk_bf16_f32 v88, v88, v89
    v_cvt_pk_bf16_f32 v90, v90, v91
    v_cvt_pk_bf16_f32 v92, v92, v93
    v_cvt_pk_bf16_f32 v94, v94, v95
    v_and_b32 v81, 0xffff0000, v80
    v_lshlrev_b32 v80, 16, v80
    v_and_b32 v83, 0xffff0000, v82
    v_lshlrev_b32 v82, 16, v82
    v_and_b32 v85, 0xffff0000, v84
    v_lshlrev_b32 v84, 16, v84
    v_and_b32 v87, 0xffff0000, v86
    v_lshlrev_b32 v86, 16, v86
    v_and_b32 v89, 0xffff0000, v88
    v_lshlrev_b32 v88, 16, v88
    v_and_b32 v91, 0xffff0000, v90
    v_lshlrev_b32 v90, 16, v90
    v_and_b32 v93, 0xffff0000, v92
    v_lshlrev_b32 v92, 16, v92
    v_and_b32 v95, 0xffff0000, v94
    v_lshlrev_b32 v94, 16, v94
    v_mul_f32 v80, v80, v235
    v_mul_f32 v81, v81, v235
    v_mul_f32 v82, v82, v235
    v_mul_f32 v83, v83, v235
    v_mul_f32 v84, v84, v235
    v_mul_f32 v85, v85, v235
    v_mul_f32 v86, v86, v235
    v_mul_f32 v87, v87, v235
    v_mul_f32 v88, v88, v231
    v_mul_f32 v89, v89, v231
    v_mul_f32 v90, v90, v231
    v_mul_f32 v91, v91, v231
    v_mul_f32 v92, v92, v231
    v_mul_f32 v93, v93, v231
    v_mul_f32 v94, v94, v231
    v_mul_f32 v95, v95, v231
    v_cvt_pk_bf16_f32 v80, v80, v81
    v_cvt_pk_bf16_f32 v82, v82, v83
    v_cvt_pk_bf16_f32 v84, v84, v85
    v_cvt_pk_bf16_f32 v86, v86, v87
    v_cvt_pk_bf16_f32 v88, v88, v89
    v_cvt_pk_bf16_f32 v90, v90, v91
    v_cvt_pk_bf16_f32 v92, v92, v93
    v_cvt_pk_bf16_f32 v94, v94, v95
    v_and_b32 v81, 0xffff0000, v80
    v_lshlrev_b32 v80, 16, v80
    v_and_b32 v83, 0xffff0000, v82
    v_lshlrev_b32 v82, 16, v82
    v_and_b32 v85, 0xffff0000, v84
    v_lshlrev_b32 v84, 16, v84
    v_and_b32 v87, 0xffff0000, v86
    v_lshlrev_b32 v86, 16, v86
    v_and_b32 v89, 0xffff0000, v88
    v_lshlrev_b32 v88, 16, v88
    v_and_b32 v91, 0xffff0000, v90
    v_lshlrev_b32 v90, 16, v90
    v_and_b32 v93, 0xffff0000, v92
    v_lshlrev_b32 v92, 16, v92
    v_and_b32 v95, 0xffff0000, v94
    v_lshlrev_b32 v94, 16, v94
    v_mul_f32 v96, 0xbfb8aa3b, v80
    v_mul_f32 v97, 0xbfb8aa3b, v81
    v_mul_f32 v98, 0xbfb8aa3b, v82
    v_mul_f32 v99, 0xbfb8aa3b, v83
    v_mul_f32 v100, 0xbfb8aa3b, v84
    v_mul_f32 v101, 0xbfb8aa3b, v85
    v_mul_f32 v102, 0xbfb8aa3b, v86
    v_mul_f32 v103, 0xbfb8aa3b, v87
    v_mul_f32 v104, 0xbfb8aa3b, v88
    v_mul_f32 v105, 0xbfb8aa3b, v89
    v_mul_f32 v106, 0xbfb8aa3b, v90
    v_mul_f32 v107, 0xbfb8aa3b, v91
    v_mul_f32 v108, 0xbfb8aa3b, v92
    v_mul_f32 v109, 0xbfb8aa3b, v93
    v_mul_f32 v110, 0xbfb8aa3b, v94
    v_mul_f32 v111, 0xbfb8aa3b, v95
    v_exp_f32 v96, v96
    v_exp_f32 v97, v97
    v_exp_f32 v98, v98
    v_exp_f32 v99, v99
    v_exp_f32 v100, v100
    v_exp_f32 v101, v101
    v_exp_f32 v102, v102
    v_exp_f32 v103, v103
    v_exp_f32 v104, v104
    v_exp_f32 v105, v105
    v_exp_f32 v106, v106
    v_exp_f32 v107, v107
    v_exp_f32 v108, v108
    v_exp_f32 v109, v109
    v_exp_f32 v110, v110
    v_exp_f32 v111, v111
    v_add_f32 v96, 1.0, v96
    v_add_f32 v97, 1.0, v97
    v_add_f32 v98, 1.0, v98
    v_add_f32 v99, 1.0, v99
    v_add_f32 v100, 1.0, v100
    v_add_f32 v101, 1.0, v101
    v_add_f32 v102, 1.0, v102
    v_add_f32 v103, 1.0, v103
    v_add_f32 v104, 1.0, v104
    v_add_f32 v105, 1.0, v105
    v_add_f32 v106, 1.0, v106
    v_add_f32 v107, 1.0, v107
    v_add_f32 v108, 1.0, v108
    v_add_f32 v109, 1.0, v109
    v_add_f32 v110, 1.0, v110
    v_add_f32 v111, 1.0, v111
    v_rcp_f32 v96, v96
    v_rcp_f32 v97, v97
    v_rcp_f32 v98, v98
    v_rcp_f32 v99, v99
    v_rcp_f32 v100, v100
    v_rcp_f32 v101, v101
    v_rcp_f32 v102, v102
    v_rcp_f32 v103, v103
    v_rcp_f32 v104, v104
    v_rcp_f32 v105, v105
    v_rcp_f32 v106, v106
    v_rcp_f32 v107, v107
    v_rcp_f32 v108, v108
    v_rcp_f32 v109, v109
    v_rcp_f32 v110, v110
    v_rcp_f32 v111, v111
    v_mul_f32 v80, v80, v96
    v_mul_f32 v81, v81, v97
    v_mul_f32 v82, v82, v98
    v_mul_f32 v83, v83, v99
    v_mul_f32 v84, v84, v100
    v_mul_f32 v85, v85, v101
    v_mul_f32 v86, v86, v102
    v_mul_f32 v87, v87, v103
    v_mul_f32 v88, v88, v104
    v_mul_f32 v89, v89, v105
    v_mul_f32 v90, v90, v106
    v_mul_f32 v91, v91, v107
    v_mul_f32 v92, v92, v108
    v_mul_f32 v93, v93, v109
    v_mul_f32 v94, v94, v110
    v_mul_f32 v95, v95, v111
    v_cvt_pk_bf16_f32 v208, v80, v81
    v_cvt_pk_bf16_f32 v209, v82, v83
    v_cvt_pk_bf16_f32 v210, v84, v85
    v_cvt_pk_bf16_f32 v211, v86, v87
    v_cvt_pk_bf16_f32 v212, v88, v89
    v_cvt_pk_bf16_f32 v213, v90, v91
    v_cvt_pk_bf16_f32 v214, v92, v93
    v_cvt_pk_bf16_f32 v215, v94, v95
    v_mov_b32 v67, 131584
    v_mov_b32 v194, s70
    v_bfe_u32 v192, v252, 4, 3
    v_lshlrev_b32 v192, 2, v192
    v_mov_b32 v233, 0x30003
    s_branch L_io13
    .p2align 12
L_iw13:
    s_branch L_iwr1
L_io13:
    v_add_u32 v228, 65536, v252
    v_add_u32 v195, 131072, v252
    s_lshl_b32 s27, s59, 3
    s_add_u32 s27, s27, s3
    s_lshl_b32 s27, s27, 12
    s_add_u32 s43, s59, 1
    s_and_b32 s43, s43, 3
    s_lshl_b32 s76, s43, 18
    s_add_u32 s76, s76, s27
    s_add_u32 s43, s59, 2
    s_and_b32 s43, s43, 3
    s_lshl_b32 s77, s43, 18
    s_add_u32 s77, s77, s27
    s_add_u32 s43, s59, 3
    s_and_b32 s43, s43, 3
    s_lshl_b32 s78, s43, 18
    s_add_u32 s78, s78, s27
    s_add_u32 s43, s59, 4
    s_and_b32 s43, s43, 3
    s_lshl_b32 s79, s43, 18
    s_add_u32 s79, s79, s27
    s_lshl_b32 s27, s3, 13
    s_lshl_b32 s42, s72, 20
    s_add_u32 s4, s52, s42
    s_addc_u32 s5, s53, 0
    s_mov_b32 s6, 1048576
    s_mov_b32 s7, 0x20000
    s_lshl_b32 s42, s36, 9
    s_lshr_b32 s43, s35, 3
    s_lshl_b32 s43, s43, 7
    s_add_u32 s42, s42, s43
    s_and_b32 s43, s35, 7
    s_lshl_b32 s43, s43, 2
    s_add_u32 s43, s43, s42
    s_add_u32 s43, s43, 17301504
    s_cmp_eq_u32 s3, 0
    s_cselect_b32 s58, s43, 1073741824
    s_lshr_b32 s42, s72, 1
    s_lshl_b32 s42, s42, 9
    s_lshl_b32 s43, s59, 7
    s_add_u32 s42, s42, s43
    s_add_u32 s25, s42, 17301504
    s_lshl_b32 s42, s72, 2
    s_add_u32 s42, s42, s73
    s_lshl_b32 s42, s42, 2
    s_lshr_b32 s43, s76, 18
    s_add_u32 s43, s43, s42
    s_mul_i32 s16, s43, 49152
    s_add_u32 s16, s16, s24
    s_add_u32 s16, s16, 20971520
    s_lshr_b32 s43, s77, 18
    s_add_u32 s43, s43, s42
    s_mul_i32 s17, s43, 49152
    s_add_u32 s17, s17, s24
    s_add_u32 s17, s17, 20987904
    s_lshr_b32 s43, s78, 18
    s_add_u32 s43, s43, s42
    s_mul_i32 s18, s43, 49152
    s_add_u32 s18, s18, s24
    s_add_u32 s18, s18, 21004288
    s_lshr_b32 s43, s79, 18
    s_add_u32 s43, s43, s42
    s_mul_i32 s19, s43, 49152
    s_add_u32 s19, s19, s24
    s_add_u32 s19, s19, 20971520
    s_waitcnt vmcnt(0) lgkmcnt(0)
    s_barrier
    ds_read_b128 v[68:71], v67
    s_waitcnt lgkmcnt(0)
    v_or3_b32 v68, v68, v69, v70
    v_or_b32 v68, v68, v71
    s_nop 0
    v_readfirstlane_b32 s43, v68
    s_nop 0
    s_cmp_lg_u32 s43, 0
    s_cbranch_scc1 L_fail
    buffer_store_dword v194, v255, s[20:23], s58 offen sc1
    s_and_b32 s48, s2, 7
    s_lshl_b32 s48, s48, 11
    s_lshl_b32 s49, s3, 9
    s_add_u32 s48, s48, s49
    s_add_u32 s47, s48, 16809984
    s_lshl_b32 s48, s3, 8
    s_add_u32 s48, s48, s75
    s_lshl_b32 s48, s48, 2
    s_add_u32 s45, s48, 16801792
    s_cmp_lt_u32 s75, 172
    s_cselect_b32 s47, s47, 1073741824
    s_cselect_b32 s45, s45, 1073741824
    s_mov_b32 m0, s29
    s_nop 0
    buffer_load_dwordx4 v240, s[8:11], s33 offen offset:0  lds
    v_lshrrev_b32 v82, 4, v252
    v_lshrrev_b32 v83, 4, v82
    v_lshlrev_b32 v83, 3, v83
    v_bfe_u32 v84, v82, 2, 2
    v_add_u32 v83, v83, v84
    v_lshlrev_b32 v83, 4, v83
    v_and_b32 v84, 1, v82
    v_lshlrev_b32 v84, 3, v84
    v_add_u32 v83, v83, v84
    v_bfe_u32 v84, v82, 1, 1
    v_lshlrev_b32 v84, 13, v84
    buffer_load_dwordx4 v240, s[8:11], s33 offen offset:1024  lds
    v_add_u32 v83, v83, v84
    v_add_u32 v83, 133120, v83
    v_lshlrev_b32 v249, 16, v248
    v_and_b32 v248, 0xffff0000, v248
    v_rcp_f32 v249, v249
    v_lshlrev_b32 v64, 16, v244
    v_and_b32 v65, 0xffff0000, v244
    ds_read_b64_tr_b16 a[64:65], v83 offset:0
    v_lshlrev_b32 v66, 16, v245
    v_and_b32 v67, 0xffff0000, v245
    ds_read_b64_tr_b16 a[66:67], v83 offset:64
    buffer_load_dwordx4 v232, s[8:11], s33 offen offset:2048  lds
    v_lshlrev_b32 v68, 16, v246
    v_and_b32 v69, 0xffff0000, v246
    ds_read_b64_tr_b16 a[68:69], v83 offset:512
    v_lshlrev_b32 v70, 16, v247
    v_and_b32 v71, 0xffff0000, v247
    ds_read_b64_tr_b16 a[70:71], v83 offset:576
    v_lshlrev_b32 v72, 16, v250
    v_and_b32 v73, 0xffff0000, v250
    ds_read_b64_tr_b16 a[72:73], v83 offset:1024
    v_lshlrev_b32 v74, 16, v251
    v_and_b32 v75, 0xffff0000, v251
    buffer_load_dwordx4 v232, s[8:11], s33 offen offset:3072  lds
    ds_read_b64_tr_b16 a[74:75], v83 offset:1088
    v_sub_f32 v64, v64, v248
    v_sub_f32 v65, v65, v248
    ds_read_b64_tr_b16 a[76:77], v83 offset:1536
    v_sub_f32 v66, v66, v248
    v_sub_f32 v67, v67, v248
    ds_read_b64_tr_b16 a[78:79], v83 offset:1600
    v_sub_f32 v68, v68, v248
    v_sub_f32 v69, v69, v248
    ds_read_b64_tr_b16 a[80:81], v83 offset:2048
    v_sub_f32 v70, v70, v248
    s_add_u32 s33, s33, 65536
    s_mov_b32 m0, s30
    s_nop 0
    buffer_load_dwordx4 v240, s[8:11], s33 offen offset:0  lds
    v_sub_f32 v71, v71, v248
    ds_read_b64_tr_b16 a[82:83], v83 offset:2112
    v_sub_f32 v72, v72, v248
    v_sub_f32 v73, v73, v248
    ds_read_b64_tr_b16 a[84:85], v83 offset:2560
    v_sub_f32 v74, v74, v248
    v_sub_f32 v75, v75, v248
    ds_read_b64_tr_b16 a[86:87], v83 offset:2624
    v_cvt_pk_bf16_f32 v64, v64, v65
    v_cvt_pk_bf16_f32 v66, v66, v67
    ds_read_b64_tr_b16 a[88:89], v83 offset:3072
    buffer_load_dwordx4 v240, s[8:11], s33 offen offset:1024  lds
    v_cvt_pk_bf16_f32 v68, v68, v69
    v_cvt_pk_bf16_f32 v70, v70, v71
    ds_read_b64_tr_b16 a[90:91], v83 offset:3136
    v_cvt_pk_bf16_f32 v72, v72, v73
    v_cvt_pk_bf16_f32 v74, v74, v75
    ds_read_b64_tr_b16 a[92:93], v83 offset:3584
    v_and_b32 v65, 0xffff0000, v64
    v_lshlrev_b32 v64, 16, v64
    ds_read_b64_tr_b16 a[94:95], v83 offset:3648
    v_and_b32 v67, 0xffff0000, v66
    buffer_load_dwordx4 v232, s[8:11], s33 offen offset:2048  lds
    v_lshlrev_b32 v66, 16, v66
    v_and_b32 v69, 0xffff0000, v68
    v_lshlrev_b32 v68, 16, v68
    v_and_b32 v71, 0xffff0000, v70
    v_lshlrev_b32 v70, 16, v70
    v_and_b32 v73, 0xffff0000, v72
    v_lshlrev_b32 v72, 16, v72
    v_and_b32 v75, 0xffff0000, v74
    v_lshlrev_b32 v74, 16, v74
    v_mul_f32 v64, v64, v249
    v_mul_f32 v65, v65, v249
    buffer_load_dwordx4 v232, s[8:11], s33 offen offset:3072  lds
    v_mul_f32 v66, v66, v249
    v_mul_f32 v67, v67, v249
    v_mul_f32 v68, v68, v249
    v_mul_f32 v69, v69, v249
    v_mul_f32 v70, v70, v249
    v_mul_f32 v71, v71, v249
    v_mul_f32 v72, v72, v249
    v_mul_f32 v73, v73, v249
    v_mul_f32 v74, v74, v249
    v_mul_f32 v75, v75, v249
    v_cvt_pk_bf16_f32 v76, v64, v65
    buffer_load_dword v193, v192, s[20:23], s25 offen sc1
    v_cvt_pk_bf16_f32 v77, v66, v67
    v_cvt_pk_bf16_f32 v78, v68, v69
    v_cvt_pk_bf16_f32 v79, v70, v71
    v_mov_b32 v85, s24
    v_lshrrev_b32 v85, 2, v85
    v_add_u32 v85, 157696, v85
    v_add_u32 v80, v85, v252
    ds_write_b128 v80, v[76:79]
    v_lshrrev_b32 v81, 8, v252
    v_lshlrev_b32 v81, 4, v81
    v_add_u32 v81, v85, v81
    s_add_u32 s33, s33, 65536
    s_mov_b32 m0, s28
    s_nop 0
    buffer_load_dwordx4 v240, s[8:11], s33 offen offset:0  lds
    ds_read_b128 a[96:99], v81 offset:0
    ds_read_b128 a[100:103], v81 offset:64
    ds_read_b128 a[104:107], v81 offset:128
    ds_read_b128 a[108:111], v81 offset:192
    ds_read_b128 a[112:115], v81 offset:256
    ds_read_b128 a[116:119], v81 offset:320
    ds_read_b128 a[120:123], v81 offset:384
    ds_read_b128 a[124:127], v81 offset:448
    v_cvt_pk_bf16_f32 v72, v72, v73
    v_cvt_pk_bf16_f32 v74, v74, v75
    v_lshlrev_b32 v216, 16, v72
    buffer_load_dwordx4 v240, s[8:11], s33 offen offset:1024  lds
    v_and_b32 v217, 0xffff0000, v72
    v_lshlrev_b32 v218, 16, v74
    v_and_b32 v219, 0xffff0000, v74
    v_lshlrev_b32 v82, 1, v82
    v_mov_b32 v85, s24
    v_lshrrev_b32 v85, 4, v85
    v_add_u32 v85, 149504, v85
    v_add_u32 v82, v85, v82
    v_mov_b32 v104, 0
    v_mov_b32 v105, 0
    v_mov_b32 v106, 0
    buffer_load_dwordx4 v232, s[8:11], s33 offen offset:2048  lds
    v_mov_b32 v107, 0
    v_mov_b32 v108, 0
    v_mov_b32 v109, 0
    v_mov_b32 v110, 0
    v_mov_b32 v111, 0
    v_mov_b32 v112, 0
    v_mov_b32 v113, 0
    v_mov_b32 v114, 0
    v_mov_b32 v115, 0
    v_mov_b32 v116, 0
    buffer_load_dwordx4 v232, s[8:11], s33 offen offset:3072  lds
    v_mov_b32 v117, 0
    v_mov_b32 v118, 0
    v_mov_b32 v119, 0
    ds_read_u16_d16_hi v104, v82 offset:0
    ds_read_u16_d16_hi v105, v82 offset:128
    ds_read_u16_d16_hi v106, v82 offset:1024
    ds_read_u16_d16_hi v107, v82 offset:1152
    ds_read_u16_d16_hi v108, v82 offset:2048
    ds_read_u16_d16_hi v109, v82 offset:2176
    ds_read_u16_d16_hi v110, v82 offset:3072
    ds_read_u16_d16_hi v111, v82 offset:3200
    s_add_u32 s33, s33, 65536
    s_mov_b32 m0, s31
    s_nop 0
    buffer_load_dwordx4 v240, s[8:11], s33 offen offset:0  lds
    ds_read_u16_d16_hi v112, v82 offset:4096
    ds_read_u16_d16_hi v113, v82 offset:4224
    ds_read_u16_d16_hi v114, v82 offset:5120
    ds_read_u16_d16_hi v115, v82 offset:5248
    ds_read_u16_d16_hi v116, v82 offset:6144
    ds_read_u16_d16_hi v117, v82 offset:6272
    ds_read_u16_d16_hi v118, v82 offset:7168
    ds_read_u16_d16_hi v119, v82 offset:7296
    v_lshrrev_b32 v94, 2, v252
    s_waitcnt lgkmcnt(15)
    v_mfma_f32_16x16x32_bf16 v[84:87], a[64:67], a[96:99], 0
    buffer_load_dwordx4 v240, s[8:11], s33 offen offset:1024  lds
    v_mfma_f32_16x16x32_bf16 v[88:91], a[68:71], a[100:103], 0
    ds_read_b64_tr_b16 a[64:65], v83 offset:4096
    ds_read_b64_tr_b16 a[66:67], v83 offset:4160
    ds_read_b128 a[96:99], v81 offset:512
    v_mfma_f32_16x16x32_bf16 v[84:87], a[72:75], a[104:107], v[84:87]
    ds_read_b64_tr_b16 a[68:69], v83 offset:4608
    ds_read_b64_tr_b16 a[70:71], v83 offset:4672
    ds_read_b128 a[100:103], v81 offset:576
    v_mfma_f32_16x16x32_bf16 v[88:91], a[76:79], a[108:111], v[88:91]
    ds_read_b64_tr_b16 a[72:73], v83 offset:5120
    ds_read_b64_tr_b16 a[74:75], v83 offset:5184
    buffer_load_dwordx4 v232, s[8:11], s33 offen offset:2048  lds
    ds_read_b128 a[104:107], v81 offset:640
    v_mfma_f32_16x16x32_bf16 v[84:87], a[80:83], a[112:115], v[84:87]
    ds_read_b64_tr_b16 a[76:77], v83 offset:5632
    ds_read_b64_tr_b16 a[78:79], v83 offset:5696
    ds_read_b128 a[108:111], v81 offset:704
    v_mfma_f32_16x16x32_bf16 v[88:91], a[84:87], a[116:119], v[88:91]
    ds_read_b64_tr_b16 a[80:81], v83 offset:6144
    ds_read_b64_tr_b16 a[82:83], v83 offset:6208
    ds_read_b128 a[112:115], v81 offset:768
    v_mfma_f32_16x16x32_bf16 v[84:87], a[88:91], a[120:123], v[84:87]
    ds_read_b64_tr_b16 a[84:85], v83 offset:6656
    buffer_load_dwordx4 v232, s[8:11], s33 offen offset:3072  lds
    ds_read_b64_tr_b16 a[86:87], v83 offset:6720
    ds_read_b128 a[116:119], v81 offset:832
    v_mfma_f32_16x16x32_bf16 v[88:91], a[92:95], a[124:127], v[88:91]
    ds_read_b64_tr_b16 a[88:89], v83 offset:7168
    ds_read_b64_tr_b16 a[90:91], v83 offset:7232
    ds_read_b128 a[120:123], v81 offset:896
    s_nop 1
    ds_read_b64_tr_b16 a[92:93], v83 offset:7680
    ds_read_b64_tr_b16 a[94:95], v83 offset:7744
    ds_read_b128 a[124:127], v81 offset:960
    s_add_u32 s33, s33, 65536
    s_cmp_eq_u32 s3, 0
    s_cbranch_scc1 L_iw14
    s_cmp_eq_u32 s3, 1
    s_cbranch_scc1 L_iw15
    s_cmp_eq_u32 s3, 2
    s_cbranch_scc1 L_iw16
    s_branch L_iw17
L_iwr9:
L_iwstop:
    s_waitcnt vmcnt(8)
    v_cmp_ne_u32 vcc, s70, v193
    s_cbranch_vccnz L_poll_slow
L_poll_ok:
    s_add_u32 m0, s27, 0
    s_add_u32 s42, s76, 0
    buffer_load_dwordx4 v252, s[4:7], s42 offen offset:0 sc1 lds
    buffer_load_dwordx4 v252, s[4:7], s42 offen offset:1024 sc1 lds
    buffer_load_dwordx4 v252, s[4:7], s42 offen offset:2048 sc1 lds
    buffer_load_dwordx4 v252, s[4:7], s42 offen offset:3072 sc1 lds
    s_add_u32 m0, s27, 4096
    s_add_u32 s43, s76, 131072
    buffer_load_dwordx4 v252, s[4:7], s43 offen offset:0 sc1 lds
    s_waitcnt lgkmcnt(0)
    v_mfma_f32_16x16x32_bf16 v[84:87], a[64:67], a[96:99], v[84:87]
    v_mfma_f32_16x16x32_bf16 v[88:91], a[68:71], a[100:103], v[88:91]
    v_mfma_f32_16x16x32_bf16 v[84:87], a[72:75], a[104:107], v[84:87]
    v_mfma_f32_16x16x32_bf16 v[88:91], a[76:79], a[108:111], v[88:91]
    v_mfma_f32_16x16x32_bf16 v[84:87], a[80:83], a[112:115], v[84:87]
    v_mfma_f32_16x16x32_bf16 v[88:91], a[84:87], a[116:119], v[88:91]
    v_mfma_f32_16x16x32_bf16 v[84:87], a[88:91], a[120:123], v[84:87]
    buffer_load_dwordx4 v252, s[4:7], s43 offen offset:1024 sc1 lds
    v_mfma_f32_16x16x32_bf16 v[88:91], a[92:95], a[124:127], v[88:91]
    s_nop 8
    v_add_f32 v84, v84, v88
    v_add_f32 v85, v85, v89
    v_add_f32 v86, v86, v90
    v_add_f32 v87, v87, v91
    v_cvt_pk_bf16_f32 v84, v84, v85
    v_cvt_pk_bf16_f32 v86, v86, v87
    v_and_b32 v85, 0xffff0000, v84
    buffer_load_dwordx4 v252, s[4:7], s43 offen offset:2048 sc1 lds
    v_lshlrev_b32 v84, 16, v84
    v_and_b32 v87, 0xffff0000, v86
    v_lshlrev_b32 v86, 16, v86
    v_mov_b32 v88, v84
    v_mov_b32 v89, v85
    v_mov_b32 v90, v86
    v_mov_b32 v91, v87
    v_permlane32_swap_b32 v84, v88
    buffer_load_dwordx4 v252, s[4:7], s43 offen offset:3072 sc1 lds
    v_permlane32_swap_b32 v85, v89
    v_permlane32_swap_b32 v86, v90
    v_permlane32_swap_b32 v87, v91
    v_mul_f32 v96, 0xbfb8aa3b, v84
    v_mul_f32 v97, 0xbfb8aa3b, v85
    v_mul_f32 v98, 0xbfb8aa3b, v86
    v_mul_f32 v99, 0xbfb8aa3b, v87
    v_exp_f32 v96, v96
    s_add_u32 m0, s27, 32768
    s_add_u32 s42, s76, 16384
    buffer_load_dwordx4 v252, s[4:7], s42 offen offset:0 sc1 lds
    v_exp_f32 v97, v97
    v_exp_f32 v98, v98
    v_exp_f32 v99, v99
    v_add_f32 v96, 1.0, v96
    v_add_f32 v97, 1.0, v97
    v_add_f32 v98, 1.0, v98
    v_add_f32 v99, 1.0, v99
    v_rcp_f32 v96, v96
    buffer_load_dwordx4 v252, s[4:7], s42 offen offset:1024 sc1 lds
    v_rcp_f32 v97, v97
    v_rcp_f32 v98, v98
    v_rcp_f32 v99, v99
    v_mul_f32 v84, v84, v96
    v_mul_f32 v85, v85, v97
    v_mul_f32 v86, v86, v98
    v_mul_f32 v87, v87, v99
    v_cvt_pk_bf16_f32 v84, v84, v85
    buffer_load_dwordx4 v252, s[4:7], s42 offen offset:2048 sc1 lds
    v_cvt_pk_bf16_f32 v86, v86, v87
    v_and_b32 v85, 0xffff0000, v84
    v_lshlrev_b32 v84, 16, v84
    v_and_b32 v87, 0xffff0000, v86
    v_lshlrev_b32 v86, 16, v86
    v_mul_f32 v84, v84, v88
    v_mul_f32 v85, v85, v89
    v_mul_f32 v86, v86, v90
    buffer_load_dwordx4 v252, s[4:7], s42 offen offset:3072 sc1 lds
    v_mul_f32 v87, v87, v91
    v_cvt_pk_bf16_f32 v84, v84, v85
    v_cvt_pk_bf16_f32 v86, v86, v87
    v_and_b32 v85, 0xffff0000, v84
    v_lshlrev_b32 v84, 16, v84
    v_and_b32 v87, 0xffff0000, v86
    v_lshlrev_b32 v86, 16, v86
    v_readlane_b32 s80, v84, 0
    s_add_u32 m0, s27, 36864
    s_add_u32 s43, s76, 147456
    buffer_load_dwordx4 v252, s[4:7], s43 offen offset:0 sc1 lds
    v_readlane_b32 s81, v85, 0
    v_readlane_b32 s82, v86, 0
    v_readlane_b32 s83, v87, 0
    v_readlane_b32 s84, v84, 16
    v_readlane_b32 s85, v85, 16
    v_readlane_b32 s86, v86, 16
    v_readlane_b32 s87, v87, 16
    v_mul_f32 v92, s80, v104
    buffer_load_dwordx4 v252, s[4:7], s43 offen offset:1024 sc1 lds
    v_mul_f32 v93, s80, v105
    v_fmac_f32 v92, s81, v106
    v_fmac_f32 v93, s81, v107
    v_fmac_f32 v92, s82, v108
    v_fmac_f32 v93, s82, v109
    v_fmac_f32 v92, s83, v110
    v_fmac_f32 v93, s83, v111
    v_fmac_f32 v92, s84, v112
    buffer_load_dwordx4 v252, s[4:7], s43 offen offset:2048 sc1 lds
    v_fmac_f32 v93, s84, v113
    v_fmac_f32 v92, s85, v114
    v_fmac_f32 v93, s85, v115
    v_fmac_f32 v92, s86, v116
    v_fmac_f32 v93, s86, v117
    v_fmac_f32 v92, s87, v118
    v_fmac_f32 v93, s87, v119
    buffer_atomic_add_f32 v92, v94, s[20:23], s47 offen offset:0
    buffer_load_dwordx4 v252, s[4:7], s43 offen offset:3072 sc1 lds
    buffer_atomic_add_f32 v93, v94, s[20:23], s47 offen offset:256
    s_waitcnt vmcnt(10)
    s_barrier
    ds_read_b128 v[0:3], v252 offset:0
    ds_read_b128 v[4:7], v252 offset:1024
    ds_read_b128 v[8:11], v252 offset:2048
    ds_read_b128 v[12:15], v252 offset:3072
    ds_read_b128 v[16:19], v252 offset:4096
    ds_read_b128 v[20:23], v252 offset:5120
    ds_read_b128 v[24:27], v252 offset:6144
    ds_read_b128 v[28:31], v252 offset:7168
    s_lshr_b32 s42, s55, 5
    s_lshr_b32 s43, s37, 5
    s_cmp_eq_u32 s42, s43
    s_cselect_b32 s80, -1, 0
    s_cselect_b32 s81, 0x7ff, 0
    s_waitcnt lgkmcnt(4)
    v_mfma_f32_16x16x32_bf16 v[64:67], v[128:131], v[0:3], 0
    ds_read_b128 v[32:35], v252 offset:8192
    ds_read_b64_tr_b16 a[0:1], v229 offset:16384
    v_mfma_f32_16x16x32_bf16 v[64:67], v[136:139], v[4:7], v[64:67]
    s_add_u32 m0, s27, 131072
    s_add_u32 s42, s77, 0
    buffer_load_dwordx4 v252, s[4:7], s42 offen offset:0 sc1 lds
    v_mfma_f32_16x16x32_bf16 v[64:67], v[144:147], v[8:11], v[64:67]
    ds_read_b128 v[36:39], v252 offset:9216
    ds_read_b64_tr_b16 a[2:3], v229 offset:20480
    s_branch L_io14
    .p2align 12
L_iw14:
    s_branch L_iw18
L_io14:
    v_mfma_f32_16x16x32_bf16 v[64:67], v[152:155], v[12:15], v[64:67]
    ds_read_b64_tr_b16 a[4:5], v229 offset:16392
    v_mfma_f32_16x16x32_bf16 v[68:71], v[132:135], v[0:3], 0
    ds_read_b128 v[40:43], v252 offset:10240
    ds_read_b64_tr_b16 a[6:7], v229 offset:20488
    v_mfma_f32_16x16x32_bf16 v[68:71], v[140:143], v[4:7], v[68:71]
    ds_read_b64_tr_b16 a[8:9], v229 offset:24576
    v_mfma_f32_16x16x32_bf16 v[68:71], v[148:151], v[8:11], v[68:71]
    ds_read_b128 v[44:47], v252 offset:11264
    v_mfma_f32_16x16x32_bf16 v[68:71], v[156:159], v[12:15], v[68:71]
    s_waitcnt lgkmcnt(9)
    buffer_load_dwordx4 v252, s[4:7], s42 offen offset:1024 sc1 lds
    v_mfma_f32_16x16x32_bf16 v[72:75], v[128:131], v[16:19], 0
    ds_read_b128 v[0:3], v252 offset:12288
    ds_read_b64_tr_b16 a[10:11], v229 offset:28672
    v_mfma_f32_16x16x32_bf16 v[72:75], v[136:139], v[20:23], v[72:75]
    ds_read_b64_tr_b16 a[12:13], v229 offset:24584
    v_mfma_f32_16x16x32_bf16 v[72:75], v[144:147], v[24:27], v[72:75]
    ds_read_b128 v[4:7], v252 offset:13312
    ds_read_b64_tr_b16 a[14:15], v229 offset:28680
    v_mfma_f32_16x16x32_bf16 v[72:75], v[152:155], v[28:31], v[72:75]
    ds_read_b64_tr_b16 a[16:17], v229 offset:32768
    v_mfma_f32_16x16x32_bf16 v[76:79], v[132:135], v[16:19], 0
    ds_read_b128 v[8:11], v252 offset:14336
    v_mfma_f32_16x16x32_bf16 v[76:79], v[140:143], v[20:23], v[76:79]
    buffer_load_dwordx4 v252, s[4:7], s42 offen offset:2048 sc1 lds
    v_mfma_f32_16x16x32_bf16 v[76:79], v[148:151], v[24:27], v[76:79]
    ds_read_b128 v[12:15], v252 offset:15360
    ds_read_b64_tr_b16 a[18:19], v229 offset:36864
    v_mfma_f32_16x16x32_bf16 v[76:79], v[156:159], v[28:31], v[76:79]
    s_waitcnt lgkmcnt(9)
    ds_read_b64_tr_b16 a[20:21], v229 offset:32776
    ds_read_b64_tr_b16 a[22:23], v229 offset:36872
    v_mfma_f32_16x16x32_bf16 v[64:67], v[160:163], v[32:35], v[64:67]
    ds_read_b128 v[16:19], v252 offset:16384
    v_mfma_f32_16x16x32_bf16 v[64:67], v[168:171], v[36:39], v[64:67]
    buffer_load_dwordx4 v252, s[4:7], s42 offen offset:3072 sc1 lds
    v_mfma_f32_16x16x32_bf16 v[64:67], v[176:179], v[40:43], v[64:67]
    ds_read_b128 v[20:23], v252 offset:17408
    ds_read_b64_tr_b16 a[24:25], v229 offset:40960
    v_mfma_f32_16x16x32_bf16 v[64:67], v[184:187], v[44:47], v[64:67]
    ds_read_b64_tr_b16 a[26:27], v229 offset:45056
    v_mfma_f32_16x16x32_bf16 v[68:71], v[164:167], v[32:35], v[68:71]
    ds_read_b128 v[24:27], v252 offset:18432
    ds_read_b64_tr_b16 a[28:29], v229 offset:40968
    v_mfma_f32_16x16x32_bf16 v[68:71], v[172:175], v[36:39], v[68:71]
    ds_read_b64_tr_b16 a[30:31], v229 offset:45064
    v_mfma_f32_16x16x32_bf16 v[68:71], v[180:183], v[40:43], v[68:71]
    ds_read_b128 v[28:31], v252 offset:19456
    s_add_u32 m0, s27, 135168
    s_add_u32 s43, s77, 131072
    v_mfma_f32_16x16x32_bf16 v[68:71], v[188:191], v[44:47], v[68:71]
    s_waitcnt lgkmcnt(11)
    buffer_load_dwordx4 v252, s[4:7], s43 offen offset:0 sc1 lds
    v_mfma_f32_16x16x32_bf16 v[72:75], v[160:163], v[0:3], v[72:75]
    ds_read_b128 v[32:35], v252 offset:20480
    ds_read_b64_tr_b16 a[32:33], v229 offset:0
    v_mfma_f32_16x16x32_bf16 v[72:75], v[168:171], v[4:7], v[72:75]
    ds_read_b64_tr_b16 a[34:35], v229 offset:4096
    v_mfma_f32_16x16x32_bf16 v[72:75], v[176:179], v[8:11], v[72:75]
    ds_read_b128 v[36:39], v252 offset:21504
    ds_read_b64_tr_b16 a[36:37], v229 offset:8
    v_mfma_f32_16x16x32_bf16 v[72:75], v[184:187], v[12:15], v[72:75]
    ds_read_b64_tr_b16 a[38:39], v229 offset:4104
    v_mfma_f32_16x16x32_bf16 v[76:79], v[164:167], v[0:3], v[76:79]
    ds_read_b128 v[40:43], v252 offset:22528
    v_mfma_f32_16x16x32_bf16 v[76:79], v[172:175], v[4:7], v[76:79]
    buffer_load_dwordx4 v252, s[4:7], s43 offen offset:1024 sc1 lds
    v_mfma_f32_16x16x32_bf16 v[76:79], v[180:183], v[8:11], v[76:79]
    ds_read_b128 v[44:47], v252 offset:23552
    ds_read_b64_tr_b16 a[40:41], v229 offset:8192
    v_mfma_f32_16x16x32_bf16 v[76:79], v[188:191], v[12:15], v[76:79]
    s_waitcnt lgkmcnt(9)
    ds_read_b64_tr_b16 a[42:43], v229 offset:12288
    ds_read_b64_tr_b16 a[44:45], v229 offset:8200
    v_mfma_f32_16x16x32_bf16 v[64:67], a[192:195], v[16:19], v[64:67]
    ds_read_b128 v[0:3], v252 offset:24576
    v_mfma_f32_16x16x32_bf16 v[64:67], a[200:203], v[20:23], v[64:67]
    ds_read_b64_tr_b16 a[46:47], v229 offset:12296
    v_mfma_f32_16x16x32_bf16 v[64:67], a[208:211], v[24:27], v[64:67]
    ds_read_b128 v[4:7], v252 offset:25600
    ds_read_b64_tr_b16 a[48:49], v229 offset:49152
    v_mfma_f32_16x16x32_bf16 v[64:67], a[216:219], v[28:31], v[64:67]
    buffer_load_dwordx4 v252, s[4:7], s43 offen offset:2048 sc1 lds
    v_mfma_f32_16x16x32_bf16 v[68:71], a[196:199], v[16:19], v[68:71]
    ds_read_b128 v[8:11], v252 offset:26624
    ds_read_b64_tr_b16 a[50:51], v229 offset:53248
    v_mfma_f32_16x16x32_bf16 v[68:71], a[204:207], v[20:23], v[68:71]
    ds_read_b64_tr_b16 a[52:53], v229 offset:49160
    v_mfma_f32_16x16x32_bf16 v[68:71], a[212:215], v[24:27], v[68:71]
    ds_read_b128 v[12:15], v252 offset:27648
    v_mfma_f32_16x16x32_bf16 v[68:71], a[220:223], v[28:31], v[68:71]
    s_waitcnt lgkmcnt(11)
    buffer_load_dwordx4 v252, s[4:7], s43 offen offset:3072 sc1 lds
    v_mfma_f32_16x16x32_bf16 v[72:75], a[192:195], v[32:35], v[72:75]
    ds_read_b128 v[16:19], v252 offset:28672
    ds_read_b64_tr_b16 a[54:55], v229 offset:53256
    v_mfma_f32_16x16x32_bf16 v[72:75], a[200:203], v[36:39], v[72:75]
    ds_read_b64_tr_b16 a[56:57], v229 offset:57344
    v_mfma_f32_16x16x32_bf16 v[72:75], a[208:211], v[40:43], v[72:75]
    ds_read_b128 v[20:23], v252 offset:29696
    ds_read_b64_tr_b16 a[58:59], v229 offset:61440
    v_mfma_f32_16x16x32_bf16 v[72:75], a[216:219], v[44:47], v[72:75]
    ds_read_b64_tr_b16 a[60:61], v229 offset:57352
    v_mfma_f32_16x16x32_bf16 v[76:79], a[196:199], v[32:35], v[76:79]
    ds_read_b128 v[24:27], v252 offset:30720
    ds_read_b64_tr_b16 a[62:63], v229 offset:61448
    v_mfma_f32_16x16x32_bf16 v[76:79], a[204:207], v[36:39], v[76:79]
    v_mfma_f32_16x16x32_bf16 v[76:79], a[212:215], v[40:43], v[76:79]
    ds_read_b128 v[28:31], v252 offset:31744
    v_mfma_f32_16x16x32_bf16 v[76:79], a[220:223], v[44:47], v[76:79]
    s_waitcnt lgkmcnt(9)
    v_mfma_f32_16x16x32_bf16 v[64:67], a[224:227], v[0:3], v[64:67]
    s_waitcnt vmcnt(9) lgkmcnt(0)
    s_barrier
    ds_read_b128 v[32:35], v252 offset:32768
    v_mfma_f32_16x16x32_bf16 v[64:67], a[232:235], v[4:7], v[64:67]
    s_add_u32 m0, s27, 65536
    s_add_u32 s42, s77, 16384
    buffer_load_dwordx4 v252, s[4:7], s42 offen offset:0 sc1 lds
    v_mfma_f32_16x16x32_bf16 v[64:67], a[240:243], v[8:11], v[64:67]
    ds_read_b128 v[36:39], v252 offset:33792
    s_add_u32 s13, s71, 1
    v_mfma_f32_16x16x32_bf16 v[64:67], a[248:251], v[12:15], v[64:67]
    s_and_b32 s13, s13, 15
    s_lshr_b32 s14, s70, 28
    v_mfma_f32_16x16x32_bf16 v[68:71], a[228:231], v[0:3], v[68:71]
    ds_read_b128 v[40:43], v252 offset:34816
    s_bfe_u32 s15, s70, 0x40018
    v_mfma_f32_16x16x32_bf16 v[68:71], a[236:239], v[4:7], v[68:71]
    s_mul_i32 s13, s13, 0x4001
    s_mul_i32 s14, s14, 0x4001
    v_mfma_f32_16x16x32_bf16 v[68:71], a[244:247], v[8:11], v[68:71]
    ds_read_b128 v[44:47], v252 offset:35840
    s_mul_i32 s15, s15, 0x4001
    v_mfma_f32_16x16x32_bf16 v[68:71], a[252:255], v[12:15], v[68:71]
    s_waitcnt lgkmcnt(4)
    buffer_load_dwordx4 v252, s[4:7], s42 offen offset:1024 sc1 lds
    v_mfma_f32_16x16x32_bf16 v[72:75], a[224:227], v[16:19], v[72:75]
    ds_read_b128 v[0:3], v252 offset:36864
    s_mov_b32 s44, 0xff
    v_mfma_f32_16x16x32_bf16 v[72:75], a[232:235], v[20:23], v[72:75]
    s_mov_b32 s50, 0x20002
    s_add_u32 s60, s19, 16384
    v_mfma_f32_16x16x32_bf16 v[72:75], a[240:243], v[24:27], v[72:75]
    ds_read_b128 v[4:7], v252 offset:37888
    s_add_u32 s61, s19, 32768
    v_mfma_f32_16x16x32_bf16 v[72:75], a[248:251], v[28:31], v[72:75]
    s_lshl_b32 s48, s73, 10
    s_add_u32 s46, s48, 16801792
    v_mfma_f32_16x16x32_bf16 v[76:79], a[228:231], v[16:19], v[76:79]
    ds_read_b128 v[8:11], v252 offset:38912
    s_lshl_b32 s48, s73, 9
    v_mfma_f32_16x16x32_bf16 v[76:79], a[236:239], v[20:23], v[76:79]
    buffer_load_dwordx4 v252, s[4:7], s42 offen offset:2048 sc1 lds
    v_mfma_f32_16x16x32_bf16 v[76:79], a[244:247], v[24:27], v[76:79]
    ds_read_b128 v[12:15], v252 offset:39936
    s_lshl_b32 s49, s3, 7
    v_mfma_f32_16x16x32_bf16 v[76:79], a[252:255], v[28:31], v[76:79]
    s_waitcnt lgkmcnt(4)
    s_add_u32 s48, s48, s49
    s_add_u32 s26, s48, 16809984
    v_mfma_f32_16x16x32_bf16 v[64:67], a[128:131], v[32:35], v[64:67]
    ds_read_b128 v[16:19], v252 offset:40960
    s_mov_b32 s8, s68
    v_mfma_f32_16x16x32_bf16 v[64:67], a[136:139], v[36:39], v[64:67]
    buffer_load_dwordx4 v252, s[4:7], s42 offen offset:3072 sc1 lds
    v_mfma_f32_16x16x32_bf16 v[64:67], a[144:147], v[40:43], v[64:67]
    ds_read_b128 v[20:23], v252 offset:41984
    s_mov_b32 s9, s69
    v_mfma_f32_16x16x32_bf16 v[64:67], a[152:155], v[44:47], v[64:67]
    s_mov_b32 s10, 2097152
    s_mov_b32 s11, 0x20000
    v_mfma_f32_16x16x32_bf16 v[68:71], a[132:135], v[32:35], v[68:71]
    ds_read_b128 v[24:27], v252 offset:43008
    v_mfma_f32_16x16x32_bf16 v[68:71], a[140:143], v[36:39], v[68:71]
    v_mfma_f32_16x16x32_bf16 v[68:71], a[148:151], v[40:43], v[68:71]
    ds_read_b128 v[28:31], v252 offset:44032
    s_add_u32 m0, s27, 69632
    s_add_u32 s43, s77, 147456
    v_mfma_f32_16x16x32_bf16 v[68:71], a[156:159], v[44:47], v[68:71]
    s_waitcnt lgkmcnt(4)
    buffer_load_dwordx4 v252, s[4:7], s43 offen offset:0 sc1 lds
    v_mfma_f32_16x16x32_bf16 v[72:75], a[128:131], v[0:3], v[72:75]
    ds_read_b128 v[32:35], v252 offset:45056
    v_mfma_f32_16x16x32_bf16 v[72:75], a[136:139], v[4:7], v[72:75]
    v_mfma_f32_16x16x32_bf16 v[72:75], a[144:147], v[8:11], v[72:75]
    ds_read_b128 v[36:39], v252 offset:46080
    v_mfma_f32_16x16x32_bf16 v[72:75], a[152:155], v[12:15], v[72:75]
    v_mfma_f32_16x16x32_bf16 v[76:79], a[132:135], v[0:3], v[76:79]
    ds_read_b128 v[40:43], v252 offset:47104
    v_mfma_f32_16x16x32_bf16 v[76:79], a[140:143], v[4:7], v[76:79]
    buffer_load_dwordx4 v252, s[4:7], s43 offen offset:1024 sc1 lds
    v_mfma_f32_16x16x32_bf16 v[76:79], a[148:151], v[8:11], v[76:79]
    ds_read_b128 v[44:47], v252 offset:48128
    v_mfma_f32_16x16x32_bf16 v[76:79], a[156:159], v[12:15], v[76:79]
    s_waitcnt lgkmcnt(4)
    v_mfma_f32_16x16x32_bf16 v[64:67], a[160:163], v[16:19], v[64:67]
    ds_read_b128 v[0:3], v252 offset:49152
    v_mfma_f32_16x16x32_bf16 v[64:67], a[168:171], v[20:23], v[64:67]
    v_mfma_f32_16x16x32_bf16 v[64:67], a[176:179], v[24:27], v[64:67]
    ds_read_b128 v[4:7], v252 offset:50176
    v_mfma_f32_16x16x32_bf16 v[64:67], a[184:187], v[28:31], v[64:67]
    buffer_load_dwordx4 v252, s[4:7], s43 offen offset:2048 sc1 lds
    v_mfma_f32_16x16x32_bf16 v[68:71], a[164:167], v[16:19], v[68:71]
    ds_read_b128 v[8:11], v252 offset:51200
    s_waitcnt vmcnt(15)
    v_mfma_f32_16x16x32_bf16 v[68:71], a[172:175], v[20:23], v[68:71]
    buffer_store_dword v194, v255, s[20:23], s45 offen sc1
    v_mfma_f32_16x16x32_bf16 v[68:71], a[180:183], v[24:27], v[68:71]
    ds_read_b128 v[12:15], v252 offset:52224
    v_mfma_f32_16x16x32_bf16 v[68:71], a[188:191], v[28:31], v[68:71]
    s_waitcnt lgkmcnt(4)
    buffer_load_dwordx4 v252, s[4:7], s43 offen offset:3072 sc1 lds
    v_mfma_f32_16x16x32_bf16 v[72:75], a[160:163], v[32:35], v[72:75]
    ds_read_b128 v[16:19], v252 offset:53248
    v_mfma_f32_16x16x32_bf16 v[72:75], a[168:171], v[36:39], v[72:75]
    v_mfma_f32_16x16x32_bf16 v[72:75], a[176:179], v[40:43], v[72:75]
    ds_read_b128 v[20:23], v252 offset:54272
    v_mfma_f32_16x16x32_bf16 v[72:75], a[184:187], v[44:47], v[72:75]
    v_mfma_f32_16x16x32_bf16 v[76:79], a[164:167], v[32:35], v[76:79]
    ds_read_b128 v[24:27], v252 offset:55296
    s_add_u32 m0, s27, 98304
    s_add_u32 s42, s78, 0
    v_mfma_f32_16x16x32_bf16 v[76:79], a[172:175], v[36:39], v[76:79]
    buffer_load_dwordx4 v252, s[4:7], s42 offen offset:0 sc1 lds
    v_mfma_f32_16x16x32_bf16 v[76:79], a[180:183], v[40:43], v[76:79]
    ds_read_b128 v[28:31], v252 offset:56320
    v_mfma_f32_16x16x32_bf16 v[76:79], a[188:191], v[44:47], v[76:79]
    s_waitcnt lgkmcnt(4)
    v_mfma_f32_16x16x32_bf16 v[64:67], a[0:3], v[0:3], v[64:67]
    ds_read_b128 v[32:35], v252 offset:57344
    v_mfma_f32_16x16x32_bf16 v[64:67], a[8:11], v[4:7], v[64:67]
    v_mfma_f32_16x16x32_bf16 v[64:67], a[16:19], v[8:11], v[64:67]
    ds_read_b128 v[36:39], v252 offset:58368
    v_mfma_f32_16x16x32_bf16 v[64:67], a[24:27], v[12:15], v[64:67]
    buffer_load_dwordx4 v252, s[4:7], s42 offen offset:1024 sc1 lds
    v_mfma_f32_16x16x32_bf16 v[68:71], a[4:7], v[0:3], v[68:71]
    ds_read_b128 v[40:43], v252 offset:59392
    v_mfma_f32_16x16x32_bf16 v[68:71], a[12:15], v[4:7], v[68:71]
    v_mfma_f32_16x16x32_bf16 v[68:71], a[20:23], v[8:11], v[68:71]
    ds_read_b128 v[44:47], v252 offset:60416
    v_mfma_f32_16x16x32_bf16 v[68:71], a[28:31], v[12:15], v[68:71]
    s_waitcnt lgkmcnt(4)
    v_mfma_f32_16x16x32_bf16 v[72:75], a[0:3], v[16:19], v[72:75]
    ds_read_b128 v[0:3], v252 offset:61440
    v_mfma_f32_16x16x32_bf16 v[72:75], a[8:11], v[20:23], v[72:75]
    buffer_load_dwordx4 v252, s[4:7], s42 offen offset:2048 sc1 lds
    v_mfma_f32_16x16x32_bf16 v[72:75], a[16:19], v[24:27], v[72:75]
    ds_read_b128 v[4:7], v252 offset:62464
    v_mfma_f32_16x16x32_bf16 v[72:75], a[24:27], v[28:31], v[72:75]
    v_mfma_f32_16x16x32_bf16 v[76:79], a[4:7], v[16:19], v[76:79]
    ds_read_b128 v[8:11], v252 offset:63488
    v_mfma_f32_16x16x32_bf16 v[76:79], a[12:15], v[20:23], v[76:79]
    buffer_load_dwordx4 v252, s[4:7], s42 offen offset:3072 sc1 lds
    v_mfma_f32_16x16x32_bf16 v[76:79], a[20:23], v[24:27], v[76:79]
    ds_read_b128 v[12:15], v252 offset:64512
    v_mfma_f32_16x16x32_bf16 v[76:79], a[28:31], v[28:31], v[76:79]
    s_waitcnt lgkmcnt(4)
    v_mfma_f32_16x16x32_bf16 v[64:67], a[32:35], v[32:35], v[64:67]
    s_waitcnt vmcnt(13) lgkmcnt(0)
    s_barrier
    ds_read_b128 v[16:19], v195 offset:0
    v_mfma_f32_16x16x32_bf16 v[64:67], a[40:43], v[36:39], v[64:67]
    v_mfma_f32_16x16x32_bf16 v[64:67], a[48:51], v[40:43], v[64:67]
    ds_read_b128 v[20:23], v195 offset:1024
    s_add_u32 m0, s27, 102400
    s_add_u32 s43, s78, 131072
    v_mfma_f32_16x16x32_bf16 v[64:67], a[56:59], v[44:47], v[64:67]
    buffer_load_dwordx4 v252, s[4:7], s43 offen offset:0 sc1 lds
    v_mfma_f32_16x16x32_bf16 v[68:71], a[36:39], v[32:35], v[68:71]
    ds_read_b128 v[24:27], v195 offset:2048
    v_mfma_f32_16x16x32_bf16 v[68:71], a[44:47], v[36:39], v[68:71]
    v_mfma_f32_16x16x32_bf16 v[68:71], a[52:55], v[40:43], v[68:71]
    ds_read_b128 v[28:31], v195 offset:3072
    v_mfma_f32_16x16x32_bf16 v[68:71], a[60:63], v[44:47], v[68:71]
    s_waitcnt lgkmcnt(4)
    v_mfma_f32_16x16x32_bf16 v[72:75], a[32:35], v[0:3], v[72:75]
    ds_read_b128 v[32:35], v195 offset:4096
    v_mfma_f32_16x16x32_bf16 v[72:75], a[40:43], v[4:7], v[72:75]
    buffer_load_dwordx4 v252, s[4:7], s43 offen offset:1024 sc1 lds
    v_mfma_f32_16x16x32_bf16 v[72:75], a[48:51], v[8:11], v[72:75]
    ds_read_b128 v[36:39], v195 offset:5120
    v_mfma_f32_16x16x32_bf16 v[72:75], a[56:59], v[12:15], v[72:75]
    v_mfma_f32_16x16x32_bf16 v[76:79], a[36:39], v[0:3], v[76:79]
    ds_read_b128 v[40:43], v195 offset:6144
    v_mfma_f32_16x16x32_bf16 v[76:79], a[44:47], v[4:7], v[76:79]
    v_mfma_f32_16x16x32_bf16 v[76:79], a[52:55], v[8:11], v[76:79]
    ds_read_b128 v[44:47], v195 offset:7168
    v_mfma_f32_16x16x32_bf16 v[76:79], a[60:63], v[12:15], v[76:79]
    s_waitcnt lgkmcnt(4)
    buffer_load_dwordx4 v252, s[4:7], s43 offen offset:2048 sc1 lds
    v_mfma_f32_16x16x32_bf16 v[80:83], v[128:131], v[16:19], 0
    ds_read_b128 v[0:3], v195 offset:8192
    v_mfma_f32_16x16x32_bf16 v[80:83], v[136:139], v[20:23], v[80:83]
    v_mfma_f32_16x16x32_bf16 v[80:83], v[144:147], v[24:27], v[80:83]
    ds_read_b128 v[4:7], v195 offset:9216
    v_mfma_f32_16x16x32_bf16 v[80:83], v[152:155], v[28:31], v[80:83]
    buffer_load_dwordx4 v252, s[4:7], s43 offen offset:3072 sc1 lds
    v_mfma_f32_16x16x32_bf16 v[84:87], v[132:135], v[16:19], 0
    ds_read_b128 v[8:11], v195 offset:10240
    v_mfma_f32_16x16x32_bf16 v[84:87], v[140:143], v[20:23], v[84:87]
    v_mfma_f32_16x16x32_bf16 v[84:87], v[148:151], v[24:27], v[84:87]
    ds_read_b128 v[12:15], v195 offset:11264
    v_mfma_f32_16x16x32_bf16 v[84:87], v[156:159], v[28:31], v[84:87]
    s_waitcnt lgkmcnt(4)
    v_mfma_f32_16x16x32_bf16 v[88:91], v[128:131], v[32:35], 0
    ds_read_b128 v[16:19], v195 offset:12288
    s_add_u32 m0, s27, 0
    s_add_u32 s42, s78, 16384
    v_mfma_f32_16x16x32_bf16 v[88:91], v[136:139], v[36:39], v[88:91]
    buffer_load_dwordx4 v252, s[4:7], s42 offen offset:0 sc1 lds
    v_mfma_f32_16x16x32_bf16 v[88:91], v[144:147], v[40:43], v[88:91]
    ds_read_b128 v[20:23], v195 offset:13312
    v_mfma_f32_16x16x32_bf16 v[88:91], v[152:155], v[44:47], v[88:91]
    v_mfma_f32_16x16x32_bf16 v[92:95], v[132:135], v[32:35], 0
    ds_read_b128 v[24:27], v195 offset:14336
    v_mfma_f32_16x16x32_bf16 v[92:95], v[140:143], v[36:39], v[92:95]
    v_mfma_f32_16x16x32_bf16 v[92:95], v[148:151], v[40:43], v[92:95]
    ds_read_b128 v[28:31], v195 offset:15360
    v_mfma_f32_16x16x32_bf16 v[92:95], v[156:159], v[44:47], v[92:95]
    s_waitcnt lgkmcnt(4)
    buffer_load_dwordx4 v252, s[4:7], s42 offen offset:1024 sc1 lds
    v_mfma_f32_16x16x32_bf16 v[80:83], v[160:163], v[0:3], v[80:83]
    ds_read_b128 v[32:35], v195 offset:16384
    s_and_b32 s82, s54, 0xffff0000
    s_xor_b32 s83, s82, 0x80000000
    s_xor_b32 s84, s82, 0xffff0000
    s_bitcmp1_b32 s82, 31
    s_cselect_b32 s82, s83, s84
    v_mov_b32 v230, s82
    v_mfma_f32_16x16x32_bf16 v[80:83], v[168:171], v[4:7], v[80:83]
    v_mul_f32 v230, 0xbfb8aa3b, v230
    v_mfma_f32_16x16x32_bf16 v[80:83], v[176:179], v[8:11], v[80:83]
    ds_read_b128 v[36:39], v195 offset:17408
    v_mfma_f32_16x16x32_bf16 v[80:83], v[184:187], v[12:15], v[80:83]
    v_exp_f32 v230, v230
    v_mfma_f32_16x16x32_bf16 v[84:87], v[164:167], v[0:3], v[84:87]
    ds_read_b128 v[40:43], v195 offset:18432
    v_lshrrev_b32 v231, 8, v252
    v_mfma_f32_16x16x32_bf16 v[84:87], v[172:175], v[4:7], v[84:87]
    buffer_load_dwordx4 v252, s[4:7], s42 offen offset:2048 sc1 lds
    v_mfma_f32_16x16x32_bf16 v[84:87], v[180:183], v[8:11], v[84:87]
    ds_read_b128 v[44:47], v195 offset:19456
    v_add_f32 v230, 1.0, v230
    v_mfma_f32_16x16x32_bf16 v[84:87], v[188:191], v[12:15], v[84:87]
    s_waitcnt lgkmcnt(4)
    v_rcp_f32 v230, v230
    v_mfma_f32_16x16x32_bf16 v[88:91], v[160:163], v[16:19], v[88:91]
    ds_read_b128 v[0:3], v195 offset:20480
    v_lshlrev_b32 v231, 3, v231
    v_mfma_f32_16x16x32_bf16 v[88:91], v[168:171], v[20:23], v[88:91]
    buffer_load_dwordx4 v252, s[4:7], s42 offen offset:3072 sc1 lds
    v_mfma_f32_16x16x32_bf16 v[88:91], v[176:179], v[24:27], v[88:91]
    ds_read_b128 v[4:7], v195 offset:21504
    v_cvt_pk_bf16_f32 v230, v230, v230
    v_mfma_f32_16x16x32_bf16 v[88:91], v[184:187], v[28:31], v[88:91]
    s_branch L_io15
    .p2align 12
L_iw15:
    s_branch L_iwr9
L_io15:
    v_lshlrev_b32 v230, 16, v230
    v_lshrrev_b32 v192, 7, v252
    v_mfma_f32_16x16x32_bf16 v[92:95], v[164:167], v[16:19], v[92:95]
    ds_read_b128 v[8:11], v195 offset:22528
    v_lshlrev_b32 v192, 11, v192
    v_mfma_f32_16x16x32_bf16 v[92:95], v[172:175], v[20:23], v[92:95]
    v_and_b32 v193, 0x70, v252
    v_add_u32 v192, v192, v193
    v_mfma_f32_16x16x32_bf16 v[92:95], v[180:183], v[24:27], v[92:95]
    ds_read_b128 v[12:15], v195 offset:23552
    s_add_u32 m0, s27, 4096
    s_add_u32 s43, s78, 147456
    v_bfe_u32 v193, v252, 4, 4
    v_mfma_f32_16x16x32_bf16 v[92:95], v[188:191], v[28:31], v[92:95]
    s_waitcnt lgkmcnt(4)
    buffer_load_dwordx4 v252, s[4:7], s43 offen offset:0 sc1 lds
    v_mfma_f32_16x16x32_bf16 v[80:83], a[192:195], v[32:35], v[80:83]
    ds_read_b128 v[16:19], v195 offset:24576
    v_lshlrev_b32 v112, 16, v220
    v_mfma_f32_16x16x32_bf16 v[80:83], a[200:203], v[36:39], v[80:83]
    v_and_b32 v113, 0xffff0000, v220
    v_lshlrev_b32 v114, 16, v221
    v_mfma_f32_16x16x32_bf16 v[80:83], a[208:211], v[40:43], v[80:83]
    ds_read_b128 v[20:23], v195 offset:25600
    v_and_b32 v115, 0xffff0000, v221
    v_mfma_f32_16x16x32_bf16 v[80:83], a[216:219], v[44:47], v[80:83]
    v_lshlrev_b32 v116, 16, v222
    v_and_b32 v117, 0xffff0000, v222
    v_mfma_f32_16x16x32_bf16 v[84:87], a[196:199], v[32:35], v[84:87]
    ds_read_b128 v[24:27], v195 offset:26624
    v_lshlrev_b32 v118, 16, v223
    v_mfma_f32_16x16x32_bf16 v[84:87], a[204:207], v[36:39], v[84:87]
    buffer_load_dwordx4 v252, s[4:7], s43 offen offset:1024 sc1 lds
    v_mfma_f32_16x16x32_bf16 v[84:87], a[212:215], v[40:43], v[84:87]
    ds_read_b128 v[28:31], v195 offset:27648
    v_and_b32 v119, 0xffff0000, v223
    v_mfma_f32_16x16x32_bf16 v[84:87], a[220:223], v[44:47], v[84:87]
    s_waitcnt lgkmcnt(4)
    v_lshlrev_b32 v120, 16, v224
    v_and_b32 v121, 0xffff0000, v224
    v_mfma_f32_16x16x32_bf16 v[88:91], a[192:195], v[0:3], v[88:91]
    ds_read_b128 v[32:35], v195 offset:28672
    v_lshlrev_b32 v122, 16, v225
    v_mfma_f32_16x16x32_bf16 v[88:91], a[200:203], v[4:7], v[88:91]
    v_and_b32 v123, 0xffff0000, v225
    v_lshlrev_b32 v124, 16, v226
    v_mfma_f32_16x16x32_bf16 v[88:91], a[208:211], v[8:11], v[88:91]
    ds_read_b128 v[36:39], v195 offset:29696
    v_and_b32 v125, 0xffff0000, v226
    v_mfma_f32_16x16x32_bf16 v[88:91], a[216:219], v[12:15], v[88:91]
    buffer_load_dwordx4 v252, s[4:7], s43 offen offset:2048 sc1 lds
    v_mfma_f32_16x16x32_bf16 v[92:95], a[196:199], v[0:3], v[92:95]
    ds_read_b128 v[40:43], v195 offset:30720
    v_lshlrev_b32 v126, 16, v227
    v_mfma_f32_16x16x32_bf16 v[92:95], a[204:207], v[4:7], v[92:95]
    v_and_b32 v127, 0xffff0000, v227
    v_mfma_f32_16x16x32_bf16 v[92:95], a[212:215], v[8:11], v[92:95]
    ds_read_b128 v[44:47], v195 offset:31744
    v_mfma_f32_16x16x32_bf16 v[92:95], a[220:223], v[12:15], v[92:95]
    s_waitcnt lgkmcnt(4)
    buffer_load_dwordx4 v252, s[4:7], s43 offen offset:3072 sc1 lds
    v_mfma_f32_16x16x32_bf16 v[80:83], a[224:227], v[16:19], v[80:83]
    s_waitcnt vmcnt(16) lgkmcnt(0)
    s_barrier
    ds_read_b128 v[0:3], v228 offset:0
    v_mfma_f32_16x16x32_bf16 v[80:83], a[232:235], v[20:23], v[80:83]
    v_mfma_f32_16x16x32_bf16 v[80:83], a[240:243], v[24:27], v[80:83]
    ds_read_b128 v[4:7], v228 offset:1024
    v_mfma_f32_16x16x32_bf16 v[80:83], a[248:251], v[28:31], v[80:83]
    v_mfma_f32_16x16x32_bf16 v[84:87], a[228:231], v[16:19], v[84:87]
    ds_read_b128 v[8:11], v228 offset:2048
    s_add_u32 m0, s27, 32768
    s_add_u32 s42, s79, 0
    v_mfma_f32_16x16x32_bf16 v[84:87], a[236:239], v[20:23], v[84:87]
    buffer_load_dwordx4 v252, s[4:7], s42 offen offset:0 sc1 lds
    v_mfma_f32_16x16x32_bf16 v[84:87], a[244:247], v[24:27], v[84:87]
    ds_read_b128 v[12:15], v228 offset:3072
    v_mfma_f32_16x16x32_bf16 v[84:87], a[252:255], v[28:31], v[84:87]
    s_waitcnt lgkmcnt(4)
    v_mfma_f32_16x16x32_bf16 v[88:91], a[224:227], v[32:35], v[88:91]
    ds_read_b128 v[16:19], v228 offset:4096
    v_mfma_f32_16x16x32_bf16 v[88:91], a[232:235], v[36:39], v[88:91]
    v_mfma_f32_16x16x32_bf16 v[88:91], a[240:243], v[40:43], v[88:91]
    ds_read_b128 v[20:23], v228 offset:5120
    v_mfma_f32_16x16x32_bf16 v[88:91], a[248:251], v[44:47], v[88:91]
    buffer_load_dwordx4 v252, s[4:7], s42 offen offset:1024 sc1 lds
    v_mfma_f32_16x16x32_bf16 v[92:95], a[228:231], v[32:35], v[92:95]
    ds_read_b128 v[24:27], v228 offset:6144
    v_mfma_f32_16x16x32_bf16 v[92:95], a[236:239], v[36:39], v[92:95]
    v_mfma_f32_16x16x32_bf16 v[92:95], a[244:247], v[40:43], v[92:95]
    ds_read_b128 v[28:31], v228 offset:7168
    v_mfma_f32_16x16x32_bf16 v[92:95], a[252:255], v[44:47], v[92:95]
    s_waitcnt lgkmcnt(4)
    v_mfma_f32_16x16x32_bf16 v[80:83], a[128:131], v[0:3], v[80:83]
    ds_read_b128 v[32:35], v228 offset:8192
    v_max3_f32 v204, |v64|, |v65|, |v66|
    v_mfma_f32_16x16x32_bf16 v[80:83], a[136:139], v[4:7], v[80:83]
    buffer_load_dwordx4 v252, s[4:7], s42 offen offset:2048 sc1 lds
    v_mfma_f32_16x16x32_bf16 v[80:83], a[144:147], v[8:11], v[80:83]
    ds_read_b128 v[36:39], v228 offset:9216
    v_max3_f32 v204, v204, |v67|, |v68|
    v_mfma_f32_16x16x32_bf16 v[80:83], a[152:155], v[12:15], v[80:83]
    v_max3_f32 v204, v204, |v69|, |v70|
    v_max3_f32 v204, v204, |v71|, |v72|
    v_mfma_f32_16x16x32_bf16 v[84:87], a[132:135], v[0:3], v[84:87]
    ds_read_b128 v[40:43], v228 offset:10240
    v_max3_f32 v204, v204, |v73|, |v74|
    s_cmp_lg_u32 s80, 0
    s_cbranch_scc1 L_y0
L_y0_back:
    v_mfma_f32_16x16x32_bf16 v[84:87], a[140:143], v[4:7], v[84:87]
    buffer_load_dwordx4 v252, s[4:7], s42 offen offset:3072 sc1 lds
    v_mfma_f32_16x16x32_bf16 v[84:87], a[148:151], v[8:11], v[84:87]
    ds_read_b128 v[44:47], v228 offset:11264
    v_max3_f32 v204, v204, |v75|, |v76|
    v_mfma_f32_16x16x32_bf16 v[84:87], a[156:159], v[12:15], v[84:87]
    s_waitcnt lgkmcnt(4)
    v_max3_f32 v204, v204, |v77|, |v78|
    v_max_f32 v204, |v79|, v204
    v_mfma_f32_16x16x32_bf16 v[88:91], a[128:131], v[16:19], v[88:91]
    ds_read_b128 v[0:3], v228 offset:12288
    v_bfe_u32 v204, v204, 23, 8
    v_mfma_f32_16x16x32_bf16 v[88:91], a[136:139], v[20:23], v[88:91]
    v_sub_u32 v205, 126, v204
    v_lshl_or_b32 v206, v204, 14, v204
    v_mfma_f32_16x16x32_bf16 v[88:91], a[144:147], v[24:27], v[88:91]
    ds_read_b128 v[4:7], v228 offset:13312
    s_add_u32 m0, s27, 36864
    s_add_u32 s43, s79, 131072
    v_ldexp_f32 v64, v64, v205
    v_mfma_f32_16x16x32_bf16 v[88:91], a[152:155], v[28:31], v[88:91]
    buffer_load_dwordx4 v252, s[4:7], s43 offen offset:0 sc1 lds
    v_mfma_f32_16x16x32_bf16 v[92:95], a[132:135], v[16:19], v[92:95]
    ds_read_b128 v[8:11], v228 offset:14336
    v_ldexp_f32 v65, v65, v205
    v_mfma_f32_16x16x32_bf16 v[92:95], a[140:143], v[20:23], v[92:95]
    v_ldexp_f32 v66, v66, v205
    v_ldexp_f32 v67, v67, v205
    v_mfma_f32_16x16x32_bf16 v[92:95], a[148:151], v[24:27], v[92:95]
    ds_read_b128 v[12:15], v228 offset:15360
    v_ldexp_f32 v68, v68, v205
    v_mfma_f32_16x16x32_bf16 v[92:95], a[156:159], v[28:31], v[92:95]
    s_waitcnt lgkmcnt(4)
    v_ldexp_f32 v69, v69, v205
    v_ldexp_f32 v70, v70, v205
    v_mfma_f32_16x16x32_bf16 v[80:83], a[160:163], v[32:35], v[80:83]
    ds_read_b128 v[16:19], v228 offset:16384
    v_ldexp_f32 v71, v71, v205
    v_mfma_f32_16x16x32_bf16 v[80:83], a[168:171], v[36:39], v[80:83]
    buffer_load_dwordx4 v252, s[4:7], s43 offen offset:1024 sc1 lds
    v_mfma_f32_16x16x32_bf16 v[80:83], a[176:179], v[40:43], v[80:83]
    ds_read_b128 v[20:23], v228 offset:17408
    v_lshrrev_b32 v207, 4, v206
    v_mfma_f32_16x16x32_bf16 v[80:83], a[184:187], v[44:47], v[80:83]
    v_cvt_pknorm_i16_f32 v64, v64, v65
    v_cvt_pknorm_i16_f32 v65, v66, v67
    v_mfma_f32_16x16x32_bf16 v[84:87], a[164:167], v[32:35], v[84:87]
    ds_read_b128 v[24:27], v228 offset:18432
    v_cvt_pknorm_i16_f32 v66, v68, v69
    v_mfma_f32_16x16x32_bf16 v[84:87], a[172:175], v[36:39], v[84:87]
    v_cvt_pknorm_i16_f32 v67, v70, v71
    v_bfi_b32 v64, v233, v206, v64
    v_mfma_f32_16x16x32_bf16 v[84:87], a[180:183], v[40:43], v[84:87]
    ds_read_b128 v[28:31], v228 offset:19456
    v_bfi_b32 v65, v233, s13, v65
    v_mfma_f32_16x16x32_bf16 v[84:87], a[188:191], v[44:47], v[84:87]
    s_waitcnt lgkmcnt(4)
    buffer_load_dwordx4 v252, s[4:7], s43 offen offset:2048 sc1 lds
    v_mfma_f32_16x16x32_bf16 v[88:91], a[160:163], v[0:3], v[88:91]
    ds_read_b128 v[32:35], v228 offset:20480
    v_bfi_b32 v66, v233, s14, v66
    v_mfma_f32_16x16x32_bf16 v[88:91], a[168:171], v[4:7], v[88:91]
    v_bfi_b32 v67, v233, s15, v67
    v_ldexp_f32 v72, v72, v205
    v_mfma_f32_16x16x32_bf16 v[88:91], a[176:179], v[8:11], v[88:91]
    ds_read_b128 v[36:39], v228 offset:21504
    v_ldexp_f32 v73, v73, v205
    v_mfma_f32_16x16x32_bf16 v[88:91], a[184:187], v[12:15], v[88:91]
    buffer_load_dwordx4 v252, s[4:7], s43 offen offset:3072 sc1 lds
    v_mfma_f32_16x16x32_bf16 v[92:95], a[164:167], v[0:3], v[92:95]
    ds_read_b128 v[40:43], v228 offset:22528
    v_ldexp_f32 v74, v74, v205
    v_mfma_f32_16x16x32_bf16 v[92:95], a[172:175], v[4:7], v[92:95]
    v_ldexp_f32 v75, v75, v205
    v_ldexp_f32 v76, v76, v205
    v_mfma_f32_16x16x32_bf16 v[92:95], a[180:183], v[8:11], v[92:95]
    ds_read_b128 v[44:47], v228 offset:23552
    v_ldexp_f32 v77, v77, v205
    v_mfma_f32_16x16x32_bf16 v[92:95], a[188:191], v[12:15], v[92:95]
    s_waitcnt lgkmcnt(4)
    v_ldexp_f32 v78, v78, v205
    v_ldexp_f32 v79, v79, v205
    v_mfma_f32_16x16x32_bf16 v[80:83], a[0:3], v[16:19], v[80:83]
    ds_read_b128 v[0:3], v228 offset:24576
    s_add_u32 m0, s27, 131072
    s_add_u32 s42, s79, 16384
    v_cvt_pknorm_i16_f32 v68, v72, v73
    v_mfma_f32_16x16x32_bf16 v[80:83], a[8:11], v[20:23], v[80:83]
    buffer_load_dwordx4 v252, s[4:7], s42 offen offset:0 sc1 lds
    v_mfma_f32_16x16x32_bf16 v[80:83], a[16:19], v[24:27], v[80:83]
    ds_read_b128 v[4:7], v228 offset:25600
    v_cvt_pknorm_i16_f32 v69, v74, v75
    v_mfma_f32_16x16x32_bf16 v[80:83], a[24:27], v[28:31], v[80:83]
    v_cvt_pknorm_i16_f32 v70, v76, v77
    v_cvt_pknorm_i16_f32 v71, v78, v79
    v_mfma_f32_16x16x32_bf16 v[84:87], a[4:7], v[16:19], v[84:87]
    ds_read_b128 v[8:11], v228 offset:26624
    v_bfi_b32 v68, v233, v207, v68
    v_mfma_f32_16x16x32_bf16 v[84:87], a[12:15], v[20:23], v[84:87]
    v_bfi_b32 v69, v233, s13, v69
    v_bfi_b32 v70, v233, s14, v70
    v_mfma_f32_16x16x32_bf16 v[84:87], a[20:23], v[24:27], v[84:87]
    ds_read_b128 v[12:15], v228 offset:27648
    v_bfi_b32 v71, v233, s15, v71
    v_mfma_f32_16x16x32_bf16 v[84:87], a[28:31], v[28:31], v[84:87]
    s_waitcnt lgkmcnt(4)
    buffer_load_dwordx4 v252, s[4:7], s42 offen offset:1024 sc1 lds
    v_mfma_f32_16x16x32_bf16 v[88:91], a[0:3], v[32:35], v[88:91]
    ds_read_b128 v[16:19], v228 offset:28672
    v_mfma_f32_16x16x32_bf16 v[88:91], a[8:11], v[36:39], v[88:91]
    v_mfma_f32_16x16x32_bf16 v[88:91], a[16:19], v[40:43], v[88:91]
    ds_read_b128 v[20:23], v228 offset:29696
    v_mfma_f32_16x16x32_bf16 v[88:91], a[24:27], v[44:47], v[88:91]
    v_mfma_f32_16x16x32_bf16 v[92:95], a[4:7], v[32:35], v[92:95]
    ds_read_b128 v[24:27], v228 offset:30720
    v_mfma_f32_16x16x32_bf16 v[92:95], a[12:15], v[36:39], v[92:95]
    buffer_load_dwordx4 v252, s[4:7], s42 offen offset:2048 sc1 lds
    v_mfma_f32_16x16x32_bf16 v[92:95], a[20:23], v[40:43], v[92:95]
    ds_read_b128 v[28:31], v228 offset:31744
    v_mfma_f32_16x16x32_bf16 v[92:95], a[28:31], v[44:47], v[92:95]
    s_waitcnt lgkmcnt(4)
    v_mfma_f32_16x16x32_bf16 v[80:83], a[32:35], v[0:3], v[80:83]
    s_waitcnt vmcnt(19) lgkmcnt(0)
    s_barrier
    ds_read_b128 v[32:35], v228 offset:32768
    v_mfma_f32_16x16x32_bf16 v[80:83], a[40:43], v[4:7], v[80:83]
    buffer_load_dwordx4 v252, s[4:7], s42 offen offset:3072 sc1 lds
    v_mfma_f32_16x16x32_bf16 v[80:83], a[48:51], v[8:11], v[80:83]
    ds_read_b128 v[36:39], v228 offset:33792
    v_mfma_f32_16x16x32_bf16 v[80:83], a[56:59], v[12:15], v[80:83]
    v_mfma_f32_16x16x32_bf16 v[84:87], a[36:39], v[0:3], v[84:87]
    ds_read_b128 v[40:43], v228 offset:34816
    s_cmp_lg_u32 s80, 0
    s_cbranch_scc1 L_y1
L_y1_back:
    v_mfma_f32_16x16x32_bf16 v[84:87], a[44:47], v[4:7], v[84:87]
    v_mfma_f32_16x16x32_bf16 v[84:87], a[52:55], v[8:11], v[84:87]
    ds_read_b128 v[44:47], v228 offset:35840
    s_add_u32 m0, s27, 135168
    s_add_u32 s43, s79, 147456
    v_mfma_f32_16x16x32_bf16 v[84:87], a[60:63], v[12:15], v[84:87]
    s_waitcnt lgkmcnt(4)
    buffer_load_dwordx4 v252, s[4:7], s43 offen offset:0 sc1 lds
    v_mfma_f32_16x16x32_bf16 v[88:91], a[32:35], v[16:19], v[88:91]
    ds_read_b128 v[0:3], v228 offset:36864
    v_mfma_f32_16x16x32_bf16 v[88:91], a[40:43], v[20:23], v[88:91]
    buffer_store_dwordx4 v[64:67], v252, s[20:23], s16 offen offset:0 sc1
    v_mfma_f32_16x16x32_bf16 v[88:91], a[48:51], v[24:27], v[88:91]
    ds_read_b128 v[4:7], v228 offset:37888
    v_max3_f32 v204, |v80|, |v81|, |v82|
    v_mfma_f32_16x16x32_bf16 v[88:91], a[56:59], v[28:31], v[88:91]
    v_max3_f32 v204, v204, |v83|, |v84|
    v_max3_f32 v204, v204, |v85|, |v86|
    v_mfma_f32_16x16x32_bf16 v[92:95], a[36:39], v[16:19], v[92:95]
    ds_read_b128 v[8:11], v228 offset:38912
    v_mfma_f32_16x16x32_bf16 v[92:95], a[44:47], v[20:23], v[92:95]
    buffer_load_dwordx4 v252, s[4:7], s43 offen offset:1024 sc1 lds
    v_mfma_f32_16x16x32_bf16 v[92:95], a[52:55], v[24:27], v[92:95]
    ds_read_b128 v[12:15], v228 offset:39936
    v_max3_f32 v204, v204, |v87|, |v88|
    v_mfma_f32_16x16x32_bf16 v[92:95], a[60:63], v[28:31], v[92:95]
    s_waitcnt lgkmcnt(4)
    v_max3_f32 v204, v204, |v89|, |v90|
    v_mfma_f32_16x16x32_bf16 v[96:99], v[128:131], v[32:35], 0
    ds_read_b128 v[16:19], v228 offset:40960
    v_mfma_f32_16x16x32_bf16 v[96:99], v[136:139], v[36:39], v[96:99]
    buffer_store_dwordx4 v[68:71], v252, s[20:23], s16 offen offset:1024 sc1
    v_mfma_f32_16x16x32_bf16 v[96:99], v[144:147], v[40:43], v[96:99]
    ds_read_b128 v[20:23], v228 offset:41984
    v_max3_f32 v204, v204, |v91|, |v92|
    v_mfma_f32_16x16x32_bf16 v[96:99], v[152:155], v[44:47], v[96:99]
    v_max3_f32 v204, v204, |v93|, |v94|
    v_max_f32 v204, |v95|, v204
    v_mfma_f32_16x16x32_bf16 v[100:103], v[132:135], v[32:35], 0
    ds_read_b128 v[24:27], v228 offset:43008
    v_bfe_u32 v204, v204, 23, 8
    v_mfma_f32_16x16x32_bf16 v[100:103], v[140:143], v[36:39], v[100:103]
    v_sub_u32 v205, 126, v204
    v_lshl_or_b32 v206, v204, 14, v204
    v_mfma_f32_16x16x32_bf16 v[100:103], v[148:151], v[40:43], v[100:103]
    ds_read_b128 v[28:31], v228 offset:44032
    v_ldexp_f32 v80, v80, v205
    v_mfma_f32_16x16x32_bf16 v[100:103], v[156:159], v[44:47], v[100:103]
    s_waitcnt lgkmcnt(4)
    v_ldexp_f32 v81, v81, v205
    v_ldexp_f32 v82, v82, v205
    v_mfma_f32_16x16x32_bf16 v[104:107], v[128:131], v[0:3], 0
    ds_read_b128 v[32:35], v228 offset:45056
    v_ldexp_f32 v83, v83, v205
    v_mfma_f32_16x16x32_bf16 v[104:107], v[136:139], v[4:7], v[104:107]
    v_ldexp_f32 v84, v84, v205
    v_ldexp_f32 v85, v85, v205
    v_mfma_f32_16x16x32_bf16 v[104:107], v[144:147], v[8:11], v[104:107]
    ds_read_b128 v[36:39], v228 offset:46080
    v_ldexp_f32 v86, v86, v205
    v_mfma_f32_16x16x32_bf16 v[104:107], v[152:155], v[12:15], v[104:107]
    v_ldexp_f32 v87, v87, v205
    v_lshrrev_b32 v207, 4, v206
    v_mfma_f32_16x16x32_bf16 v[108:111], v[132:135], v[0:3], 0
    ds_read_b128 v[40:43], v228 offset:47104
    v_cvt_pknorm_i16_f32 v80, v80, v81
    v_mfma_f32_16x16x32_bf16 v[108:111], v[140:143], v[4:7], v[108:111]
    v_cvt_pknorm_i16_f32 v81, v82, v83
    v_cvt_pknorm_i16_f32 v82, v84, v85
    v_mfma_f32_16x16x32_bf16 v[108:111], v[148:151], v[8:11], v[108:111]
    ds_read_b128 v[44:47], v228 offset:48128
    v_cvt_pknorm_i16_f32 v83, v86, v87
    v_mfma_f32_16x16x32_bf16 v[108:111], v[156:159], v[12:15], v[108:111]
    s_waitcnt lgkmcnt(4)
    v_bfi_b32 v80, v233, v206, v80
    v_bfi_b32 v81, v233, s13, v81
    v_mfma_f32_16x16x32_bf16 v[96:99], v[160:163], v[16:19], v[96:99]
    ds_read_b128 v[0:3], v228 offset:49152
    v_bfi_b32 v82, v233, s14, v82
    v_mfma_f32_16x16x32_bf16 v[96:99], v[168:171], v[20:23], v[96:99]
    v_bfi_b32 v83, v233, s15, v83
    v_ldexp_f32 v88, v88, v205
    v_mfma_f32_16x16x32_bf16 v[96:99], v[176:179], v[24:27], v[96:99]
    ds_read_b128 v[4:7], v228 offset:50176
    v_ldexp_f32 v89, v89, v205
    v_mfma_f32_16x16x32_bf16 v[96:99], v[184:187], v[28:31], v[96:99]
    buffer_store_dwordx4 v[80:83], v252, s[20:23], s17 offen offset:0 sc1
    v_mfma_f32_16x16x32_bf16 v[100:103], v[164:167], v[16:19], v[100:103]
    ds_read_b128 v[8:11], v228 offset:51200
    v_ldexp_f32 v90, v90, v205
    v_mfma_f32_16x16x32_bf16 v[100:103], v[172:175], v[20:23], v[100:103]
    v_ldexp_f32 v91, v91, v205
    v_ldexp_f32 v92, v92, v205
    v_mfma_f32_16x16x32_bf16 v[100:103], v[180:183], v[24:27], v[100:103]
    ds_read_b128 v[12:15], v228 offset:52224
    v_ldexp_f32 v93, v93, v205
    v_mfma_f32_16x16x32_bf16 v[100:103], v[188:191], v[28:31], v[100:103]
    s_waitcnt lgkmcnt(4)
    v_ldexp_f32 v94, v94, v205
    v_ldexp_f32 v95, v95, v205
    v_mfma_f32_16x16x32_bf16 v[104:107], v[160:163], v[32:35], v[104:107]
    ds_read_b128 v[16:19], v228 offset:53248
    v_cvt_pknorm_i16_f32 v84, v88, v89
    v_mfma_f32_16x16x32_bf16 v[104:107], v[168:171], v[36:39], v[104:107]
    v_cvt_pknorm_i16_f32 v85, v90, v91
    v_cvt_pknorm_i16_f32 v86, v92, v93
    v_mfma_f32_16x16x32_bf16 v[104:107], v[176:179], v[40:43], v[104:107]
    ds_read_b128 v[20:23], v228 offset:54272
    v_cvt_pknorm_i16_f32 v87, v94, v95
    v_mfma_f32_16x16x32_bf16 v[104:107], v[184:187], v[44:47], v[104:107]
    v_bfi_b32 v84, v233, v207, v84
    v_bfi_b32 v85, v233, s13, v85
    s_branch L_io16
    .p2align 12
L_iw16:
    s_branch L_iwr9
L_io16:
    v_mfma_f32_16x16x32_bf16 v[108:111], v[164:167], v[32:35], v[108:111]
    ds_read_b128 v[24:27], v228 offset:55296
    v_bfi_b32 v86, v233, s14, v86
    v_mfma_f32_16x16x32_bf16 v[108:111], v[172:175], v[36:39], v[108:111]
    v_bfi_b32 v87, v233, s15, v87
    v_mfma_f32_16x16x32_bf16 v[108:111], v[180:183], v[40:43], v[108:111]
    ds_read_b128 v[28:31], v228 offset:56320
    v_mfma_f32_16x16x32_bf16 v[108:111], v[188:191], v[44:47], v[108:111]
    s_waitcnt lgkmcnt(4)
    buffer_store_dwordx4 v[84:87], v252, s[20:23], s17 offen offset:1024 sc1
    v_mfma_f32_16x16x32_bf16 v[96:99], a[192:195], v[0:3], v[96:99]
    ds_read_b128 v[32:35], v228 offset:57344
    v_mfma_f32_16x16x32_bf16 v[96:99], a[200:203], v[4:7], v[96:99]
    buffer_load_dwordx4 v252, s[4:7], s43 offen offset:2048 sc1 lds
    v_mfma_f32_16x16x32_bf16 v[96:99], a[208:211], v[8:11], v[96:99]
    ds_read_b128 v[36:39], v228 offset:58368
    v_mfma_f32_16x16x32_bf16 v[96:99], a[216:219], v[12:15], v[96:99]
    v_mfma_f32_16x16x32_bf16 v[100:103], a[196:199], v[0:3], v[100:103]
    ds_read_b128 v[40:43], v228 offset:59392
    v_mfma_f32_16x16x32_bf16 v[100:103], a[204:207], v[4:7], v[100:103]
    buffer_load_dwordx4 v252, s[4:7], s43 offen offset:3072 sc1 lds
    v_mfma_f32_16x16x32_bf16 v[100:103], a[212:215], v[8:11], v[100:103]
    ds_read_b128 v[44:47], v228 offset:60416
    v_mfma_f32_16x16x32_bf16 v[100:103], a[220:223], v[12:15], v[100:103]
    s_waitcnt lgkmcnt(4)
    v_mfma_f32_16x16x32_bf16 v[104:107], a[192:195], v[16:19], v[104:107]
    ds_read_b128 v[0:3], v228 offset:61440
    v_mfma_f32_16x16x32_bf16 v[104:107], a[200:203], v[20:23], v[104:107]
    s_cmp_lg_u32 s80, 0
    s_cbranch_scc1 L_y2
L_y2_back:
    v_mfma_f32_16x16x32_bf16 v[104:107], a[208:211], v[24:27], v[104:107]
    ds_read_b128 v[4:7], v228 offset:62464
    v_add_f32_dpp v244, v244, v244 row_ror:8 row_mask:0xf bank_mask:0xf
    v_mfma_f32_16x16x32_bf16 v[104:107], a[216:219], v[28:31], v[104:107]
    v_add_f32_dpp v245, v245, v245 row_ror:8 row_mask:0xf bank_mask:0xf
    v_add_f32_dpp v246, v246, v246 row_ror:8 row_mask:0xf bank_mask:0xf
    v_mfma_f32_16x16x32_bf16 v[108:111], a[196:199], v[16:19], v[108:111]
    ds_read_b128 v[8:11], v228 offset:63488
    v_add_f32_dpp v247, v247, v247 row_ror:8 row_mask:0xf bank_mask:0xf
    v_mfma_f32_16x16x32_bf16 v[108:111], a[204:207], v[20:23], v[108:111]
    v_mov_b32 v248, v244
    v_mov_b32 v249, v245
    v_mfma_f32_16x16x32_bf16 v[108:111], a[212:215], v[24:27], v[108:111]
    ds_read_b128 v[12:15], v228 offset:64512
    v_mov_b32 v250, v246
    v_mfma_f32_16x16x32_bf16 v[108:111], a[220:223], v[28:31], v[108:111]
    s_waitcnt lgkmcnt(4)
    v_mov_b32 v251, v247
    v_permlane16_swap_b32 v248, v244
    v_mfma_f32_16x16x32_bf16 v[96:99], a[224:227], v[32:35], v[96:99]
    s_waitcnt vmcnt(20) lgkmcnt(0)
    s_barrier
    ds_read_b128 v[16:19], v252 offset:0
    v_mfma_f32_16x16x32_bf16 v[96:99], a[232:235], v[36:39], v[96:99]
    v_permlane16_swap_b32 v249, v245
    v_permlane16_swap_b32 v250, v246
    v_mfma_f32_16x16x32_bf16 v[96:99], a[240:243], v[40:43], v[96:99]
    ds_read_b128 v[20:23], v252 offset:1024
    v_permlane16_swap_b32 v251, v247
    v_mfma_f32_16x16x32_bf16 v[96:99], a[248:251], v[44:47], v[96:99]
    v_add_f32 v244, v244, v248
    v_add_f32 v245, v245, v249
    v_mfma_f32_16x16x32_bf16 v[100:103], a[228:231], v[32:35], v[100:103]
    ds_read_b128 v[24:27], v252 offset:2048
    v_add_f32 v246, v246, v250
    v_mfma_f32_16x16x32_bf16 v[100:103], a[236:239], v[36:39], v[100:103]
    v_add_f32 v247, v247, v251
    v_mov_b32 v248, v244
    v_mfma_f32_16x16x32_bf16 v[100:103], a[244:247], v[40:43], v[100:103]
    ds_read_b128 v[28:31], v252 offset:3072
    v_mov_b32 v249, v245
    v_mfma_f32_16x16x32_bf16 v[100:103], a[252:255], v[44:47], v[100:103]
    s_waitcnt lgkmcnt(4)
    v_mov_b32 v250, v246
    v_mov_b32 v251, v247
    v_mfma_f32_16x16x32_bf16 v[104:107], a[224:227], v[0:3], v[104:107]
    ds_read_b128 v[32:35], v252 offset:4096
    v_permlane32_swap_b32 v248, v244
    v_mfma_f32_16x16x32_bf16 v[104:107], a[232:235], v[4:7], v[104:107]
    v_permlane32_swap_b32 v249, v245
    v_permlane32_swap_b32 v250, v246
    v_mfma_f32_16x16x32_bf16 v[104:107], a[240:243], v[8:11], v[104:107]
    ds_read_b128 v[36:39], v252 offset:5120
    v_permlane32_swap_b32 v251, v247
    v_mfma_f32_16x16x32_bf16 v[104:107], a[248:251], v[12:15], v[104:107]
    v_add_f32 v244, v244, v248
    v_add_f32 v245, v245, v249
    v_mfma_f32_16x16x32_bf16 v[108:111], a[228:231], v[0:3], v[108:111]
    ds_read_b128 v[40:43], v252 offset:6144
    v_add_f32 v246, v246, v250
    v_mfma_f32_16x16x32_bf16 v[108:111], a[236:239], v[4:7], v[108:111]
    v_add_f32 v247, v247, v251
    v_cvt_pk_bf16_f32 v244, v244, v245
    v_mfma_f32_16x16x32_bf16 v[108:111], a[244:247], v[8:11], v[108:111]
    ds_read_b128 v[44:47], v252 offset:7168
    v_cvt_pk_bf16_f32 v246, v246, v247
    v_mfma_f32_16x16x32_bf16 v[108:111], a[252:255], v[12:15], v[108:111]
    s_waitcnt lgkmcnt(4)
    v_and_b32 v245, 0xffff0000, v244
    v_lshlrev_b32 v244, 16, v244
    v_mfma_f32_16x16x32_bf16 v[96:99], a[128:131], v[16:19], v[96:99]
    ds_read_b128 v[0:3], v252 offset:8192
    v_and_b32 v247, 0xffff0000, v246
    v_mfma_f32_16x16x32_bf16 v[96:99], a[136:139], v[20:23], v[96:99]
    v_lshlrev_b32 v246, 16, v246
    v_mul_f32 v244, v244, v230
    v_mfma_f32_16x16x32_bf16 v[96:99], a[144:147], v[24:27], v[96:99]
    ds_read_b128 v[4:7], v252 offset:9216
    v_mul_f32 v245, v245, v230
    v_mfma_f32_16x16x32_bf16 v[96:99], a[152:155], v[28:31], v[96:99]
    v_mul_f32 v246, v246, v230
    v_mul_f32 v247, v247, v230
    v_mfma_f32_16x16x32_bf16 v[100:103], a[132:135], v[16:19], v[100:103]
    ds_read_b128 v[8:11], v252 offset:10240
    v_cvt_pk_bf16_f32 v244, v244, v245
    v_mfma_f32_16x16x32_bf16 v[100:103], a[140:143], v[20:23], v[100:103]
    v_cvt_pk_bf16_f32 v246, v246, v247
    v_and_b32 v245, 0xffff0000, v244
    v_mfma_f32_16x16x32_bf16 v[100:103], a[148:151], v[24:27], v[100:103]
    ds_read_b128 v[12:15], v252 offset:11264
    v_lshlrev_b32 v244, 16, v244
    v_mfma_f32_16x16x32_bf16 v[100:103], a[156:159], v[28:31], v[100:103]
    s_waitcnt lgkmcnt(4)
    v_and_b32 v247, 0xffff0000, v246
    v_lshlrev_b32 v246, 16, v246
    v_mfma_f32_16x16x32_bf16 v[104:107], a[128:131], v[32:35], v[104:107]
    ds_read_b128 v[16:19], v252 offset:12288
    v_add_f32 v244, v244, v216
    v_mfma_f32_16x16x32_bf16 v[104:107], a[136:139], v[36:39], v[104:107]
    v_add_f32 v245, v245, v217
    v_add_f32 v246, v246, v218
    v_mfma_f32_16x16x32_bf16 v[104:107], a[144:147], v[40:43], v[104:107]
    ds_read_b128 v[20:23], v252 offset:13312
    v_add_f32 v247, v247, v219
    v_mfma_f32_16x16x32_bf16 v[104:107], a[152:155], v[44:47], v[104:107]
    v_cvt_pk_bf16_f32 v244, v244, v245
    v_cvt_pk_bf16_f32 v246, v246, v247
    v_mfma_f32_16x16x32_bf16 v[108:111], a[132:135], v[32:35], v[108:111]
    ds_read_b128 v[24:27], v252 offset:14336
    v_and_b32 v245, 0xffff0000, v244
    v_mfma_f32_16x16x32_bf16 v[108:111], a[140:143], v[36:39], v[108:111]
    v_lshlrev_b32 v244, 16, v244
    v_and_b32 v247, 0xffff0000, v246
    v_mfma_f32_16x16x32_bf16 v[108:111], a[148:151], v[40:43], v[108:111]
    ds_read_b128 v[28:31], v252 offset:15360
    v_lshlrev_b32 v246, 16, v246
    v_mfma_f32_16x16x32_bf16 v[108:111], a[156:159], v[44:47], v[108:111]
    s_waitcnt lgkmcnt(4)
    v_mul_f32 v248, 0xbfb8aa3b, v244
    v_mul_f32 v249, 0xbfb8aa3b, v245
    v_mfma_f32_16x16x32_bf16 v[96:99], a[160:163], v[0:3], v[96:99]
    ds_read_b128 v[32:35], v252 offset:16384
    v_mul_f32 v250, 0xbfb8aa3b, v246
    v_mfma_f32_16x16x32_bf16 v[96:99], a[168:171], v[4:7], v[96:99]
    v_mul_f32 v251, 0xbfb8aa3b, v247
    v_mfma_f32_16x16x32_bf16 v[96:99], a[176:179], v[8:11], v[96:99]
    ds_read_b128 v[36:39], v252 offset:17408
    v_mfma_f32_16x16x32_bf16 v[96:99], a[184:187], v[12:15], v[96:99]
    v_exp_f32 v248, v248
    v_mfma_f32_16x16x32_bf16 v[100:103], a[164:167], v[0:3], v[100:103]
    ds_read_b128 v[40:43], v252 offset:18432
    v_mfma_f32_16x16x32_bf16 v[100:103], a[172:175], v[4:7], v[100:103]
    v_exp_f32 v249, v249
    v_mfma_f32_16x16x32_bf16 v[100:103], a[180:183], v[8:11], v[100:103]
    ds_read_b128 v[44:47], v252 offset:19456
    v_mfma_f32_16x16x32_bf16 v[100:103], a[188:191], v[12:15], v[100:103]
    s_waitcnt lgkmcnt(4)
    v_exp_f32 v250, v250
    v_mfma_f32_16x16x32_bf16 v[104:107], a[160:163], v[16:19], v[104:107]
    ds_read_b128 v[0:3], v252 offset:20480
    v_mfma_f32_16x16x32_bf16 v[104:107], a[168:171], v[20:23], v[104:107]
    v_exp_f32 v251, v251
    v_mfma_f32_16x16x32_bf16 v[104:107], a[176:179], v[24:27], v[104:107]
    ds_read_b128 v[4:7], v252 offset:21504
    v_add_f32 v248, 1.0, v248
    v_mfma_f32_16x16x32_bf16 v[104:107], a[184:187], v[28:31], v[104:107]
    v_add_f32 v249, 1.0, v249
    v_add_f32 v250, 1.0, v250
    v_mfma_f32_16x16x32_bf16 v[108:111], a[164:167], v[16:19], v[108:111]
    ds_read_b128 v[8:11], v252 offset:22528
    v_add_f32 v251, 1.0, v251
    v_mfma_f32_16x16x32_bf16 v[108:111], a[172:175], v[20:23], v[108:111]
    v_rcp_f32 v248, v248
    v_mfma_f32_16x16x32_bf16 v[108:111], a[180:183], v[24:27], v[108:111]
    ds_read_b128 v[12:15], v252 offset:23552
    v_mfma_f32_16x16x32_bf16 v[108:111], a[188:191], v[28:31], v[108:111]
    s_waitcnt lgkmcnt(4)
    v_rcp_f32 v249, v249
    v_mfma_f32_16x16x32_bf16 v[96:99], a[0:3], v[32:35], v[96:99]
    ds_read_b128 v[16:19], v252 offset:24576
    v_mfma_f32_16x16x32_bf16 v[96:99], a[8:11], v[36:39], v[96:99]
    buffer_load_dwordx4 v[80:83], v252, s[20:23], s19 offen offset:0 sc1
    v_mfma_f32_16x16x32_bf16 v[96:99], a[16:19], v[40:43], v[96:99]
    ds_read_b128 v[20:23], v252 offset:25600
    v_mfma_f32_16x16x32_bf16 v[96:99], a[24:27], v[44:47], v[96:99]
    buffer_load_dwordx4 v[84:87], v252, s[20:23], s19 offen offset:1024 sc1
    v_mfma_f32_16x16x32_bf16 v[100:103], a[4:7], v[32:35], v[100:103]
    ds_read_b128 v[24:27], v252 offset:26624
    v_mfma_f32_16x16x32_bf16 v[100:103], a[12:15], v[36:39], v[100:103]
    buffer_load_dwordx4 v[88:91], v252, s[20:23], s60 offen offset:0 sc1
    v_mfma_f32_16x16x32_bf16 v[100:103], a[20:23], v[40:43], v[100:103]
    ds_read_b128 v[28:31], v252 offset:27648
    v_mfma_f32_16x16x32_bf16 v[100:103], a[28:31], v[44:47], v[100:103]
    s_waitcnt lgkmcnt(4)
    buffer_load_dwordx4 v[92:95], v252, s[20:23], s60 offen offset:1024 sc1
    v_mfma_f32_16x16x32_bf16 v[104:107], a[0:3], v[0:3], v[104:107]
    ds_read_b128 v[32:35], v252 offset:28672
    v_mfma_f32_16x16x32_bf16 v[104:107], a[8:11], v[4:7], v[104:107]
    v_rcp_f32 v250, v250
    v_mfma_f32_16x16x32_bf16 v[104:107], a[16:19], v[8:11], v[104:107]
    ds_read_b128 v[36:39], v252 offset:29696
    v_mfma_f32_16x16x32_bf16 v[104:107], a[24:27], v[12:15], v[104:107]
    v_rcp_f32 v251, v251
    v_mfma_f32_16x16x32_bf16 v[108:111], a[4:7], v[0:3], v[108:111]
    ds_read_b128 v[40:43], v252 offset:30720
    v_mul_f32 v244, v244, v248
    v_mfma_f32_16x16x32_bf16 v[108:111], a[12:15], v[4:7], v[108:111]
    v_mul_f32 v245, v245, v249
    v_mul_f32 v246, v246, v250
    v_mfma_f32_16x16x32_bf16 v[108:111], a[20:23], v[8:11], v[108:111]
    ds_read_b128 v[44:47], v252 offset:31744
    v_mul_f32 v247, v247, v251
    v_mfma_f32_16x16x32_bf16 v[108:111], a[28:31], v[12:15], v[108:111]
    s_waitcnt lgkmcnt(4)
    v_cvt_pk_bf16_f32 v244, v244, v245
    v_cvt_pk_bf16_f32 v245, v246, v247
    v_mfma_f32_16x16x32_bf16 v[96:99], a[32:35], v[16:19], v[96:99]
    s_waitcnt vmcnt(16) lgkmcnt(0)
    s_barrier
    ds_read_b128 v[0:3], v252 offset:32768
    v_mfma_f32_16x16x32_bf16 v[96:99], a[40:43], v[20:23], v[96:99]
    ds_bpermute_b32 v248, v231, v244 offset:0
    ds_bpermute_b32 v249, v231, v245 offset:0
    v_mfma_f32_16x16x32_bf16 v[96:99], a[48:51], v[24:27], v[96:99]
    ds_read_b128 v[4:7], v252 offset:33792
    ds_bpermute_b32 v250, v231, v244 offset:4
    v_mfma_f32_16x16x32_bf16 v[96:99], a[56:59], v[28:31], v[96:99]
    ds_bpermute_b32 v251, v231, v245 offset:4
    s_sub_u32 s82, s55, s37
    s_sub_u32 s83, s82, 16
    v_cmp_eq_u32 s[84:85], s82, v193
    v_mfma_f32_16x16x32_bf16 v[100:103], a[36:39], v[16:19], v[100:103]
    ds_read_b128 v[8:11], v252 offset:34816
    v_cmp_eq_u32 s[86:87], s83, v193
    v_mfma_f32_16x16x32_bf16 v[100:103], a[44:47], v[20:23], v[100:103]
    v_mfma_f32_16x16x32_bf16 v[100:103], a[52:55], v[24:27], v[100:103]
    ds_read_b128 v[12:15], v252 offset:35840
    v_mfma_f32_16x16x32_bf16 v[100:103], a[60:63], v[28:31], v[100:103]
    s_waitcnt lgkmcnt(8)
    v_mfma_f32_16x16x32_bf16 v[104:107], a[32:35], v[32:35], v[104:107]
    ds_read_b128 v[16:19], v252 offset:36864
    v_mfma_f32_16x16x32_bf16 v[104:107], a[40:43], v[36:39], v[104:107]
    v_mfma_f32_16x16x32_bf16 v[104:107], a[48:51], v[40:43], v[104:107]
    ds_read_b128 v[20:23], v252 offset:37888
    v_max3_f32 v204, |v96|, |v97|, |v98|
    v_max3_f32 v204, v204, |v99|, |v100|
    v_mfma_f32_16x16x32_bf16 v[104:107], a[56:59], v[44:47], v[104:107]
    v_max3_f32 v204, v204, |v101|, |v102|
    v_mfma_f32_16x16x32_bf16 v[108:111], a[36:39], v[32:35], v[108:111]
    ds_read_b128 v[24:27], v252 offset:38912
    s_waitcnt lgkmcnt(5)
    v_cndmask_b32 v208, v208, v248, s[84:85]
    v_mfma_f32_16x16x32_bf16 v[108:111], a[44:47], v[36:39], v[108:111]
    v_cndmask_b32 v209, v209, v249, s[84:85]
    v_cndmask_b32 v210, v210, v250, s[84:85]
    v_mfma_f32_16x16x32_bf16 v[108:111], a[52:55], v[40:43], v[108:111]
    ds_read_b128 v[28:31], v252 offset:39936
    v_max3_f32 v204, v204, |v103|, |v104|
    v_max3_f32 v204, v204, |v105|, |v106|
    v_mfma_f32_16x16x32_bf16 v[108:111], a[60:63], v[44:47], v[108:111]
    s_waitcnt lgkmcnt(4)
    v_cndmask_b32 v211, v211, v251, s[84:85]
    v_cndmask_b32 v212, v212, v248, s[86:87]
    v_mfma_f32_16x16x32_bf16 v[48:51], v[128:131], v[0:3], 0
    ds_read_b128 v[32:35], v252 offset:40960
    v_cndmask_b32 v213, v213, v249, s[86:87]
    v_mfma_f32_16x16x32_bf16 v[48:51], v[136:139], v[4:7], v[48:51]
    v_cndmask_b32 v214, v214, v250, s[86:87]
    v_cndmask_b32 v215, v215, v251, s[86:87]
    v_mfma_f32_16x16x32_bf16 v[48:51], v[144:147], v[8:11], v[48:51]
    ds_read_b128 v[36:39], v252 offset:41984
    v_max3_f32 v204, v204, |v107|, |v108|
    v_max3_f32 v204, v204, |v109|, |v110|
    v_mfma_f32_16x16x32_bf16 v[48:51], v[152:155], v[12:15], v[48:51]
    v_max_f32 v204, |v111|, v204
    v_bfe_u32 v204, v204, 23, 8
    v_sub_u32 v205, 126, v204
    v_mfma_f32_16x16x32_bf16 v[52:55], v[132:135], v[0:3], 0
    ds_read_b128 v[40:43], v252 offset:43008
    v_lshl_or_b32 v206, v204, 14, v204
    v_ldexp_f32 v96, v96, v205
    v_mfma_f32_16x16x32_bf16 v[52:55], v[140:143], v[4:7], v[52:55]
    v_ldexp_f32 v97, v97, v205
    v_ldexp_f32 v98, v98, v205
    v_ldexp_f32 v99, v99, v205
    v_mfma_f32_16x16x32_bf16 v[52:55], v[148:151], v[8:11], v[52:55]
    ds_read_b128 v[44:47], v252 offset:44032
    v_ldexp_f32 v100, v100, v205
    v_ldexp_f32 v101, v101, v205
    v_mfma_f32_16x16x32_bf16 v[52:55], v[156:159], v[12:15], v[52:55]
    s_waitcnt lgkmcnt(4)
    v_ldexp_f32 v102, v102, v205
    v_ldexp_f32 v103, v103, v205
    v_lshrrev_b32 v207, 4, v206
    v_mfma_f32_16x16x32_bf16 v[56:59], v[128:131], v[16:19], 0
    ds_read_b128 v[0:3], v252 offset:45056
    v_cvt_pknorm_i16_f32 v96, v96, v97
    v_cvt_pknorm_i16_f32 v97, v98, v99
    v_mfma_f32_16x16x32_bf16 v[56:59], v[136:139], v[20:23], v[56:59]
    v_cvt_pknorm_i16_f32 v98, v100, v101
    v_cvt_pknorm_i16_f32 v99, v102, v103
    v_bfi_b32 v96, v233, v206, v96
    v_mfma_f32_16x16x32_bf16 v[56:59], v[144:147], v[24:27], v[56:59]
    ds_read_b128 v[4:7], v252 offset:46080
    v_bfi_b32 v97, v233, s13, v97
    v_bfi_b32 v98, v233, s14, v98
    v_mfma_f32_16x16x32_bf16 v[56:59], v[152:155], v[28:31], v[56:59]
    v_bfi_b32 v99, v233, s15, v99
    buffer_store_dwordx4 v[96:99], v252, s[20:23], s18 offen offset:0 sc1
    v_mfma_f32_16x16x32_bf16 v[60:63], v[132:135], v[16:19], 0
    ds_read_b128 v[8:11], v252 offset:47104
    v_ldexp_f32 v104, v104, v205
    v_ldexp_f32 v105, v105, v205
    v_mfma_f32_16x16x32_bf16 v[60:63], v[140:143], v[20:23], v[60:63]
    v_ldexp_f32 v106, v106, v205
    v_ldexp_f32 v107, v107, v205
    v_ldexp_f32 v108, v108, v205
    v_mfma_f32_16x16x32_bf16 v[60:63], v[148:151], v[24:27], v[60:63]
    ds_read_b128 v[12:15], v252 offset:48128
    v_ldexp_f32 v109, v109, v205
    v_ldexp_f32 v110, v110, v205
    v_mfma_f32_16x16x32_bf16 v[60:63], v[156:159], v[28:31], v[60:63]
    s_waitcnt lgkmcnt(4)
    v_ldexp_f32 v111, v111, v205
    v_cvt_pknorm_i16_f32 v100, v104, v105
    v_cvt_pknorm_i16_f32 v101, v106, v107
    v_mfma_f32_16x16x32_bf16 v[48:51], v[160:163], v[32:35], v[48:51]
    ds_read_b128 v[16:19], v252 offset:49152
    v_cvt_pknorm_i16_f32 v102, v108, v109
    v_cvt_pknorm_i16_f32 v103, v110, v111
    v_mfma_f32_16x16x32_bf16 v[48:51], v[168:171], v[36:39], v[48:51]
    v_bfi_b32 v100, v233, v207, v100
    v_bfi_b32 v101, v233, s13, v101
    v_bfi_b32 v102, v233, s14, v102
    v_mfma_f32_16x16x32_bf16 v[48:51], v[176:179], v[40:43], v[48:51]
    ds_read_b128 v[20:23], v252 offset:50176
    v_bfi_b32 v103, v233, s15, v103
    v_mfma_f32_16x16x32_bf16 v[48:51], v[184:187], v[44:47], v[48:51]
    buffer_store_dwordx4 v[100:103], v252, s[20:23], s18 offen offset:1024 sc1
    v_mfma_f32_16x16x32_bf16 v[52:55], v[164:167], v[32:35], v[52:55]
    ds_read_b128 v[24:27], v252 offset:51200
    v_mfma_f32_16x16x32_bf16 v[52:55], v[172:175], v[36:39], v[52:55]
    v_mfma_f32_16x16x32_bf16 v[52:55], v[180:183], v[40:43], v[52:55]
    ds_read_b128 v[28:31], v252 offset:52224
    v_mfma_f32_16x16x32_bf16 v[52:55], v[188:191], v[44:47], v[52:55]
    s_waitcnt lgkmcnt(4)
    v_mfma_f32_16x16x32_bf16 v[56:59], v[160:163], v[0:3], v[56:59]
    ds_read_b128 v[32:35], v252 offset:53248
    v_mfma_f32_16x16x32_bf16 v[56:59], v[168:171], v[4:7], v[56:59]
    v_mfma_f32_16x16x32_bf16 v[56:59], v[176:179], v[8:11], v[56:59]
    ds_read_b128 v[36:39], v252 offset:54272
    v_mfma_f32_16x16x32_bf16 v[56:59], v[184:187], v[12:15], v[56:59]
    v_mfma_f32_16x16x32_bf16 v[60:63], v[164:167], v[0:3], v[60:63]
    ds_read_b128 v[40:43], v252 offset:55296
    v_mfma_f32_16x16x32_bf16 v[60:63], v[172:175], v[4:7], v[60:63]
    v_mfma_f32_16x16x32_bf16 v[60:63], v[180:183], v[8:11], v[60:63]
    ds_read_b128 v[44:47], v252 offset:56320
    v_mfma_f32_16x16x32_bf16 v[60:63], v[188:191], v[12:15], v[60:63]
    s_waitcnt lgkmcnt(4)
    v_mfma_f32_16x16x32_bf16 v[48:51], a[192:195], v[16:19], v[48:51]
    ds_read_b128 v[0:3], v252 offset:57344
    v_mfma_f32_16x16x32_bf16 v[48:51], a[200:203], v[20:23], v[48:51]
    v_mfma_f32_16x16x32_bf16 v[48:51], a[208:211], v[24:27], v[48:51]
    ds_read_b128 v[4:7], v252 offset:58368
    v_mfma_f32_16x16x32_bf16 v[48:51], a[216:219], v[28:31], v[48:51]
    v_mfma_f32_16x16x32_bf16 v[52:55], a[196:199], v[16:19], v[52:55]
    s_branch L_io17
    .p2align 12
L_iw17:
    s_branch L_iwr9
L_io17:
    ds_read_b128 v[8:11], v252 offset:59392
    v_mfma_f32_16x16x32_bf16 v[52:55], a[204:207], v[20:23], v[52:55]
    v_mfma_f32_16x16x32_bf16 v[52:55], a[212:215], v[24:27], v[52:55]
    ds_read_b128 v[12:15], v252 offset:60416
    v_mfma_f32_16x16x32_bf16 v[52:55], a[220:223], v[28:31], v[52:55]
    s_waitcnt lgkmcnt(4)
    v_mfma_f32_16x16x32_bf16 v[56:59], a[192:195], v[32:35], v[56:59]
    ds_read_b128 v[16:19], v252 offset:61440
    v_mfma_f32_16x16x32_bf16 v[56:59], a[200:203], v[36:39], v[56:59]
    v_mfma_f32_16x16x32_bf16 v[56:59], a[208:211], v[40:43], v[56:59]
    ds_read_b128 v[20:23], v252 offset:62464
    v_mfma_f32_16x16x32_bf16 v[56:59], a[216:219], v[44:47], v[56:59]
    v_mfma_f32_16x16x32_bf16 v[60:63], a[196:199], v[32:35], v[60:63]
    ds_read_b128 v[24:27], v252 offset:63488
    v_mfma_f32_16x16x32_bf16 v[60:63], a[204:207], v[36:39], v[60:63]
    v_mfma_f32_16x16x32_bf16 v[60:63], a[212:215], v[40:43], v[60:63]
    ds_read_b128 v[28:31], v252 offset:64512
    v_mfma_f32_16x16x32_bf16 v[60:63], a[220:223], v[44:47], v[60:63]
    s_waitcnt lgkmcnt(4)
    v_mfma_f32_16x16x32_bf16 v[48:51], a[224:227], v[0:3], v[48:51]
    s_waitcnt vmcnt(6) lgkmcnt(0)
    s_barrier
    ds_read_b128 v[32:35], v195 offset:0
    s_waitcnt vmcnt(2)
    v_mfma_f32_16x16x32_bf16 v[48:51], a[232:235], v[4:7], v[48:51]
    v_xor_b32 v196, s13, v81
    v_xor_b32 v197, s14, v82
    v_mfma_f32_16x16x32_bf16 v[48:51], a[240:243], v[8:11], v[48:51]
    ds_read_b128 v[36:39], v195 offset:1024
    v_bitop3_b32 v196, v83, s15, v196 bitop3:0xbe
    v_mfma_f32_16x16x32_bf16 v[48:51], a[248:251], v[12:15], v[48:51]
    v_bitop3_b32 v197, v85, s13, v197 bitop3:0xbe
    v_bitop3_b32 v196, v86, s14, v196 bitop3:0xbe
    v_mfma_f32_16x16x32_bf16 v[52:55], a[228:231], v[0:3], v[52:55]
    ds_read_b128 v[40:43], v195 offset:2048
    v_bitop3_b32 v197, v87, s15, v197 bitop3:0xbe
    v_mfma_f32_16x16x32_bf16 v[52:55], a[236:239], v[4:7], v[52:55]
    v_bitop3_b32 v196, v89, s13, v196 bitop3:0xbe
    v_bitop3_b32 v197, v90, s14, v197 bitop3:0xbe
    v_mfma_f32_16x16x32_bf16 v[52:55], a[244:247], v[8:11], v[52:55]
    ds_read_b128 v[44:47], v195 offset:3072
    v_bitop3_b32 v196, v91, s15, v196 bitop3:0xbe
    v_mfma_f32_16x16x32_bf16 v[52:55], a[252:255], v[12:15], v[52:55]
    s_waitcnt lgkmcnt(4)
    v_bitop3_b32 v197, v93, s13, v197 bitop3:0xbe
    v_bitop3_b32 v196, v94, s14, v196 bitop3:0xbe
    v_mfma_f32_16x16x32_bf16 v[56:59], a[224:227], v[16:19], v[56:59]
    ds_read_b128 v[0:3], v195 offset:4096
    v_bitop3_b32 v197, v95, s15, v197 bitop3:0xbe
    v_mfma_f32_16x16x32_bf16 v[56:59], a[232:235], v[20:23], v[56:59]
    v_or_b32 v196, v196, v197
    v_bitop3_b32 v196, v196, v233, s70 bitop3:0x6a
    v_mfma_f32_16x16x32_bf16 v[56:59], a[240:243], v[24:27], v[56:59]
    ds_read_b128 v[4:7], v195 offset:5120
    v_mfma_f32_16x16x32_bf16 v[56:59], a[248:251], v[28:31], v[56:59]
    v_cmp_ne_u32 vcc, s70, v196
    s_cbranch_vccnz L_p01_slow
L_p01_ok:
    v_mfma_f32_16x16x32_bf16 v[60:63], a[228:231], v[16:19], v[60:63]
    ds_read_b128 v[8:11], v195 offset:6144
    v_and_b32 v198, v233, v80
    v_mfma_f32_16x16x32_bf16 v[60:63], a[236:239], v[20:23], v[60:63]
    v_and_b32 v199, v233, v84
    v_lshl_or_b32 v198, v199, 4, v198
    v_mfma_f32_16x16x32_bf16 v[60:63], a[244:247], v[24:27], v[60:63]
    ds_read_b128 v[12:15], v195 offset:7168
    v_lshrrev_b32 v199, 14, v198
    v_mfma_f32_16x16x32_bf16 v[60:63], a[252:255], v[28:31], v[60:63]
    s_waitcnt lgkmcnt(4)
    v_bitop3_b32 v198, v198, s44, v199 bitop3:0xea
    v_lshlrev_b32 v201, 23, v198
    v_mfma_f32_16x16x32_bf16 v[48:51], a[128:131], v[32:35], v[48:51]
    ds_read_b128 v[16:19], v195 offset:8192
    v_mul_f32 v201, 0x38800100, v201
    v_mfma_f32_16x16x32_bf16 v[48:51], a[136:139], v[36:39], v[48:51]
    v_bfi_b32 v80, v233, s50, v80
    v_bfi_b32 v81, v233, s50, v81
    v_mfma_f32_16x16x32_bf16 v[48:51], a[144:147], v[40:43], v[48:51]
    ds_read_b128 v[20:23], v195 offset:9216
    v_bfi_b32 v82, v233, s50, v82
    v_mfma_f32_16x16x32_bf16 v[48:51], a[152:155], v[44:47], v[48:51]
    v_bfi_b32 v83, v233, s50, v83
    v_cvt_f32_i32_sdwa v64, sext(v80) dst_sel:DWORD dst_unused:UNUSED_PAD src0_sel:WORD_0
    v_mfma_f32_16x16x32_bf16 v[52:55], a[132:135], v[32:35], v[52:55]
    ds_read_b128 v[24:27], v195 offset:10240
    v_cvt_f32_i32_sdwa v65, sext(v80) dst_sel:DWORD dst_unused:UNUSED_PAD src0_sel:WORD_1
    v_mfma_f32_16x16x32_bf16 v[52:55], a[140:143], v[36:39], v[52:55]
    v_cvt_f32_i32_sdwa v66, sext(v81) dst_sel:DWORD dst_unused:UNUSED_PAD src0_sel:WORD_0
    v_cvt_f32_i32_sdwa v67, sext(v81) dst_sel:DWORD dst_unused:UNUSED_PAD src0_sel:WORD_1
    v_mfma_f32_16x16x32_bf16 v[52:55], a[148:151], v[40:43], v[52:55]
    ds_read_b128 v[28:31], v195 offset:11264
    v_cvt_f32_i32_sdwa v68, sext(v82) dst_sel:DWORD dst_unused:UNUSED_PAD src0_sel:WORD_0
    v_mfma_f32_16x16x32_bf16 v[52:55], a[156:159], v[44:47], v[52:55]
    s_waitcnt lgkmcnt(4)
    v_cvt_f32_i32_sdwa v69, sext(v82) dst_sel:DWORD dst_unused:UNUSED_PAD src0_sel:WORD_1
    v_cvt_f32_i32_sdwa v70, sext(v83) dst_sel:DWORD dst_unused:UNUSED_PAD src0_sel:WORD_0
    v_mfma_f32_16x16x32_bf16 v[56:59], a[128:131], v[0:3], v[56:59]
    ds_read_b128 v[32:35], v195 offset:12288
    v_cvt_f32_i32_sdwa v71, sext(v83) dst_sel:DWORD dst_unused:UNUSED_PAD src0_sel:WORD_1
    v_mfma_f32_16x16x32_bf16 v[56:59], a[136:139], v[4:7], v[56:59]
    v_mul_f32 v64, v64, v201
    v_mul_f32 v65, v65, v201
    v_mfma_f32_16x16x32_bf16 v[56:59], a[144:147], v[8:11], v[56:59]
    ds_read_b128 v[36:39], v195 offset:13312
    v_mul_f32 v66, v66, v201
    v_mfma_f32_16x16x32_bf16 v[56:59], a[152:155], v[12:15], v[56:59]
    v_mul_f32 v67, v67, v201
    v_mul_f32 v68, v68, v201
    v_mfma_f32_16x16x32_bf16 v[60:63], a[132:135], v[0:3], v[60:63]
    ds_read_b128 v[40:43], v195 offset:14336
    v_mul_f32 v69, v69, v201
    v_mfma_f32_16x16x32_bf16 v[60:63], a[140:143], v[4:7], v[60:63]
    v_mul_f32 v70, v70, v201
    v_mul_f32 v71, v71, v201
    v_mfma_f32_16x16x32_bf16 v[60:63], a[148:151], v[8:11], v[60:63]
    ds_read_b128 v[44:47], v195 offset:15360
    v_bfi_b32 v84, v233, s50, v84
    v_mfma_f32_16x16x32_bf16 v[60:63], a[156:159], v[12:15], v[60:63]
    s_waitcnt lgkmcnt(4)
    v_bfi_b32 v85, v233, s50, v85
    v_bfi_b32 v86, v233, s50, v86
    v_mfma_f32_16x16x32_bf16 v[48:51], a[160:163], v[16:19], v[48:51]
    ds_read_b128 v[0:3], v195 offset:16384
    v_bfi_b32 v87, v233, s50, v87
    v_mfma_f32_16x16x32_bf16 v[48:51], a[168:171], v[20:23], v[48:51]
    buffer_load_dwordx4 v[96:99], v252, s[20:23], s61 offen offset:0 sc1
    v_mfma_f32_16x16x32_bf16 v[48:51], a[176:179], v[24:27], v[48:51]
    ds_read_b128 v[4:7], v195 offset:17408
    v_cvt_f32_i32_sdwa v72, sext(v84) dst_sel:DWORD dst_unused:UNUSED_PAD src0_sel:WORD_0
    v_mfma_f32_16x16x32_bf16 v[48:51], a[184:187], v[28:31], v[48:51]
    buffer_load_dwordx4 v[100:103], v252, s[20:23], s61 offen offset:1024 sc1
    v_mfma_f32_16x16x32_bf16 v[52:55], a[164:167], v[16:19], v[52:55]
    ds_read_b128 v[8:11], v195 offset:18432
    v_cvt_f32_i32_sdwa v73, sext(v84) dst_sel:DWORD dst_unused:UNUSED_PAD src0_sel:WORD_1
    v_mfma_f32_16x16x32_bf16 v[52:55], a[172:175], v[20:23], v[52:55]
    v_cvt_f32_i32_sdwa v74, sext(v85) dst_sel:DWORD dst_unused:UNUSED_PAD src0_sel:WORD_0
    v_cvt_f32_i32_sdwa v75, sext(v85) dst_sel:DWORD dst_unused:UNUSED_PAD src0_sel:WORD_1
    v_mfma_f32_16x16x32_bf16 v[52:55], a[180:183], v[24:27], v[52:55]
    ds_read_b128 v[12:15], v195 offset:19456
    v_cvt_f32_i32_sdwa v76, sext(v86) dst_sel:DWORD dst_unused:UNUSED_PAD src0_sel:WORD_0
    v_mfma_f32_16x16x32_bf16 v[52:55], a[188:191], v[28:31], v[52:55]
    s_waitcnt lgkmcnt(4)
    v_cvt_f32_i32_sdwa v77, sext(v86) dst_sel:DWORD dst_unused:UNUSED_PAD src0_sel:WORD_1
    v_cvt_f32_i32_sdwa v78, sext(v87) dst_sel:DWORD dst_unused:UNUSED_PAD src0_sel:WORD_0
    v_mfma_f32_16x16x32_bf16 v[56:59], a[160:163], v[32:35], v[56:59]
    ds_read_b128 v[16:19], v195 offset:20480
    v_cvt_f32_i32_sdwa v79, sext(v87) dst_sel:DWORD dst_unused:UNUSED_PAD src0_sel:WORD_1
    v_mfma_f32_16x16x32_bf16 v[56:59], a[168:171], v[36:39], v[56:59]
    v_mul_f32 v72, v72, v201
    v_mul_f32 v73, v73, v201
    v_mfma_f32_16x16x32_bf16 v[56:59], a[176:179], v[40:43], v[56:59]
    ds_read_b128 v[20:23], v195 offset:21504
    v_mul_f32 v74, v74, v201
    v_mfma_f32_16x16x32_bf16 v[56:59], a[184:187], v[44:47], v[56:59]
    v_mul_f32 v75, v75, v201
    v_mul_f32 v76, v76, v201
    v_mfma_f32_16x16x32_bf16 v[60:63], a[164:167], v[32:35], v[60:63]
    ds_read_b128 v[24:27], v195 offset:22528
    v_mul_f32 v77, v77, v201
    v_mfma_f32_16x16x32_bf16 v[60:63], a[172:175], v[36:39], v[60:63]
    v_mul_f32 v78, v78, v201
    v_mul_f32 v79, v79, v201
    v_mfma_f32_16x16x32_bf16 v[60:63], a[180:183], v[40:43], v[60:63]
    ds_read_b128 v[28:31], v195 offset:23552
    v_and_b32 v198, v233, v88
    v_mfma_f32_16x16x32_bf16 v[60:63], a[188:191], v[44:47], v[60:63]
    s_waitcnt lgkmcnt(4)
    v_and_b32 v199, v233, v92
    v_lshl_or_b32 v198, v199, 4, v198
    v_mfma_f32_16x16x32_bf16 v[48:51], a[0:3], v[0:3], v[48:51]
    ds_read_b128 v[32:35], v195 offset:24576
    v_lshrrev_b32 v199, 14, v198
    v_mfma_f32_16x16x32_bf16 v[48:51], a[8:11], v[4:7], v[48:51]
    v_bitop3_b32 v198, v198, s44, v199 bitop3:0xea
    v_lshlrev_b32 v202, 23, v198
    v_mfma_f32_16x16x32_bf16 v[48:51], a[16:19], v[8:11], v[48:51]
    ds_read_b128 v[36:39], v195 offset:25600
    v_mul_f32 v202, 0x38800100, v202
    v_mfma_f32_16x16x32_bf16 v[48:51], a[24:27], v[12:15], v[48:51]
    v_bfi_b32 v88, v233, s50, v88
    v_bfi_b32 v89, v233, s50, v89
    v_mfma_f32_16x16x32_bf16 v[52:55], a[4:7], v[0:3], v[52:55]
    ds_read_b128 v[40:43], v195 offset:26624
    v_bfi_b32 v90, v233, s50, v90
    v_mfma_f32_16x16x32_bf16 v[52:55], a[12:15], v[4:7], v[52:55]
    v_bfi_b32 v91, v233, s50, v91
    v_cvt_f32_i32_sdwa v104, sext(v88) dst_sel:DWORD dst_unused:UNUSED_PAD src0_sel:WORD_0
    v_mfma_f32_16x16x32_bf16 v[52:55], a[20:23], v[8:11], v[52:55]
    ds_read_b128 v[44:47], v195 offset:27648
    v_cvt_f32_i32_sdwa v105, sext(v88) dst_sel:DWORD dst_unused:UNUSED_PAD src0_sel:WORD_1
    v_mfma_f32_16x16x32_bf16 v[52:55], a[28:31], v[12:15], v[52:55]
    s_waitcnt lgkmcnt(4)
    v_cvt_f32_i32_sdwa v106, sext(v89) dst_sel:DWORD dst_unused:UNUSED_PAD src0_sel:WORD_0
    v_cvt_f32_i32_sdwa v107, sext(v89) dst_sel:DWORD dst_unused:UNUSED_PAD src0_sel:WORD_1
    v_mfma_f32_16x16x32_bf16 v[56:59], a[0:3], v[16:19], v[56:59]
    ds_read_b128 v[0:3], v195 offset:28672
    v_cvt_f32_i32_sdwa v108, sext(v90) dst_sel:DWORD dst_unused:UNUSED_PAD src0_sel:WORD_0
    v_mfma_f32_16x16x32_bf16 v[56:59], a[8:11], v[20:23], v[56:59]
    v_cvt_f32_i32_sdwa v109, sext(v90) dst_sel:DWORD dst_unused:UNUSED_PAD src0_sel:WORD_1
    v_cvt_f32_i32_sdwa v110, sext(v91) dst_sel:DWORD dst_unused:UNUSED_PAD src0_sel:WORD_0
    v_mfma_f32_16x16x32_bf16 v[56:59], a[16:19], v[24:27], v[56:59]
    ds_read_b128 v[4:7], v195 offset:29696
    v_cvt_f32_i32_sdwa v111, sext(v91) dst_sel:DWORD dst_unused:UNUSED_PAD src0_sel:WORD_1
    v_mfma_f32_16x16x32_bf16 v[56:59], a[24:27], v[28:31], v[56:59]
    v_fmac_f32 v64, v104, v202
    v_fmac_f32 v65, v105, v202
    v_mfma_f32_16x16x32_bf16 v[60:63], a[4:7], v[16:19], v[60:63]
    ds_read_b128 v[8:11], v195 offset:30720
    v_fmac_f32 v66, v106, v202
    v_mfma_f32_16x16x32_bf16 v[60:63], a[12:15], v[20:23], v[60:63]
    v_fmac_f32 v67, v107, v202
    v_fmac_f32 v68, v108, v202
    v_mfma_f32_16x16x32_bf16 v[60:63], a[20:23], v[24:27], v[60:63]
    ds_read_b128 v[12:15], v195 offset:31744
    v_fmac_f32 v69, v109, v202
    v_mfma_f32_16x16x32_bf16 v[60:63], a[28:31], v[28:31], v[60:63]
    s_waitcnt lgkmcnt(4)
    v_fmac_f32 v70, v110, v202
    v_fmac_f32 v71, v111, v202
    v_mfma_f32_16x16x32_bf16 v[48:51], a[32:35], v[32:35], v[48:51]
    v_bfi_b32 v92, v233, s50, v92
    v_bfi_b32 v93, v233, s50, v93
    v_mfma_f32_16x16x32_bf16 v[48:51], a[40:43], v[36:39], v[48:51]
    v_bfi_b32 v94, v233, s50, v94
    v_bfi_b32 v95, v233, s50, v95
    v_mfma_f32_16x16x32_bf16 v[48:51], a[48:51], v[40:43], v[48:51]
    v_cvt_f32_i32_sdwa v104, sext(v92) dst_sel:DWORD dst_unused:UNUSED_PAD src0_sel:WORD_0
    v_cvt_f32_i32_sdwa v105, sext(v92) dst_sel:DWORD dst_unused:UNUSED_PAD src0_sel:WORD_1
    v_mfma_f32_16x16x32_bf16 v[48:51], a[56:59], v[44:47], v[48:51]
    v_cvt_f32_i32_sdwa v106, sext(v93) dst_sel:DWORD dst_unused:UNUSED_PAD src0_sel:WORD_0
    v_cvt_f32_i32_sdwa v107, sext(v93) dst_sel:DWORD dst_unused:UNUSED_PAD src0_sel:WORD_1
    v_mfma_f32_16x16x32_bf16 v[52:55], a[36:39], v[32:35], v[52:55]
    v_cvt_f32_i32_sdwa v108, sext(v94) dst_sel:DWORD dst_unused:UNUSED_PAD src0_sel:WORD_0
    v_cvt_f32_i32_sdwa v109, sext(v94) dst_sel:DWORD dst_unused:UNUSED_PAD src0_sel:WORD_1
    v_mfma_f32_16x16x32_bf16 v[52:55], a[44:47], v[36:39], v[52:55]
    v_cvt_f32_i32_sdwa v110, sext(v95) dst_sel:DWORD dst_unused:UNUSED_PAD src0_sel:WORD_0
    v_cvt_f32_i32_sdwa v111, sext(v95) dst_sel:DWORD dst_unused:UNUSED_PAD src0_sel:WORD_1
    v_mfma_f32_16x16x32_bf16 v[52:55], a[52:55], v[40:43], v[52:55]
    v_fmac_f32 v72, v104, v202
    v_fmac_f32 v73, v105, v202
    v_mfma_f32_16x16x32_bf16 v[52:55], a[60:63], v[44:47], v[52:55]
    s_waitcnt lgkmcnt(0)
    v_fmac_f32 v74, v106, v202
    v_fmac_f32 v75, v107, v202
    v_mfma_f32_16x16x32_bf16 v[56:59], a[32:35], v[0:3], v[56:59]
    v_fmac_f32 v76, v108, v202
    v_fmac_f32 v77, v109, v202
    v_mfma_f32_16x16x32_bf16 v[56:59], a[40:43], v[4:7], v[56:59]
    v_fmac_f32 v78, v110, v202
    v_fmac_f32 v79, v111, v202
    v_mfma_f32_16x16x32_bf16 v[56:59], a[48:51], v[8:11], v[56:59]
    v_lshlrev_b32 v80, 16, v208
    v_and_b32 v81, 0xffff0000, v208
    v_mfma_f32_16x16x32_bf16 v[56:59], a[56:59], v[12:15], v[56:59]
    v_lshlrev_b32 v82, 16, v209
    v_and_b32 v83, 0xffff0000, v209
    v_mfma_f32_16x16x32_bf16 v[60:63], a[36:39], v[0:3], v[60:63]
    v_lshlrev_b32 v84, 16, v210
    v_and_b32 v85, 0xffff0000, v210
    v_mfma_f32_16x16x32_bf16 v[60:63], a[44:47], v[4:7], v[60:63]
    v_lshlrev_b32 v86, 16, v211
    v_and_b32 v87, 0xffff0000, v211
    v_mfma_f32_16x16x32_bf16 v[60:63], a[52:55], v[8:11], v[60:63]
    v_lshlrev_b32 v88, 16, v212
    v_and_b32 v89, 0xffff0000, v212
    v_mfma_f32_16x16x32_bf16 v[60:63], a[60:63], v[12:15], v[60:63]
    v_lshlrev_b32 v90, 16, v213
    v_and_b32 v91, 0xffff0000, v213
    v_lshlrev_b32 v92, 16, v214
    v_and_b32 v93, 0xffff0000, v214
    v_lshlrev_b32 v94, 16, v215
    v_and_b32 v95, 0xffff0000, v215
    s_waitcnt vmcnt(0)
    v_xor_b32 v196, s13, v97
    v_xor_b32 v197, s14, v98
    v_bitop3_b32 v196, v99, s15, v196 bitop3:0xbe
    v_bitop3_b32 v197, v101, s13, v197 bitop3:0xbe
    v_bitop3_b32 v196, v102, s14, v196 bitop3:0xbe
    v_bitop3_b32 v197, v103, s15, v197 bitop3:0xbe
    v_or_b32 v196, v196, v197
    v_bitop3_b32 v196, v196, v233, s70 bitop3:0x6a
    v_cmp_ne_u32 vcc, s70, v196
    s_cbranch_vccnz L_p2_slow
L_p2_ok:
    v_and_b32 v198, v233, v96
    v_and_b32 v199, v233, v100
    v_lshl_or_b32 v198, v199, 4, v198
    v_lshrrev_b32 v199, 14, v198
    v_bitop3_b32 v198, v198, s44, v199 bitop3:0xea
    v_lshlrev_b32 v201, 23, v198
    v_mul_f32 v201, 0x38800100, v201
    v_bfi_b32 v96, v233, s50, v96
    v_bfi_b32 v97, v233, s50, v97
    v_bfi_b32 v98, v233, s50, v98
    v_bfi_b32 v99, v233, s50, v99
    v_cvt_f32_i32_sdwa v104, sext(v96) dst_sel:DWORD dst_unused:UNUSED_PAD src0_sel:WORD_0
    v_cvt_f32_i32_sdwa v105, sext(v96) dst_sel:DWORD dst_unused:UNUSED_PAD src0_sel:WORD_1
    v_cvt_f32_i32_sdwa v106, sext(v97) dst_sel:DWORD dst_unused:UNUSED_PAD src0_sel:WORD_0
    v_cvt_f32_i32_sdwa v107, sext(v97) dst_sel:DWORD dst_unused:UNUSED_PAD src0_sel:WORD_1
    v_cvt_f32_i32_sdwa v108, sext(v98) dst_sel:DWORD dst_unused:UNUSED_PAD src0_sel:WORD_0
    v_cvt_f32_i32_sdwa v109, sext(v98) dst_sel:DWORD dst_unused:UNUSED_PAD src0_sel:WORD_1
    v_cvt_f32_i32_sdwa v110, sext(v99) dst_sel:DWORD dst_unused:UNUSED_PAD src0_sel:WORD_0
    v_cvt_f32_i32_sdwa v111, sext(v99) dst_sel:DWORD dst_unused:UNUSED_PAD src0_sel:WORD_1
    v_fmac_f32 v64, v104, v201
    v_fmac_f32 v65, v105, v201
    v_fmac_f32 v66, v106, v201
    v_fmac_f32 v67, v107, v201
    v_fmac_f32 v68, v108, v201
    v_fmac_f32 v69, v109, v201
    v_fmac_f32 v70, v110, v201
    v_fmac_f32 v71, v111, v201
    v_bfi_b32 v100, v233, s50, v100
    v_bfi_b32 v101, v233, s50, v101
    v_bfi_b32 v102, v233, s50, v102
    v_bfi_b32 v103, v233, s50, v103
    v_cvt_f32_i32_sdwa v104, sext(v100) dst_sel:DWORD dst_unused:UNUSED_PAD src0_sel:WORD_0
    v_cvt_f32_i32_sdwa v105, sext(v100) dst_sel:DWORD dst_unused:UNUSED_PAD src0_sel:WORD_1
    v_cvt_f32_i32_sdwa v106, sext(v101) dst_sel:DWORD dst_unused:UNUSED_PAD src0_sel:WORD_0
    v_cvt_f32_i32_sdwa v107, sext(v101) dst_sel:DWORD dst_unused:UNUSED_PAD src0_sel:WORD_1
    v_cvt_f32_i32_sdwa v108, sext(v102) dst_sel:DWORD dst_unused:UNUSED_PAD src0_sel:WORD_0
    v_cvt_f32_i32_sdwa v109, sext(v102) dst_sel:DWORD dst_unused:UNUSED_PAD src0_sel:WORD_1
    v_cvt_f32_i32_sdwa v110, sext(v103) dst_sel:DWORD dst_unused:UNUSED_PAD src0_sel:WORD_0
    v_cvt_f32_i32_sdwa v111, sext(v103) dst_sel:DWORD dst_unused:UNUSED_PAD src0_sel:WORD_1
    v_fmac_f32 v72, v104, v201
    v_fmac_f32 v73, v105, v201
    v_fmac_f32 v74, v106, v201
    v_fmac_f32 v75, v107, v201
    v_fmac_f32 v76, v108, v201
    v_fmac_f32 v77, v109, v201
    v_fmac_f32 v78, v110, v201
    v_fmac_f32 v79, v111, v201
    v_pk_add_f32 v[64:65], v[64:65], v[48:49]
    v_pk_add_f32 v[66:67], v[66:67], v[50:51]
    v_pk_add_f32 v[68:69], v[68:69], v[52:53]
    v_pk_add_f32 v[70:71], v[70:71], v[54:55]
    v_pk_add_f32 v[72:73], v[72:73], v[56:57]
    v_pk_add_f32 v[74:75], v[74:75], v[58:59]
    v_pk_add_f32 v[76:77], v[76:77], v[60:61]
    v_pk_add_f32 v[78:79], v[78:79], v[62:63]
    v_cvt_pk_bf16_f32 v64, v64, v65
    v_cvt_pk_bf16_f32 v66, v66, v67
    v_cvt_pk_bf16_f32 v68, v68, v69
    v_cvt_pk_bf16_f32 v70, v70, v71
    v_cvt_pk_bf16_f32 v72, v72, v73
    v_cvt_pk_bf16_f32 v74, v74, v75
    v_cvt_pk_bf16_f32 v76, v76, v77
    v_cvt_pk_bf16_f32 v78, v78, v79
    v_and_b32 v65, 0xffff0000, v64
    v_lshlrev_b32 v64, 16, v64
    v_and_b32 v67, 0xffff0000, v66
    v_lshlrev_b32 v66, 16, v66
    v_and_b32 v69, 0xffff0000, v68
    v_lshlrev_b32 v68, 16, v68
    v_and_b32 v71, 0xffff0000, v70
    v_lshlrev_b32 v70, 16, v70
    v_and_b32 v73, 0xffff0000, v72
    v_lshlrev_b32 v72, 16, v72
    v_and_b32 v75, 0xffff0000, v74
    v_lshlrev_b32 v74, 16, v74
    v_and_b32 v77, 0xffff0000, v76
    v_lshlrev_b32 v76, 16, v76
    v_and_b32 v79, 0xffff0000, v78
    v_lshlrev_b32 v78, 16, v78
    v_pk_mul_f32 v[64:65], v[64:65], v[80:81]
    v_pk_mul_f32 v[66:67], v[66:67], v[82:83]
    v_pk_mul_f32 v[68:69], v[68:69], v[84:85]
    v_pk_mul_f32 v[70:71], v[70:71], v[86:87]
    v_pk_mul_f32 v[72:73], v[72:73], v[88:89]
    v_pk_mul_f32 v[74:75], v[74:75], v[90:91]
    v_pk_mul_f32 v[76:77], v[76:77], v[92:93]
    v_pk_mul_f32 v[78:79], v[78:79], v[94:95]
    v_cvt_pk_bf16_f32 v64, v64, v65
    v_cvt_pk_bf16_f32 v66, v66, v67
    v_cvt_pk_bf16_f32 v68, v68, v69
    v_cvt_pk_bf16_f32 v70, v70, v71
    v_cvt_pk_bf16_f32 v72, v72, v73
    v_cvt_pk_bf16_f32 v74, v74, v75
    v_cvt_pk_bf16_f32 v76, v76, v77
    v_cvt_pk_bf16_f32 v78, v78, v79
    v_and_b32 v65, 0xffff0000, v64
    v_lshlrev_b32 v64, 16, v64
    v_and_b32 v67, 0xffff0000, v66
    v_lshlrev_b32 v66, 16, v66
    v_and_b32 v69, 0xffff0000, v68
    v_lshlrev_b32 v68, 16, v68
    v_and_b32 v71, 0xffff0000, v70
    v_lshlrev_b32 v70, 16, v70
    v_and_b32 v73, 0xffff0000, v72
    v_lshlrev_b32 v72, 16, v72
    v_and_b32 v75, 0xffff0000, v74
    v_lshlrev_b32 v74, 16, v74
    s_branch L_io18
    .p2align 12
L_iw18:
    s_branch L_iwr9
L_io18:
    v_and_b32 v77, 0xffff0000, v76
    v_lshlrev_b32 v76, 16, v76
    v_and_b32 v79, 0xffff0000, v78
    v_lshlrev_b32 v78, 16, v78
    v_pk_add_f32 v[64:65], v[64:65], v[112:113]
    v_pk_add_f32 v[66:67], v[66:67], v[114:115]
    v_pk_add_f32 v[68:69], v[68:69], v[116:117]
    v_pk_add_f32 v[70:71], v[70:71], v[118:119]
    v_pk_add_f32 v[72:73], v[72:73], v[120:121]
    v_pk_add_f32 v[74:75], v[74:75], v[122:123]
    v_pk_add_f32 v[76:77], v[76:77], v[124:125]
    v_pk_add_f32 v[78:79], v[78:79], v[126:127]
    v_cvt_pk_bf16_f32 v16, v64, v65
    v_cvt_pk_bf16_f32 v17, v66, v67
    v_cvt_pk_bf16_f32 v18, v68, v69
    v_cvt_pk_bf16_f32 v19, v70, v71
    v_cvt_pk_bf16_f32 v20, v72, v73
    v_cvt_pk_bf16_f32 v21, v74, v75
    v_cvt_pk_bf16_f32 v22, v76, v77
    v_cvt_pk_bf16_f32 v23, v78, v79
    buffer_store_dwordx4 v[16:19], v241, s[8:11], s38 offen
    buffer_store_dwordx4 v[20:23], v241, s[8:11], s12 offen
    s_add_u32 s42, s2, s3
    s_cmp_eq_u32 s42, 0
    s_cselect_b32 s42, 16797696, 1073741824
    s_add_u32 s43, s71, 1
    v_mov_b32 v0, s43
    buffer_store_dword v0, v255, s[20:23], s42 offen
    s_waitcnt vmcnt(0)
L_end:
    s_endpgm
L_maxpass:
    v_lshrrev_b32 v248, 4, v252
    v_and_b32 v249, 15, v248
    v_lshrrev_b32 v248, 4, v248
    v_lshlrev_b32 v249, 8, v249
    v_lshlrev_b32 v248, 4, v248
    v_add_u32 v248, v248, v249
    s_mov_b32 s42, 0
    s_nop 7
    s_nop 7
L_maxloop:
    buffer_load_dwordx4 a[0:3], v248, s[12:15], s42 offen offset:0
    buffer_load_dwordx4 a[4:7], v248, s[12:15], s42 offen offset:64
    buffer_load_dwordx4 a[8:11], v248, s[12:15], s42 offen offset:128
    buffer_load_dwordx4 a[12:15], v248, s[12:15], s42 offen offset:192
    s_add_u32 s42, s42, 4096
    buffer_load_dwordx4 a[16:19], v248, s[12:15], s42 offen offset:0
    buffer_load_dwordx4 a[20:23], v248, s[12:15], s42 offen offset:64
    buffer_load_dwordx4 a[24:27], v248, s[12:15], s42 offen offset:128
    buffer_load_dwordx4 a[28:31], v248, s[12:15], s42 offen offset:192
    s_add_u32 s42, s42, 4096
    buffer_load_dwordx4 a[32:35], v248, s[12:15], s42 offen offset:0
    buffer_load_dwordx4 a[36:39], v248, s[12:15], s42 offen offset:64
    buffer_load_dwordx4 a[40:43], v248, s[12:15], s42 offen offset:128
    buffer_load_dwordx4 a[44:47], v248, s[12:15], s42 offen offset:192
    s_add_u32 s42, s42, 4096
    buffer_load_dwordx4 a[48:51], v248, s[12:15], s42 offen offset:0
    buffer_load_dwordx4 a[52:55], v248, s[12:15], s42 offen offset:64
    buffer_load_dwordx4 a[56:59], v248, s[12:15], s42 offen offset:128
    buffer_load_dwordx4 a[60:63], v248, s[12:15], s42 offen offset:192
    s_add_u32 s42, s42, 4096
    s_waitcnt vmcnt(0)
    v_mfma_f32_16x16x32_bf16 v[64:67], a[0:3], v[128:131], 0
    v_mfma_f32_16x16x32_bf16 v[64:67], a[4:7], v[132:135], v[64:67]
    v_mfma_f32_16x16x32_bf16 v[64:67], a[8:11], v[136:139], v[64:67]
    v_mfma_f32_16x16x32_bf16 v[64:67], a[12:15], v[140:143], v[64:67]
    v_mfma_f32_16x16x32_bf16 v[68:71], a[16:19], v[128:131], 0
    v_mfma_f32_16x16x32_bf16 v[68:71], a[20:23], v[132:135], v[68:71]
    v_mfma_f32_16x16x32_bf16 v[68:71], a[24:27], v[136:139], v[68:71]
    v_mfma_f32_16x16x32_bf16 v[68:71], a[28:31], v[140:143], v[68:71]
    v_mfma_f32_16x16x32_bf16 v[72:75], a[32:35], v[128:131], 0
    v_mfma_f32_16x16x32_bf16 v[72:75], a[36:39], v[132:135], v[72:75]
    v_mfma_f32_16x16x32_bf16 v[72:75], a[40:43], v[136:139], v[72:75]
    v_mfma_f32_16x16x32_bf16 v[72:75], a[44:47], v[140:143], v[72:75]
    v_mfma_f32_16x16x32_bf16 v[76:79], a[48:51], v[128:131], 0
    v_mfma_f32_16x16x32_bf16 v[76:79], a[52:55], v[132:135], v[76:79]
    v_mfma_f32_16x16x32_bf16 v[76:79], a[56:59], v[136:139], v[76:79]
    v_mfma_f32_16x16x32_bf16 v[76:79], a[60:63], v[140:143], v[76:79]
    v_mfma_f32_16x16x32_bf16 v[80:83], a[0:3], v[144:147], 0
    v_mfma_f32_16x16x32_bf16 v[80:83], a[4:7], v[148:151], v[80:83]
    v_mfma_f32_16x16x32_bf16 v[80:83], a[8:11], v[152:155], v[80:83]
    v_mfma_f32_16x16x32_bf16 v[80:83], a[12:15], v[156:159], v[80:83]
    v_mfma_f32_16x16x32_bf16 v[84:87], a[16:19], v[144:147], 0
    v_mfma_f32_16x16x32_bf16 v[84:87], a[20:23], v[148:151], v[84:87]
    v_mfma_f32_16x16x32_bf16 v[84:87], a[24:27], v[152:155], v[84:87]
    v_mfma_f32_16x16x32_bf16 v[84:87], a[28:31], v[156:159], v[84:87]
    v_mfma_f32_16x16x32_bf16 v[88:91], a[32:35], v[144:147], 0
    v_mfma_f32_16x16x32_bf16 v[88:91], a[36:39], v[148:151], v[88:91]
    v_mfma_f32_16x16x32_bf16 v[88:91], a[40:43], v[152:155], v[88:91]
    v_mfma_f32_16x16x32_bf16 v[88:91], a[44:47], v[156:159], v[88:91]
    v_mfma_f32_16x16x32_bf16 v[92:95], a[48:51], v[144:147], 0
    v_mfma_f32_16x16x32_bf16 v[92:95], a[52:55], v[148:151], v[92:95]
    v_mfma_f32_16x16x32_bf16 v[92:95], a[56:59], v[152:155], v[92:95]
    v_mfma_f32_16x16x32_bf16 v[92:95], a[60:63], v[156:159], v[92:95]
    v_mfma_f32_16x16x32_bf16 v[96:99], a[0:3], v[160:163], 0
    v_mfma_f32_16x16x32_bf16 v[96:99], a[4:7], v[164:167], v[96:99]
    v_mfma_f32_16x16x32_bf16 v[96:99], a[8:11], v[168:171], v[96:99]
    v_mfma_f32_16x16x32_bf16 v[96:99], a[12:15], v[172:175], v[96:99]
    v_mfma_f32_16x16x32_bf16 v[100:103], a[16:19], v[160:163], 0
    v_mfma_f32_16x16x32_bf16 v[100:103], a[20:23], v[164:167], v[100:103]
    v_mfma_f32_16x16x32_bf16 v[100:103], a[24:27], v[168:171], v[100:103]
    v_mfma_f32_16x16x32_bf16 v[100:103], a[28:31], v[172:175], v[100:103]
    v_mfma_f32_16x16x32_bf16 v[104:107], a[32:35], v[160:163], 0
    v_mfma_f32_16x16x32_bf16 v[104:107], a[36:39], v[164:167], v[104:107]
    v_mfma_f32_16x16x32_bf16 v[104:107], a[40:43], v[168:171], v[104:107]
    v_mfma_f32_16x16x32_bf16 v[104:107], a[44:47], v[172:175], v[104:107]
    v_mfma_f32_16x16x32_bf16 v[108:111], a[48:51], v[160:163], 0
    v_mfma_f32_16x16x32_bf16 v[108:111], a[52:55], v[164:167], v[108:111]
    v_mfma_f32_16x16x32_bf16 v[108:111], a[56:59], v[168:171], v[108:111]
    v_mfma_f32_16x16x32_bf16 v[108:111], a[60:63], v[172:175], v[108:111]
    v_mfma_f32_16x16x32_bf16 v[112:115], a[0:3], v[176:179], 0
    v_mfma_f32_16x16x32_bf16 v[112:115], a[4:7], v[180:183], v[112:115]
    v_mfma_f32_16x16x32_bf16 v[112:115], a[8:11], v[184:187], v[112:115]
    v_mfma_f32_16x16x32_bf16 v[112:115], a[12:15], v[188:191], v[112:115]
    v_mfma_f32_16x16x32_bf16 v[116:119], a[16:19], v[176:179], 0
    v_mfma_f32_16x16x32_bf16 v[116:119], a[20:23], v[180:183], v[116:119]
    v_mfma_f32_16x16x32_bf16 v[116:119], a[24:27], v[184:187], v[116:119]
    v_mfma_f32_16x16x32_bf16 v[116:119], a[28:31], v[188:191], v[116:119]
    v_mfma_f32_16x16x32_bf16 v[120:123], a[32:35], v[176:179], 0
    v_mfma_f32_16x16x32_bf16 v[120:123], a[36:39], v[180:183], v[120:123]
    v_mfma_f32_16x16x32_bf16 v[120:123], a[40:43], v[184:187], v[120:123]
    v_mfma_f32_16x16x32_bf16 v[120:123], a[44:47], v[188:191], v[120:123]
    v_mfma_f32_16x16x32_bf16 v[124:127], a[48:51], v[176:179], 0
    v_mfma_f32_16x16x32_bf16 v[124:127], a[52:55], v[180:183], v[124:127]
    v_mfma_f32_16x16x32_bf16 v[124:127], a[56:59], v[184:187], v[124:127]
    v_mfma_f32_16x16x32_bf16 v[124:127], a[60:63], v[188:191], v[124:127]
    s_nop 7
    s_nop 1
    v_max3_f32 v208, v208, v64, v65
    v_max3_f32 v208, v208, v66, v67
    v_max3_f32 v208, v208, v68, v69
    v_max3_f32 v208, v208, v70, v71
    v_max3_f32 v208, v208, v72, v73
    v_max3_f32 v208, v208, v74, v75
    v_max3_f32 v208, v208, v76, v77
    v_max3_f32 v208, v208, v78, v79
    v_max3_f32 v209, v209, v80, v81
    v_max3_f32 v209, v209, v82, v83
    v_max3_f32 v209, v209, v84, v85
    v_max3_f32 v209, v209, v86, v87
    v_max3_f32 v209, v209, v88, v89
    v_max3_f32 v209, v209, v90, v91
    v_max3_f32 v209, v209, v92, v93
    v_max3_f32 v209, v209, v94, v95
    v_max3_f32 v210, v210, v96, v97
    v_max3_f32 v210, v210, v98, v99
    v_max3_f32 v210, v210, v100, v101
    v_max3_f32 v210, v210, v102, v103
    v_max3_f32 v210, v210, v104, v105
    v_max3_f32 v210, v210, v106, v107
    v_max3_f32 v210, v210, v108, v109
    v_max3_f32 v210, v210, v110, v111
    v_max3_f32 v211, v211, v112, v113
    v_max3_f32 v211, v211, v114, v115
    v_max3_f32 v211, v211, v116, v117
    v_max3_f32 v211, v211, v118, v119
    v_max3_f32 v211, v211, v120, v121
    v_max3_f32 v211, v211, v122, v123
    v_max3_f32 v211, v211, v124, v125
    v_max3_f32 v211, v211, v126, v127
    s_cmp_lt_u32 s42, 524288
    s_cbranch_scc1 L_maxloop
    s_branch L_maxdone
L_st_slow:
    s_mov_b32 s34, 20000
L_st_spin:
    s_sleep 2
    buffer_load_dwordx2 v[244:245], v156, s[20:23], s54 offen offset:0 sc1
    buffer_load_dwordx2 v[246:247], v156, s[20:23], s54 offen offset:128 sc1
    buffer_load_dwordx2 v[248:249], v156, s[20:23], s54 offen offset:256 sc1
    buffer_load_dwordx2 v[250:251], v156, s[20:23], s54 offen offset:384 sc1
    s_waitcnt vmcnt(0)
    v_cmp_ne_u32 vcc, s70, v245
    v_cmp_ne_u32 s[42:43], s70, v247
    s_nop 0
    s_or_b64 vcc, vcc, s[42:43]
    v_cmp_ne_u32 s[42:43], s70, v249
    s_nop 0
    s_or_b64 vcc, vcc, s[42:43]
    v_cmp_ne_u32 s[42:43], s70, v251
    s_nop 0
    s_or_b64 vcc, vcc, s[42:43]
    s_cbranch_vccz L_st_ok
    s_sub_u32 s34, s34, 1
    s_cmp_lg_u32 s34, 0
    s_cbranch_scc1 L_st_spin
    s_branch L_st_ok
L_key_slow:
    s_mov_b32 s34, 20000
L_key_spin:
    s_sleep 2
    buffer_load_dwordx4 v[244:247], v252, s[20:23], s54 offen offset:0 sc1
    buffer_load_dwordx4 v[248:251], v252, s[20:23], s54 offen offset:1024 sc1
    s_waitcnt vmcnt(0)
    v_cmp_ne_u32 vcc, s70, v245
    v_cmp_ne_u32 s[42:43], s70, v247
    s_nop 0
    s_or_b64 vcc, vcc, s[42:43]
    v_cmp_ne_u32 s[42:43], s70, v249
    s_nop 0
    s_or_b64 vcc, vcc, s[42:43]
    v_cmp_ne_u32 s[42:43], s70, v251
    s_nop 0
    s_or_b64 vcc, vcc, s[42:43]
    s_cbranch_vccz L_key_ok
    s_sub_u32 s34, s34, 1
    s_cmp_lg_u32 s34, 0
    s_cbranch_scc1 L_key_spin
    s_branch L_key_ok
L_fail:
    s_mov_b32 s74, 1
    s_waitcnt vmcnt(0)
    s_barrier
    s_branch L_restart
L_poll_slow:
    s_mov_b32 s34, 20000
L_poll_spin:
    s_sleep 2
    buffer_load_dword v193, v192, s[20:23], s25 offen sc1
    s_waitcnt vmcnt(0)
    v_cmp_ne_u32 vcc, s70, v193
    s_cbranch_vccz L_poll_ok
    s_sub_u32 s34, s34, 1
    s_cmp_lg_u32 s34, 0
    s_cbranch_scc1 L_poll_spin
    s_branch L_poll_ok
L_y0:
    buffer_load_dwordx4 v[244:247], v252, s[20:23], s46 offen sc1
    s_branch L_y0_back
L_f2_slow:
    s_mov_b32 s34, 20000
L_f2_spin:
    s_sleep 2
    buffer_load_dwordx4 v[244:247], v252, s[20:23], s46 offen sc1
    s_waitcnt vmcnt(0)
    v_cmp_ne_u32 vcc, s70, v244
    v_cmp_ne_u32 s[86:87], s70, v245
    s_nop 0
    s_or_b64 vcc, vcc, s[86:87]
    v_cmp_ne_u32 s[86:87], s70, v246
    s_nop 0
    s_or_b64 vcc, vcc, s[86:87]
    v_cmp_ne_u32 s[86:87], s70, v247
    s_nop 0
    s_or_b64 vcc, vcc, s[86:87]
    s_and_b64 vcc, vcc, s[80:81]
    s_cbranch_vccz L_f2_ok
    s_sub_u32 s34, s34, 1
    s_cmp_lg_u32 s34, 0
    s_cbranch_scc1 L_f2_spin
    s_branch L_f2_ok
L_y1:
    s_waitcnt vmcnt(9)
    v_cmp_ne_u32 vcc, s70, v244
    v_cmp_ne_u32 s[86:87], s70, v245
    s_nop 0
    s_or_b64 vcc, vcc, s[86:87]
    v_cmp_ne_u32 s[86:87], s70, v246
    s_nop 0
    s_or_b64 vcc, vcc, s[86:87]
    v_cmp_ne_u32 s[86:87], s70, v247
    s_nop 0
    s_or_b64 vcc, vcc, s[86:87]
    s_and_b64 vcc, vcc, s[80:81]
    s_cbranch_vccnz L_f2_slow
L_f2_ok:
    buffer_load_dwordx4 v[244:247], v192, s[20:23], s26 offen sc1
    s_branch L_y1_back
L_y2:
    s_waitcnt vmcnt(8)
    s_branch L_y2_back
L_p01_slow:
    s_mov_b32 s34, 20000
L_p01_spin:
    s_sleep 2
    buffer_load_dwordx4 v[80:83], v252, s[20:23], s19 offen offset:0 sc1
    buffer_load_dwordx4 v[84:87], v252, s[20:23], s19 offen offset:1024 sc1
    buffer_load_dwordx4 v[88:91], v252, s[20:23], s60 offen offset:0 sc1
    buffer_load_dwordx4 v[92:95], v252, s[20:23], s60 offen offset:1024 sc1
    s_waitcnt vmcnt(0)
    v_xor_b32 v196, s13, v81
    v_xor_b32 v197, s14, v82
    v_bitop3_b32 v196, v83, s15, v196 bitop3:0xbe
    v_bitop3_b32 v197, v85, s13, v197 bitop3:0xbe
    v_bitop3_b32 v196, v86, s14, v196 bitop3:0xbe
    v_bitop3_b32 v197, v87, s15, v197 bitop3:0xbe
    v_bitop3_b32 v196, v89, s13, v196 bitop3:0xbe
    v_bitop3_b32 v197, v90, s14, v197 bitop3:0xbe
    v_bitop3_b32 v196, v91, s15, v196 bitop3:0xbe
    v_bitop3_b32 v197, v93, s13, v197 bitop3:0xbe
    v_bitop3_b32 v196, v94, s14, v196 bitop3:0xbe
    v_bitop3_b32 v197, v95, s15, v197 bitop3:0xbe
    v_or_b32 v196, v196, v197
    v_bitop3_b32 v196, v196, v233, s70 bitop3:0x6a
    v_cmp_ne_u32 vcc, s70, v196
    s_cbranch_vccz L_p01_ok
    s_sub_u32 s34, s34, 1
    s_cmp_lg_u32 s34, 0
    s_cbranch_scc1 L_p01_spin
    s_branch L_p01_ok
L_p2_slow:
    s_mov_b32 s34, 20000
L_p2_spin:
    s_sleep 2
    buffer_load_dwordx4 v[96:99], v252, s[20:23], s61 offen offset:0 sc1
    buffer_load_dwordx4 v[100:103], v252, s[20:23], s61 offen offset:1024 sc1
    s_waitcnt vmcnt(0)
    v_xor_b32 v196, s13, v97
    v_xor_b32 v197, s14, v98
    v_bitop3_b32 v196, v99, s15, v196 bitop3:0xbe
    v_bitop3_b32 v197, v101, s13, v197 bitop3:0xbe
    v_bitop3_b32 v196, v102, s14, v196 bitop3:0xbe
    v_bitop3_b32 v197, v103, s15, v197 bitop3:0xbe
    v_or_b32 v196, v196, v197
    v_bitop3_b32 v196, v196, v233, s70 bitop3:0x6a
    v_cmp_ne_u32 vcc, s70, v196
    s_cbranch_vccz L_p2_ok
    s_sub_u32 s34, s34, 1
    s_cmp_lg_u32 s34, 0
    s_cbranch_scc1 L_p2_spin
    s_branch L_p2_ok
L_codeend:
.section .rodata,"a"
.p2align 6
.amdhsa_kernel recurrent_scan__mha_block_cached__moe_arch_mod__prompt_kernel
  .amdhsa_next_free_vgpr 512
  .amdhsa_next_free_sgpr 102
  .amdhsa_accum_offset 256
  .amdhsa_group_segment_fixed_size 0
  .amdhsa_kernarg_size 104
  .amdhsa_user_sgpr_count 2
  .amdhsa_user_sgpr_kernarg_segment_ptr 1
  .amdhsa_system_sgpr_workgroup_id_x 1
.end_amdhsa_kernel
```
